```python
import torch

def _softmax(x, axis=-1):
    return torch.softmax(x, dim=axis)
def _gelu(x):
    return torch.nn.functional.gelu(x, approximate="tanh")
def _silu(x):
    return torch.nn.functional.silu(x)
def _sigmoid(x):
    return torch.sigmoid(x)
def _layernorm(x, axis=-1, eps=1e-5):
    m = x.mean(dim=axis, keepdim=True)
    v = x.var(dim=axis, keepdim=True, unbiased=False)
    return (x - m) / torch.sqrt(v + eps)
def _scatter_add(tgt, idx, src, axis=0):
    return tgt.clone().index_add_(axis, idx, src)
def _segment_sum(src, seg, n):
    out = torch.zeros((n,) + src.shape[1:], dtype=src.dtype)
    return out.index_add_(0, seg, src)
def _pad(x, pw):
    flat = tuple(v for pair in reversed(pw) for v in pair)
    return torch.nn.functional.pad(x, flat)

kernel_name = 'concat_heads__ssm_conv_s4d__mha_block__prompt'

def setup_inputs():

    _w = (lambda a: (lambda t: t.to(torch.bfloat16) if t.is_floating_point() else t)(torch.as_tensor(a)))
    def _A_setup():
        Bsz, L, D, N = 1, 2048, 576, 128
        return {
            "u": _w((lambda *s: torch.randn(*s, dtype=torch.bfloat16) * 0.05)(Bsz, L, D)),
            "log_A_real": _w((lambda *s: torch.randn(*s, dtype=torch.bfloat16) * 3.2)(D, N) * 0.5),
            "A_imag": _w((lambda *s: torch.randn(*s, dtype=torch.bfloat16) * 0.1)(D, N) * 3.14),
            "C_real": _w((lambda *s: torch.randn(*s, dtype=torch.bfloat16) * 0.8)(D, N) / N ** 0.5),
            "C_imag": _w((lambda *s: torch.randn(*s, dtype=torch.bfloat16) * 1.6)(D, N) / N ** 0.5),
            "log_dt": _w((lambda *s: torch.randn(*s, dtype=torch.bfloat16) * 0.1)(D) * 0.5 - 4.0),
            "D_skip": _w((lambda *s: torch.randn(*s, dtype=torch.bfloat16) * 0.1)(D)),
        }
    _A_in = _A_setup()

    def _B_setup():
        B, S, D, H = 1, 2048, 576, 32
        return {
            "x": _w((lambda *s: torch.randn(*s, dtype=torch.bfloat16) * 0.2)(B, S, D)),
            "wqkv": _w((lambda *s: torch.randn(*s, dtype=torch.bfloat16) * 0.2)(D, 3 * D)),
            "wo": _w((lambda *s: torch.randn(*s, dtype=torch.bfloat16) * 0.05)(D, D)),
        }
    _B_in = _B_setup()

    return {
        "A_u": _A_in["u"],
        "A_log_A_real": _A_in["log_A_real"],
        "A_A_imag": _A_in["A_imag"],
        "A_C_real": _A_in["C_real"],
        "A_C_imag": _A_in["C_imag"],
        "A_log_dt": _A_in["log_dt"],
        "A_D_skip": _A_in["D_skip"],
        "B_x": _B_in["x"],
        "B_wqkv": _B_in["wqkv"],
        "B_wo": _B_in["wo"],
    }

def reference(A_u, A_log_A_real, A_A_imag, A_C_real, A_C_imag, A_log_dt, A_D_skip, B_x, B_wqkv, B_wo):
    def _A_ref(u, log_A_real, A_imag, C_real, C_imag, log_dt, D_skip):
        L = u.shape[1]
        dt = torch.exp(log_dt)
        A = -torch.exp(log_A_real) + 1j * A_imag
        C = (C_real + 1j * C_imag) * dt[:, None]
        pos = (lambda x, dt: x.to(dt))(torch.arange(L), log_dt.dtype)
        P = torch.exp((A * dt[:, None])[:, :, None] * pos[None, None, :])
        K = 2.0 * torch.einsum("dn,dnl->dl", C, P).real
        L2 = 2 * L
        u_t = (lambda x, *d: x.permute(*d))(u, 0, 2, 1)
        Kf = (lambda x, *a, **k: torch.fft.rfft(x.float(), *a, **k))(K, L2)
        Uf = (lambda x, *a, **k: torch.fft.rfft(x.float(), *a, **k))(u_t, L2)
        y = (lambda x, *a, **k: torch.fft.irfft(x, *a, **k).to(torch.bfloat16))(Uf * Kf[None, :, :], L2)[:, :, :L]
        y = (lambda x, *d: x.permute(*d))(y, 0, 2, 1)
        return y + u * D_skip[None, None, :]

    def _B_ref(x, wqkv, wo):
        B, S, D = x.shape
        H = 32
        Dh = D // H
        qkv = (lambda x, *d: x.permute(*d))((x @ wqkv).reshape(B, S, 3, H, Dh), 2, 0, 3, 1, 4)
        q, k, v = qkv[0], qkv[1], qkv[2]
        scores = torch.einsum("bhqd,bhkd->bhqk", q, k) * (Dh ** -0.5)
        p = _softmax(scores, axis=-1)
        o = torch.einsum("bhqk,bhkd->bhqd", p, v)
        return (lambda x, *d: x.permute(*d))(o, 0, 2, 1, 3).reshape(B, S, D) @ wo

    a = _A_ref(A_u, A_log_A_real, A_A_imag, A_C_real, A_C_imag, A_log_dt, A_D_skip)
    b = _B_ref(B_x, B_wqkv, B_wo)
    return torch.concatenate([a, b], axis=-1)
```

```asm
; @launch kernel=k1_kernel grid=(256,1,1) block=(512,1,1) lds=141952
; @launch kernel=k2_kernel grid=(400,1,1) block=(512,1,1) lds=73728
; @launch kernel=k3_kernel grid=(256,1,1) block=(512,1,1) lds=122880
.amdgcn_target "amdgcn-amd-amdhsa--gfx950"
.text
.globl k1_kernel
.p2align 8
.type k1_kernel,@function
k1_kernel:
    s_cmp_ge_u32 s2, 256
    s_cbranch_scc1 k1_exit
    s_cmp_ge_u32 s2, 8
    s_cbranch_scc1 cpf_1
    v_cmp_gt_u32 vcc, 64, v0
    s_nop 0
    s_and_saveexec_b64 s[86:87], vcc
    s_cbranch_execz cpf_1_x
    s_getpc_b64 s[84:85]
cpf_1_pc:
    s_add_u32 s84, s84, k1_role0-cpf_1_pc
    s_addc_u32 s85, s85, 0
    v_lshlrev_b32 v254, 7, v0
    global_load_dword v255, v254, s[84:85]
cpf_1_x:
    s_mov_b64 exec, -1
cpf_1:
    s_cmp_ge_u32 s2, 192
    s_cbranch_scc1 k1_role1
k1_role0:
    v_lshrrev_b32 v12, 6, v0
    v_and_b32 v1, 63, v0
    v_readfirstlane_b32 s16, v12
    s_nop 0
    s_cmp_ge_u32 s16, 4
    s_cbranch_scc1 g1_ld_6
    s_mov_b32 s17, s16
    s_load_dwordx2 s[38:39], s[0:1], 8
    s_load_dwordx2 s[40:41], s[0:1], 16
    s_load_dwordx2 s[42:43], s[0:1], 24
    s_load_dwordx2 s[44:45], s[0:1], 32
    s_load_dwordx2 s[46:47], s[0:1], 40
    s_lshr_b32 s27, s17, 1
    s_lshl_b32 s76, s2, 1
    s_add_u32 s76, s76, s27
    s_and_b32 s77, s17, 1
    s_mul_i32 s78, s17, 8704
    s_add_u32 s78, s78, 104448
    s_waitcnt lgkmcnt(0)
    s_lshl_b32 s80, s76, 8
    s_lshl_b32 s81, s77, 7
    v_lshlrev_b32 v130, 1, v1
    s_add_u32 s83, s80, s81
    v_add_u32 v131, s83, v130
    s_lshl_b32 s80, s76, 1
    v_mov_b32 v130, s80
    global_load_ushort v28, v131, s[38:39]
    global_load_ushort v29, v131, s[40:41]
    global_load_ushort v30, v131, s[42:43]
    global_load_ushort v32, v131, s[44:45]
    global_load_ushort v36, v130, s[46:47]
    s_load_dwordx2 s[34:35], s[0:1], 96
    s_barrier
    s_branch g1_comp_2
g1_ld_6:
    s_load_dwordx2 s[50:51], s[0:1], 56
    s_load_dwordx2 s[52:53], s[0:1], 64
    s_load_dwordx2 s[34:35], s[0:1], 96
    s_and_b32 s27, s2, 7
    s_lshr_b32 s28, s2, 3
    s_and_b32 s19, s27, 3
    s_lshl_b32 s19, s19, 2
    s_and_b32 s29, s28, 3
    s_add_u32 s19, s19, s29
    s_lshr_b32 s20, s27, 2
    s_mul_i32 s20, s20, 6
    s_lshr_b32 s29, s28, 2
    s_add_u32 s20, s20, s29
    s_lshr_b32 s21, s20, 2
    s_and_b32 s29, s28, 3
    s_mul_i32 s24, s29, 5
    s_lshr_b32 s29, s28, 2
    s_mul_i32 s29, s29, 20
    s_add_u32 s24, s24, s29
    s_mul_i32 s29, s27, 7
    s_add_u32 s24, s24, s29
    s_mul_i32 s29, s24, 3641
    s_lshr_b32 s29, s29, 16
    s_mul_i32 s29, s29, 18
    s_sub_u32 s24, s24, s29
    s_lshl_b32 s22, s24, 6
    s_mul_i32 s23, s24, 110592
    s_sub_u32 s18, s16, 4
    v_lshrrev_b32 v12, 2, v1
    v_and_b32 v13, 3, v1
    v_lshrrev_b32 v14, 2, v12
    v_and_b32 v14, 2, v14
    v_xor_b32 v13, v13, v14
    s_lshl_b32 s27, s19, 7
    s_lshl_b32 s28, s18, 5
    s_add_u32 s27, s27, s28
    v_add_u32 v12, s27, v12
    v_mul_u32_u24 v12, 1152, v12
    v_lshl_add_u32 v20, v13, 4, v12
    s_mul_i32 s28, s20, 288
    s_lshl_b32 s27, s18, 7
    v_add_u32 v12, s27, v1
    s_add_u32 s27, s27, 64
    v_mul_u32_u24 v13, 3641, v12
    v_lshrrev_b32 v13, 16, v13
    v_mul_u32_u24 v14, 18, v13
    v_sub_u32 v14, v12, v14
    v_and_b32 v15, 19, v13
    v_bfe_u32 v16, v13, 2, 1
    v_lshl_add_u32 v15, v16, 3, v15
    v_bfe_u32 v16, v13, 3, 1
    v_lshl_add_u32 v15, v16, 2, v15
    v_mul_u32_u24 v15, 3456, v15
    v_lshl_add_u32 v15, v14, 4, v15
    v_add_u32 v21, s28, v15
    v_add_u32 v12, s27, v1
    s_add_u32 s27, s27, 64
    v_mul_u32_u24 v13, 3641, v12
    v_lshrrev_b32 v13, 16, v13
    v_mul_u32_u24 v14, 18, v13
    v_sub_u32 v14, v12, v14
    v_and_b32 v15, 19, v13
    v_bfe_u32 v16, v13, 2, 1
    v_lshl_add_u32 v15, v16, 3, v15
    v_bfe_u32 v16, v13, 3, 1
    v_lshl_add_u32 v15, v16, 2, v15
    v_mul_u32_u24 v15, 3456, v15
    v_lshl_add_u32 v15, v14, 4, v15
    v_add_u32 v22, s28, v15
    v_add_u32 v12, 512, v1
    v_mul_u32_u24 v13, 3641, v12
    v_lshrrev_b32 v13, 16, v13
    v_mul_u32_u24 v14, 18, v13
    v_sub_u32 v14, v12, v14
    v_and_b32 v15, 19, v13
    v_bfe_u32 v16, v13, 2, 1
    v_lshl_add_u32 v15, v16, 3, v15
    v_bfe_u32 v16, v13, 3, 1
    v_lshl_add_u32 v15, v16, 2, v15
    v_mul_u32_u24 v15, 3456, v15
    v_lshl_add_u32 v15, v14, 4, v15
    v_add_u32 v23, s28, v15
    s_lshl_b32 s25, s18, 11
    s_add_u32 s26, s25, 8192
    s_waitcnt lgkmcnt(0)
    s_mov_b32 s4, s50
    s_mov_b32 s5, s51
    s_mov_b32 s6, 2359296
    s_mov_b32 s7, 0x20000
    s_mov_b32 s8, s52
    s_mov_b32 s9, s53
    s_mov_b32 s10, 1990656
    s_mov_b32 s11, 0x20000
    s_mov_b32 s12, s34
    s_mov_b32 s13, s35
    s_mov_b32 s14, 24117248
    s_mov_b32 s15, 0x20000
    s_barrier
    s_add_u32 m0, s25, 0
    s_add_u32 s33, s22, 0
    buffer_load_dwordx4 v20, s[4:7], s33 offen  lds
    s_add_u32 m0, s26, 0
    s_add_u32 s24, s24, 1
    buffer_load_dwordx4 v21, s[8:11], s23 offen  lds
    s_add_u32 m0, s25, 1024
    s_add_u32 s33, s22, 18432
    buffer_load_dwordx4 v20, s[4:7], s33 offen  lds
    s_add_u32 m0, s26, 1024
    s_cmp_eq_u32 s18, 0
    buffer_load_dwordx4 v22, s[8:11], s23 offen  lds
    s_mov_b32 m0, 16384
    s_cbranch_scc0 nox_7
    buffer_load_dwordx4 v23, s[8:11], s23 offen  lds
nox_7:
    s_add_u32 s22, s22, 64
    s_add_u32 s23, s23, 110592
    s_cmp_eq_u32 s24, 18
    s_cselect_b32 s24, 0, s24
    s_cselect_b32 s22, 0, s22
    s_cselect_b32 s23, 0, s23
    s_add_u32 m0, s25, 17408
    s_add_u32 s33, s22, 0
    buffer_load_dwordx4 v20, s[4:7], s33 offen  lds
    s_add_u32 m0, s26, 17408
    s_add_u32 s24, s24, 1
    buffer_load_dwordx4 v21, s[8:11], s23 offen  lds
    s_add_u32 m0, s25, 18432
    s_add_u32 s33, s22, 18432
    buffer_load_dwordx4 v20, s[4:7], s33 offen  lds
    s_add_u32 m0, s26, 18432
    s_cmp_eq_u32 s18, 1
    buffer_load_dwordx4 v22, s[8:11], s23 offen  lds
    s_mov_b32 m0, 33792
    s_cbranch_scc0 nox_8
    buffer_load_dwordx4 v23, s[8:11], s23 offen  lds
nox_8:
    s_add_u32 s22, s22, 64
    s_add_u32 s23, s23, 110592
    s_cmp_eq_u32 s24, 18
    s_cselect_b32 s24, 0, s24
    s_cselect_b32 s22, 0, s22
    s_cselect_b32 s23, 0, s23
    s_add_u32 m0, s25, 34816
    s_add_u32 s33, s22, 0
    buffer_load_dwordx4 v20, s[4:7], s33 offen  lds
    s_add_u32 m0, s26, 34816
    s_add_u32 s24, s24, 1
    buffer_load_dwordx4 v21, s[8:11], s23 offen  lds
    s_add_u32 m0, s25, 35840
    s_add_u32 s33, s22, 18432
    buffer_load_dwordx4 v20, s[4:7], s33 offen  lds
    s_add_u32 m0, s26, 35840
    s_cmp_eq_u32 s18, 2
    buffer_load_dwordx4 v22, s[8:11], s23 offen  lds
    s_mov_b32 m0, 51200
    s_cbranch_scc0 nox_9
    buffer_load_dwordx4 v23, s[8:11], s23 offen  lds
nox_9:
    s_add_u32 s22, s22, 64
    s_add_u32 s23, s23, 110592
    s_cmp_eq_u32 s24, 18
    s_cselect_b32 s24, 0, s24
    s_cselect_b32 s22, 0, s22
    s_cselect_b32 s23, 0, s23
    s_add_u32 m0, s25, 52224
    s_add_u32 s33, s22, 0
    buffer_load_dwordx4 v20, s[4:7], s33 offen  lds
    s_add_u32 m0, s26, 52224
    s_add_u32 s24, s24, 1
    buffer_load_dwordx4 v21, s[8:11], s23 offen  lds
    s_add_u32 m0, s25, 53248
    s_add_u32 s33, s22, 18432
    buffer_load_dwordx4 v20, s[4:7], s33 offen  lds
    s_add_u32 m0, s26, 53248
    s_cmp_eq_u32 s18, 3
    buffer_load_dwordx4 v22, s[8:11], s23 offen  lds
    s_mov_b32 m0, 68608
    s_cbranch_scc0 nox_10
    buffer_load_dwordx4 v23, s[8:11], s23 offen  lds
nox_10:
    s_add_u32 s22, s22, 64
    s_add_u32 s23, s23, 110592
    s_cmp_eq_u32 s24, 18
    s_cselect_b32 s24, 0, s24
    s_cselect_b32 s22, 0, s22
    s_cselect_b32 s23, 0, s23
    s_add_u32 m0, s25, 69632
    s_add_u32 s33, s22, 0
    buffer_load_dwordx4 v20, s[4:7], s33 offen  lds
    s_add_u32 m0, s26, 69632
    s_add_u32 s24, s24, 1
    buffer_load_dwordx4 v21, s[8:11], s23 offen  lds
    s_add_u32 m0, s25, 70656
    s_add_u32 s33, s22, 18432
    buffer_load_dwordx4 v20, s[4:7], s33 offen  lds
    s_add_u32 m0, s26, 70656
    s_cmp_eq_u32 s18, 0
    buffer_load_dwordx4 v22, s[8:11], s23 offen  lds
    s_mov_b32 m0, 86016
    s_cbranch_scc0 nox_11
    buffer_load_dwordx4 v23, s[8:11], s23 offen  lds
nox_11:
    s_add_u32 s22, s22, 64
    s_add_u32 s23, s23, 110592
    s_cmp_eq_u32 s24, 18
    s_cselect_b32 s24, 0, s24
    s_cselect_b32 s22, 0, s22
    s_cselect_b32 s23, 0, s23
    s_waitcnt vmcnt(16)
    s_barrier
    s_add_u32 m0, s25, 87040
    s_add_u32 s33, s22, 0
    buffer_load_dwordx4 v20, s[4:7], s33 offen  lds
    s_add_u32 m0, s26, 87040
    s_add_u32 s24, s24, 1
    buffer_load_dwordx4 v21, s[8:11], s23 offen  lds
    s_add_u32 m0, s25, 88064
    s_add_u32 s33, s22, 18432
    buffer_load_dwordx4 v20, s[4:7], s33 offen  lds
    s_add_u32 m0, s26, 88064
    s_cmp_eq_u32 s18, 1
    buffer_load_dwordx4 v22, s[8:11], s23 offen  lds
    s_mov_b32 m0, 103424
    s_cbranch_scc0 nox_12
    buffer_load_dwordx4 v23, s[8:11], s23 offen  lds
nox_12:
    s_add_u32 s22, s22, 64
    s_add_u32 s23, s23, 110592
    s_cmp_eq_u32 s24, 18
    s_cselect_b32 s24, 0, s24
    s_cselect_b32 s22, 0, s22
    s_cselect_b32 s23, 0, s23
    s_waitcnt vmcnt(16)
    s_barrier
    s_add_u32 m0, s25, 0
    s_add_u32 s33, s22, 0
    buffer_load_dwordx4 v20, s[4:7], s33 offen  lds
    s_add_u32 m0, s26, 0
    s_add_u32 s24, s24, 1
    buffer_load_dwordx4 v21, s[8:11], s23 offen  lds
    s_add_u32 m0, s25, 1024
    s_add_u32 s33, s22, 18432
    buffer_load_dwordx4 v20, s[4:7], s33 offen  lds
    s_add_u32 m0, s26, 1024
    s_cmp_eq_u32 s18, 2
    buffer_load_dwordx4 v22, s[8:11], s23 offen  lds
    s_mov_b32 m0, 16384
    s_cbranch_scc0 nox_13
    buffer_load_dwordx4 v23, s[8:11], s23 offen  lds
nox_13:
    s_add_u32 s22, s22, 64
    s_add_u32 s23, s23, 110592
    s_cmp_eq_u32 s24, 18
    s_cselect_b32 s24, 0, s24
    s_cselect_b32 s22, 0, s22
    s_cselect_b32 s23, 0, s23
    s_waitcnt vmcnt(16)
    s_barrier
    s_add_u32 m0, s25, 17408
    s_add_u32 s33, s22, 0
    buffer_load_dwordx4 v20, s[4:7], s33 offen  lds
    s_add_u32 m0, s26, 17408
    s_add_u32 s24, s24, 1
    buffer_load_dwordx4 v21, s[8:11], s23 offen  lds
    s_add_u32 m0, s25, 18432
    s_add_u32 s33, s22, 18432
    buffer_load_dwordx4 v20, s[4:7], s33 offen  lds
    s_add_u32 m0, s26, 18432
    s_cmp_eq_u32 s18, 3
    buffer_load_dwordx4 v22, s[8:11], s23 offen  lds
    s_mov_b32 m0, 33792
    s_cbranch_scc0 nox_14
    buffer_load_dwordx4 v23, s[8:11], s23 offen  lds
nox_14:
    s_add_u32 s22, s22, 64
    s_add_u32 s23, s23, 110592
    s_cmp_eq_u32 s24, 18
    s_cselect_b32 s24, 0, s24
    s_cselect_b32 s22, 0, s22
    s_cselect_b32 s23, 0, s23
    s_waitcnt vmcnt(16)
    s_barrier
    s_add_u32 m0, s25, 34816
    s_add_u32 s33, s22, 0
    buffer_load_dwordx4 v20, s[4:7], s33 offen  lds
    s_add_u32 m0, s26, 34816
    s_add_u32 s24, s24, 1
    buffer_load_dwordx4 v21, s[8:11], s23 offen  lds
    s_add_u32 m0, s25, 35840
    s_add_u32 s33, s22, 18432
    buffer_load_dwordx4 v20, s[4:7], s33 offen  lds
    s_add_u32 m0, s26, 35840
    s_cmp_eq_u32 s18, 0
    buffer_load_dwordx4 v22, s[8:11], s23 offen  lds
    s_mov_b32 m0, 51200
    s_cbranch_scc0 nox_15
    buffer_load_dwordx4 v23, s[8:11], s23 offen  lds
nox_15:
    s_add_u32 s22, s22, 64
    s_add_u32 s23, s23, 110592
    s_cmp_eq_u32 s24, 18
    s_cselect_b32 s24, 0, s24
    s_cselect_b32 s22, 0, s22
    s_cselect_b32 s23, 0, s23
    s_waitcnt vmcnt(16)
    s_barrier
    s_add_u32 m0, s25, 52224
    s_add_u32 s33, s22, 0
    buffer_load_dwordx4 v20, s[4:7], s33 offen  lds
    s_add_u32 m0, s26, 52224
    s_add_u32 s24, s24, 1
    buffer_load_dwordx4 v21, s[8:11], s23 offen  lds
    s_add_u32 m0, s25, 53248
    s_add_u32 s33, s22, 18432
    buffer_load_dwordx4 v20, s[4:7], s33 offen  lds
    s_add_u32 m0, s26, 53248
    s_cmp_eq_u32 s18, 1
    buffer_load_dwordx4 v22, s[8:11], s23 offen  lds
    s_mov_b32 m0, 68608
    s_cbranch_scc0 nox_16
    buffer_load_dwordx4 v23, s[8:11], s23 offen  lds
nox_16:
    s_add_u32 s22, s22, 64
    s_add_u32 s23, s23, 110592
    s_cmp_eq_u32 s24, 18
    s_cselect_b32 s24, 0, s24
    s_cselect_b32 s22, 0, s22
    s_cselect_b32 s23, 0, s23
    s_waitcnt vmcnt(16)
    s_barrier
    s_add_u32 m0, s25, 69632
    s_add_u32 s33, s22, 0
    buffer_load_dwordx4 v20, s[4:7], s33 offen  lds
    s_add_u32 m0, s26, 69632
    s_add_u32 s24, s24, 1
    buffer_load_dwordx4 v21, s[8:11], s23 offen  lds
    s_add_u32 m0, s25, 70656
    s_add_u32 s33, s22, 18432
    buffer_load_dwordx4 v20, s[4:7], s33 offen  lds
    s_add_u32 m0, s26, 70656
    s_cmp_eq_u32 s18, 2
    buffer_load_dwordx4 v22, s[8:11], s23 offen  lds
    s_mov_b32 m0, 86016
    s_cbranch_scc0 nox_17
    buffer_load_dwordx4 v23, s[8:11], s23 offen  lds
nox_17:
    s_add_u32 s22, s22, 64
    s_add_u32 s23, s23, 110592
    s_cmp_eq_u32 s24, 18
    s_cselect_b32 s24, 0, s24
    s_cselect_b32 s22, 0, s22
    s_cselect_b32 s23, 0, s23
    s_waitcnt vmcnt(16)
    s_barrier
    s_add_u32 m0, s25, 87040
    s_add_u32 s33, s22, 0
    buffer_load_dwordx4 v20, s[4:7], s33 offen  lds
    s_add_u32 m0, s26, 87040
    s_add_u32 s24, s24, 1
    buffer_load_dwordx4 v21, s[8:11], s23 offen  lds
    s_add_u32 m0, s25, 88064
    s_add_u32 s33, s22, 18432
    buffer_load_dwordx4 v20, s[4:7], s33 offen  lds
    s_add_u32 m0, s26, 88064
    s_cmp_eq_u32 s18, 3
    buffer_load_dwordx4 v22, s[8:11], s23 offen  lds
    s_mov_b32 m0, 103424
    s_cbranch_scc0 nox_18
    buffer_load_dwordx4 v23, s[8:11], s23 offen  lds
nox_18:
    s_add_u32 s22, s22, 64
    s_add_u32 s23, s23, 110592
    s_cmp_eq_u32 s24, 18
    s_cselect_b32 s24, 0, s24
    s_cselect_b32 s22, 0, s22
    s_cselect_b32 s23, 0, s23
    s_waitcnt vmcnt(16)
    s_barrier
    s_add_u32 m0, s25, 0
    s_add_u32 s33, s22, 0
    buffer_load_dwordx4 v20, s[4:7], s33 offen  lds
    s_add_u32 m0, s26, 0
    s_add_u32 s24, s24, 1
    buffer_load_dwordx4 v21, s[8:11], s23 offen  lds
    s_add_u32 m0, s25, 1024
    s_add_u32 s33, s22, 18432
    buffer_load_dwordx4 v20, s[4:7], s33 offen  lds
    s_add_u32 m0, s26, 1024
    s_cmp_eq_u32 s18, 0
    buffer_load_dwordx4 v22, s[8:11], s23 offen  lds
    s_mov_b32 m0, 16384
    s_cbranch_scc0 nox_19
    buffer_load_dwordx4 v23, s[8:11], s23 offen  lds
nox_19:
    s_add_u32 s22, s22, 64
    s_add_u32 s23, s23, 110592
    s_cmp_eq_u32 s24, 18
    s_cselect_b32 s24, 0, s24
    s_cselect_b32 s22, 0, s22
    s_cselect_b32 s23, 0, s23
    s_waitcnt vmcnt(16)
    s_barrier
    s_add_u32 m0, s25, 17408
    s_add_u32 s33, s22, 0
    buffer_load_dwordx4 v20, s[4:7], s33 offen  lds
    s_add_u32 m0, s26, 17408
    s_add_u32 s24, s24, 1
    buffer_load_dwordx4 v21, s[8:11], s23 offen  lds
    s_add_u32 m0, s25, 18432
    s_add_u32 s33, s22, 18432
    buffer_load_dwordx4 v20, s[4:7], s33 offen  lds
    s_add_u32 m0, s26, 18432
    s_cmp_eq_u32 s18, 1
    buffer_load_dwordx4 v22, s[8:11], s23 offen  lds
    s_mov_b32 m0, 33792
    s_cbranch_scc0 nox_20
    buffer_load_dwordx4 v23, s[8:11], s23 offen  lds
nox_20:
    s_add_u32 s22, s22, 64
    s_add_u32 s23, s23, 110592
    s_cmp_eq_u32 s24, 18
    s_cselect_b32 s24, 0, s24
    s_cselect_b32 s22, 0, s22
    s_cselect_b32 s23, 0, s23
    s_waitcnt vmcnt(16)
    s_barrier
    s_add_u32 m0, s25, 34816
    s_add_u32 s33, s22, 0
    buffer_load_dwordx4 v20, s[4:7], s33 offen  lds
    s_add_u32 m0, s26, 34816
    s_add_u32 s24, s24, 1
    buffer_load_dwordx4 v21, s[8:11], s23 offen  lds
    s_add_u32 m0, s25, 35840
    s_add_u32 s33, s22, 18432
    buffer_load_dwordx4 v20, s[4:7], s33 offen  lds
    s_add_u32 m0, s26, 35840
    s_cmp_eq_u32 s18, 2
    buffer_load_dwordx4 v22, s[8:11], s23 offen  lds
    s_mov_b32 m0, 51200
    s_cbranch_scc0 nox_21
    buffer_load_dwordx4 v23, s[8:11], s23 offen  lds
nox_21:
    s_add_u32 s22, s22, 64
    s_add_u32 s23, s23, 110592
    s_cmp_eq_u32 s24, 18
    s_cselect_b32 s24, 0, s24
    s_cselect_b32 s22, 0, s22
    s_cselect_b32 s23, 0, s23
    s_waitcnt vmcnt(16)
    s_barrier
    s_add_u32 m0, s25, 52224
    s_add_u32 s33, s22, 0
    buffer_load_dwordx4 v20, s[4:7], s33 offen  lds
    s_add_u32 m0, s26, 52224
    s_add_u32 s24, s24, 1
    buffer_load_dwordx4 v21, s[8:11], s23 offen  lds
    s_add_u32 m0, s25, 53248
    s_add_u32 s33, s22, 18432
    buffer_load_dwordx4 v20, s[4:7], s33 offen  lds
    s_add_u32 m0, s26, 53248
    s_cmp_eq_u32 s18, 3
    buffer_load_dwordx4 v22, s[8:11], s23 offen  lds
    s_mov_b32 m0, 68608
    s_cbranch_scc0 nox_22
    buffer_load_dwordx4 v23, s[8:11], s23 offen  lds
nox_22:
    s_add_u32 s22, s22, 64
    s_add_u32 s23, s23, 110592
    s_cmp_eq_u32 s24, 18
    s_cselect_b32 s24, 0, s24
    s_cselect_b32 s22, 0, s22
    s_cselect_b32 s23, 0, s23
    s_waitcnt vmcnt(16)
    s_barrier
    s_add_u32 m0, s25, 69632
    s_add_u32 s33, s22, 0
    buffer_load_dwordx4 v20, s[4:7], s33 offen  lds
    s_add_u32 m0, s26, 69632
    s_add_u32 s24, s24, 1
    buffer_load_dwordx4 v21, s[8:11], s23 offen  lds
    s_add_u32 m0, s25, 70656
    s_add_u32 s33, s22, 18432
    buffer_load_dwordx4 v20, s[4:7], s33 offen  lds
    s_add_u32 m0, s26, 70656
    s_cmp_eq_u32 s18, 0
    buffer_load_dwordx4 v22, s[8:11], s23 offen  lds
    s_mov_b32 m0, 86016
    s_cbranch_scc0 nox_23
    buffer_load_dwordx4 v23, s[8:11], s23 offen  lds
nox_23:
    s_add_u32 s22, s22, 64
    s_add_u32 s23, s23, 110592
    s_cmp_eq_u32 s24, 18
    s_cselect_b32 s24, 0, s24
    s_cselect_b32 s22, 0, s22
    s_cselect_b32 s23, 0, s23
    s_lshr_b32 s27, s18, 1
    s_lshl_b32 s76, s2, 1
    s_add_u32 s76, s76, s27
    s_and_b32 s77, s18, 1
    s_mul_i32 s78, s27, 17408
    s_add_u32 s78, s78, 104448
    s_mul_i32 s79, s27, 1344
    s_add_u32 s79, s79, 139264
    s_waitcnt vmcnt(16)
    s_barrier
    s_add_u32 m0, s25, 87040
    s_add_u32 s33, s22, 0
    buffer_load_dwordx4 v20, s[4:7], s33 offen  lds
    s_add_u32 m0, s26, 87040
    s_add_u32 s24, s24, 1
    buffer_load_dwordx4 v21, s[8:11], s23 offen  lds
    s_add_u32 m0, s25, 88064
    s_add_u32 s33, s22, 18432
    buffer_load_dwordx4 v20, s[4:7], s33 offen  lds
    s_add_u32 m0, s26, 88064
    s_cmp_eq_u32 s18, 1
    buffer_load_dwordx4 v22, s[8:11], s23 offen  lds
    s_mov_b32 m0, 103424
    s_cbranch_scc0 nox_24
    buffer_load_dwordx4 v23, s[8:11], s23 offen  lds
nox_24:
    s_add_u32 s22, s22, 64
    s_add_u32 s23, s23, 110592
    s_cmp_eq_u32 s24, 18
    s_cselect_b32 s24, 0, s24
    s_cselect_b32 s22, 0, s22
    s_cselect_b32 s23, 0, s23
    s_cmp_eq_u32 s77, 1
    s_cbranch_scc1 g1_fin_25
    v_lshlrev_b32 v132, 4, v1
    v_add_u32 v132, s78, v132
    v_mov_b32 v131, s78
    ds_read_b128 v[116:119], v132 offset:0
    ds_read_b128 v[120:123], v132 offset:1024
    ds_read_b128 v[124:127], v132 offset:2048
    ds_read_b128 v[100:103], v132 offset:8704
    ds_read_b128 v[104:107], v132 offset:9728
    ds_read_b128 v[108:111], v132 offset:10752
g1_fin_25:
    s_waitcnt vmcnt(16)
    s_barrier
    s_cmp_eq_u32 s77, 1
    s_cbranch_scc1 g1_fin_26
    v_and_b32 v84, 15, v1
    v_lshrrev_b32 v85, 4, v1
    v_lshrrev_b32 v86, 1, v85
    v_lshlrev_b32 v86, 7, v86
    v_and_b32 v87, 1, v85
    v_lshl_add_u32 v86, v87, 2, v86
    v_lshl_add_u32 v42, v84, 3, v86
    v_lshlrev_b32 v86, 6, v85
    v_lshl_add_u32 v87, v84, 1, v86
    v_add_u32 v45, v86, v84
    v_lshl_add_u32 v86, v84, 2, v86
    v_cmp_gt_u32 vcc, 2, v85
    s_nop 1
    v_cndmask_b32 v43, v87, v86, vcc
    v_add_u32 v43, 256, v43
    v_add_u32 v45, 512, v45
    v_mov_b32 v86, 64
    v_mov_b32 v87, 4
    v_cndmask_b32 v44, v86, v87, vcc
    v_lshlrev_b32 v42, 1, v42
    v_add_u32 v42, s79, v42
    v_lshlrev_b32 v43, 1, v43
    v_add_u32 v43, s79, v43
    v_lshlrev_b32 v45, 1, v45
    v_add_u32 v45, s79, v45
    v_add_u32 v44, v44, v43
g1_fin_26:
    s_waitcnt vmcnt(12)
    s_barrier
    s_cmp_eq_u32 s77, 1
    s_cbranch_scc1 g1_fin_27
    s_waitcnt lgkmcnt(0)
    v_add_f32 v116, v116, v100
    v_add_f32 v117, v117, v101
    v_add_f32 v118, v118, v102
    v_add_f32 v119, v119, v103
    v_add_f32 v120, v120, v104
    v_add_f32 v121, v121, v105
    v_add_f32 v122, v122, v106
    v_add_f32 v123, v123, v107
    v_add_f32 v124, v124, v108
    v_add_f32 v125, v125, v109
    v_add_f32 v126, v126, v110
    v_add_f32 v127, v127, v111
    v_cvt_pk_bf16_f32 v116, v116, v117
    v_cvt_pk_bf16_f32 v117, v118, v119
    v_cvt_pk_bf16_f32 v120, v120, v121
    v_cvt_pk_bf16_f32 v121, v122, v123
    v_cvt_pk_bf16_f32 v124, v124, v125
    v_cvt_pk_bf16_f32 v125, v126, v127
g1_fin_27:
    s_waitcnt vmcnt(8)
    s_barrier
    s_cmp_eq_u32 s77, 1
    s_cbranch_scc1 g1_fin_28
    ds_write_b16 v42, v116
    ds_write_b16_d16_hi v42, v116 offset:2
    ds_write_b16 v42, v117 offset:4
    ds_write_b16_d16_hi v42, v117 offset:6
    ds_write_b16 v43, v120
    ds_write_b16_d16_hi v43, v120 offset:2
    ds_write_b16 v44, v121
    ds_write_b16_d16_hi v44, v121 offset:2
    s_mov_b32 exec_hi, 0xffff
    ds_write_b16 v45, v124
    s_mov_b32 exec_hi, 0
    ds_write_b16_d16_hi v45, v124 offset:32
    ds_write_b16 v45, v125 offset:64
    ds_write_b16_d16_hi v45, v125 offset:96
    s_mov_b64 exec, -1
g1_fin_28:
    s_waitcnt vmcnt(4)
    s_barrier
    s_waitcnt vmcnt(0)
    s_barrier
    s_cmp_eq_u32 s77, 1
    s_cbranch_scc1 g1_fin_29
    s_waitcnt lgkmcnt(0)
    v_lshlrev_b32 v130, 4, v1
    v_add_u32 v131, s79, v130
    ds_read_b128 v[100:103], v131
    ds_read_b128 v[104:107], v131 offset:1024
    s_mul_i32 s80, s76, 1344
    s_add_u32 s80, s80, 11534336
    s_waitcnt lgkmcnt(0)
    buffer_store_dwordx4 v[100:103], v130, s[12:15], s80 offen sc1
    s_mov_b64 exec, 0xfffff
    buffer_store_dwordx4 v[104:107], v130, s[12:15], s80 offen offset:1024 sc1
    s_mov_b64 exec, -1
kg_t3_30:
g1_fin_29:
    s_cmp_eq_u32 s21, 2
    s_cbranch_scc1 v_epi_5
    s_branch qk_epi_4
g1_comp_2:
    s_and_b32 s27, s2, 7
    s_lshr_b32 s28, s2, 3
    s_and_b32 s19, s27, 3
    s_lshl_b32 s19, s19, 2
    s_and_b32 s29, s28, 3
    s_add_u32 s19, s19, s29
    s_lshr_b32 s20, s27, 2
    s_mul_i32 s20, s20, 6
    s_lshr_b32 s29, s28, 2
    s_add_u32 s20, s20, s29
    s_lshr_b32 s21, s20, 2
    v_lshrrev_b32 v2, 4, v1
    v_and_b32 v3, 15, v1
    v_lshrrev_b32 v12, 2, v3
    v_and_b32 v12, 2, v12
    v_xor_b32 v12, v12, v2
    v_lshlrev_b32 v12, 4, v12
    s_lshl_b32 s27, s17, 5
    v_add_u32 v13, s27, v3
    v_lshl_add_u32 v4, v13, 6, v12
    v_lshrrev_b32 v12, 1, v2
    v_lshlrev_b32 v12, 4, v12
    v_and_b32 v13, 1, v2
    v_lshl_add_u32 v12, v13, 2, v12
    v_lshrrev_b32 v13, 2, v3
    v_add_u32 v12, v12, v13
    v_mul_u32_u24 v12, 288, v12
    v_and_b32 v13, 3, v3
    v_lshl_add_u32 v7, v13, 3, v12
    v_add_u32 v5, 52224, v4
    v_add_u32 v8, 52224, v7
    v_add_u32 v6, 104448, v4
    v_add_u32 v9, 104448, v7
    s_waitcnt lgkmcnt(0)
    s_mov_b32 s12, s34
    s_mov_b32 s13, s35
    s_mov_b32 s14, 24117248
    s_mov_b32 s15, 0x20000
    s_waitcnt vmcnt(0)
    v_lshlrev_b32 v128, 2, v1
    v_and_b32 v130, 15, v1
    v_add_u32 v128, s78, v128
    v_mul_u32_u24 v129, 272, v130
    v_lshrrev_b32 v130, 4, v1
    v_lshlrev_b32 v36, 16, v36
    v_lshl_add_u32 v129, v130, 4, v129
    v_mul_f32 v36, 0x3fb8aa3b, v36
    v_add_u32 v129, s78, v129
    v_lshlrev_b32 v28, 16, v28
    v_add_u32 v133, 0, v128
    v_add_u32 v134, 1088, v128
    v_add_u32 v135, 2176, v128
    v_add_u32 v136, 3264, v128
    v_add_u32 v137, 4352, v128
    v_add_u32 v138, 5440, v128
    v_add_u32 v139, 6528, v128
    v_add_u32 v140, 7616, v128
    v_exp_f32 v36, v36
    v_mul_f32 v28, 0x3fb8aa3b, v28
    v_lshlrev_b32 v29, 16, v29
    v_exp_f32 v28, v28
    v_cvt_pk_bf16_f32 v36, v36, v36
    v_lshlrev_b32 v30, 16, v30
    v_lshlrev_b32 v32, 16, v32
    v_lshlrev_b32 v36, 16, v36
    v_cvt_pk_bf16_f32 v28, v28, v28
    v_mul_f32 v29, v29, v36
    v_lshlrev_b32 v28, 16, v28
    v_add_f32 v131, v36, v36
    v_mul_f32 v28, v28, v36
    v_mul_f32 v35, 0.15915494, v29
    v_mul_f32 v38, v30, v131
    v_mul_f32 v39, v32, v131
    v_mul_f32 v34, 0xbfb8aa3b, v28
    v_mul_f32 v68, 0x3f800000, v34
    v_mul_f32 v69, 0x3f800000, v35
    v_mul_f32 v70, 0x41000000, v34
    v_mul_f32 v71, 0x41000000, v35
    v_mul_f32 v72, 0x43000000, v34
    v_mul_f32 v73, 0x43000000, v35
    v_exp_f32 v68, v68
    v_fract_f32 v69, v69
    v_exp_f32 v70, v70
    v_fract_f32 v71, v71
    v_exp_f32 v72, v72
    v_fract_f32 v73, v73
    v_cos_f32 v42, v69
    v_sin_f32 v43, v69
    v_cos_f32 v44, v71
    v_sin_f32 v45, v71
    v_cos_f32 v46, v73
    v_sin_f32 v47, v73
    v_mul_f32 v42, v42, v68
    v_mul_f32 v43, v43, v68
    v_mul_f32 v44, v44, v70
    v_mul_f32 v45, v45, v70
    v_mul_f32 v46, v46, v72
    v_mul_f32 v47, v47, v72
    v_mov_b32 v68, 1.0
    v_mov_b32 v69, 0
    v_mov_b32 v52, v38
    v_mov_b32 v53, v39
    v_pk_mul_f32 v[76:77], v[44:45], v[44:45] op_sel_hi:[1,0]
    v_pk_mul_f32 v[78:79], v[52:53], v[42:43] op_sel_hi:[1,0]
    v_pk_fma_f32 v[48:49], v[44:45], v[44:45], v[76:77] op_sel:[1,1,0] op_sel_hi:[0,1,1] neg_lo:[1,0,0]
    v_pk_fma_f32 v[54:55], v[52:53], v[42:43], v[78:79] op_sel:[1,1,0] op_sel_hi:[0,1,1] neg_lo:[1,0,0]
    v_cvt_pk_bf16_f32 v80, v68, -v69
    v_cvt_pk_bf16_f32 v81, v44, -v45
    ds_write2_b32 v133, v80, v81 offset0:0 offset1:68
    v_mov_b32 v68, v48
    v_mov_b32 v69, v49
    v_pk_mul_f32 v[76:77], v[44:45], v[48:49] op_sel_hi:[1,0]
    v_pk_mul_f32 v[78:79], v[54:55], v[42:43] op_sel_hi:[1,0]
    v_pk_fma_f32 v[70:71], v[44:45], v[48:49], v[76:77] op_sel:[1,1,0] op_sel_hi:[0,1,1] neg_lo:[1,0,0]
    v_pk_fma_f32 v[56:57], v[54:55], v[42:43], v[78:79] op_sel:[1,1,0] op_sel_hi:[0,1,1] neg_lo:[1,0,0]
    v_cvt_pk_bf16_f32 v82, v68, -v69
    v_cvt_pk_bf16_f32 v83, v70, -v71
    ds_write2_b32 v133, v82, v83 offset0:136 offset1:204
    v_pk_mul_f32 v[76:77], v[68:69], v[48:49] op_sel_hi:[1,0]
    v_pk_mul_f32 v[78:79], v[70:71], v[48:49] op_sel_hi:[1,0]
    v_pk_fma_f32 v[72:73], v[68:69], v[48:49], v[76:77] op_sel:[1,1,0] op_sel_hi:[0,1,1] neg_lo:[1,0,0]
    v_pk_fma_f32 v[74:75], v[70:71], v[48:49], v[78:79] op_sel:[1,1,0] op_sel_hi:[0,1,1] neg_lo:[1,0,0]
    v_cvt_pk_bf16_f32 v80, v72, -v73
    v_cvt_pk_bf16_f32 v81, v74, -v75
    ds_write2_b32 v134, v80, v81 offset0:0 offset1:68
    v_pk_mul_f32 v[76:77], v[72:73], v[48:49] op_sel_hi:[1,0]
    v_pk_mul_f32 v[78:79], v[74:75], v[48:49] op_sel_hi:[1,0]
    v_pk_fma_f32 v[68:69], v[72:73], v[48:49], v[76:77] op_sel:[1,1,0] op_sel_hi:[0,1,1] neg_lo:[1,0,0]
    v_pk_fma_f32 v[70:71], v[74:75], v[48:49], v[78:79] op_sel:[1,1,0] op_sel_hi:[0,1,1] neg_lo:[1,0,0]
    v_cvt_pk_bf16_f32 v82, v68, -v69
    v_cvt_pk_bf16_f32 v83, v70, -v71
    ds_write2_b32 v134, v82, v83 offset0:136 offset1:204
    v_pk_mul_f32 v[76:77], v[68:69], v[48:49] op_sel_hi:[1,0]
    v_pk_mul_f32 v[78:79], v[70:71], v[48:49] op_sel_hi:[1,0]
    v_pk_fma_f32 v[72:73], v[68:69], v[48:49], v[76:77] op_sel:[1,1,0] op_sel_hi:[0,1,1] neg_lo:[1,0,0]
    v_pk_fma_f32 v[74:75], v[70:71], v[48:49], v[78:79] op_sel:[1,1,0] op_sel_hi:[0,1,1] neg_lo:[1,0,0]
    v_cvt_pk_bf16_f32 v80, v72, -v73
    v_cvt_pk_bf16_f32 v81, v74, -v75
    ds_write2_b32 v135, v80, v81 offset0:0 offset1:68
    v_pk_mul_f32 v[76:77], v[72:73], v[48:49] op_sel_hi:[1,0]
    v_pk_mul_f32 v[78:79], v[74:75], v[48:49] op_sel_hi:[1,0]
    v_pk_fma_f32 v[68:69], v[72:73], v[48:49], v[76:77] op_sel:[1,1,0] op_sel_hi:[0,1,1] neg_lo:[1,0,0]
    v_pk_fma_f32 v[70:71], v[74:75], v[48:49], v[78:79] op_sel:[1,1,0] op_sel_hi:[0,1,1] neg_lo:[1,0,0]
    v_cvt_pk_bf16_f32 v82, v68, -v69
    v_cvt_pk_bf16_f32 v83, v70, -v71
    ds_write2_b32 v135, v82, v83 offset0:136 offset1:204
    v_pk_mul_f32 v[76:77], v[68:69], v[48:49] op_sel_hi:[1,0]
    v_pk_mul_f32 v[78:79], v[70:71], v[48:49] op_sel_hi:[1,0]
    v_pk_fma_f32 v[72:73], v[68:69], v[48:49], v[76:77] op_sel:[1,1,0] op_sel_hi:[0,1,1] neg_lo:[1,0,0]
    v_pk_fma_f32 v[74:75], v[70:71], v[48:49], v[78:79] op_sel:[1,1,0] op_sel_hi:[0,1,1] neg_lo:[1,0,0]
    v_cvt_pk_bf16_f32 v80, v72, -v73
    v_cvt_pk_bf16_f32 v81, v74, -v75
    ds_write2_b32 v136, v80, v81 offset0:0 offset1:68
    v_pk_mul_f32 v[76:77], v[72:73], v[48:49] op_sel_hi:[1,0]
    v_pk_mul_f32 v[78:79], v[74:75], v[48:49] op_sel_hi:[1,0]
    v_pk_fma_f32 v[68:69], v[72:73], v[48:49], v[76:77] op_sel:[1,1,0] op_sel_hi:[0,1,1] neg_lo:[1,0,0]
    v_pk_fma_f32 v[70:71], v[74:75], v[48:49], v[78:79] op_sel:[1,1,0] op_sel_hi:[0,1,1] neg_lo:[1,0,0]
    v_cvt_pk_bf16_f32 v82, v68, -v69
    v_cvt_pk_bf16_f32 v83, v70, -v71
    ds_write2_b32 v136, v82, v83 offset0:136 offset1:204
    ds_read_b128 v[84:87], v129 offset:0
    ds_read_b128 v[88:91], v129 offset:64
    ds_read_b128 v[92:95], v129 offset:128
    ds_read_b128 v[96:99], v129 offset:192
    v_pk_mul_f32 v[76:77], v[56:57], v[42:43] op_sel_hi:[1,0]
    v_pk_mul_f32 v[78:79], v[46:47], v[46:47] op_sel_hi:[1,0]
    v_pk_fma_f32 v[58:59], v[56:57], v[42:43], v[76:77] op_sel:[1,1,0] op_sel_hi:[0,1,1] neg_lo:[1,0,0]
    v_pk_fma_f32 v[48:49], v[46:47], v[46:47], v[78:79] op_sel:[1,1,0] op_sel_hi:[0,1,1] neg_lo:[1,0,0]
    v_pk_mul_f32 v[76:77], v[58:59], v[42:43] op_sel_hi:[1,0]
    v_pk_mul_f32 v[78:79], v[48:49], v[46:47] op_sel_hi:[1,0]
    v_pk_fma_f32 v[60:61], v[58:59], v[42:43], v[76:77] op_sel:[1,1,0] op_sel_hi:[0,1,1] neg_lo:[1,0,0]
    v_pk_fma_f32 v[50:51], v[48:49], v[46:47], v[78:79] op_sel:[1,1,0] op_sel_hi:[0,1,1] neg_lo:[1,0,0]
    v_pk_mul_f32 v[76:77], v[60:61], v[42:43] op_sel_hi:[1,0]
    v_pk_mul_f32 v[78:79], v[52:53], v[46:47] op_sel_hi:[1,0]
    v_pk_fma_f32 v[62:63], v[60:61], v[42:43], v[76:77] op_sel:[1,1,0] op_sel_hi:[0,1,1] neg_lo:[1,0,0]
    v_pk_fma_f32 v[68:69], v[52:53], v[46:47], v[78:79] op_sel:[1,1,0] op_sel_hi:[0,1,1] neg_lo:[1,0,0]
    v_pk_mul_f32 v[76:77], v[62:63], v[42:43] op_sel_hi:[1,0]
    v_pk_mul_f32 v[78:79], v[54:55], v[46:47] op_sel_hi:[1,0]
    v_pk_fma_f32 v[64:65], v[62:63], v[42:43], v[76:77] op_sel:[1,1,0] op_sel_hi:[0,1,1] neg_lo:[1,0,0]
    v_pk_fma_f32 v[70:71], v[54:55], v[46:47], v[78:79] op_sel:[1,1,0] op_sel_hi:[0,1,1] neg_lo:[1,0,0]
    v_cvt_pk_bf16_f32 v80, v52, v53
    v_cvt_pk_bf16_f32 v81, v54, v55
    ds_write2_b32 v137, v80, v81 offset0:0 offset1:68
    v_cvt_pk_bf16_f32 v82, v56, v57
    v_cvt_pk_bf16_f32 v83, v58, v59
    ds_write2_b32 v137, v82, v83 offset0:136 offset1:204
    v_cvt_pk_bf16_f32 v80, v68, v69
    v_cvt_pk_bf16_f32 v81, v70, v71
    ds_write2_b32 v139, v80, v81 offset0:0 offset1:68
    v_pk_mul_f32 v[76:77], v[64:65], v[42:43] op_sel_hi:[1,0]
    v_pk_mul_f32 v[78:79], v[56:57], v[46:47] op_sel_hi:[1,0]
    v_pk_fma_f32 v[66:67], v[64:65], v[42:43], v[76:77] op_sel:[1,1,0] op_sel_hi:[0,1,1] neg_lo:[1,0,0]
    v_pk_fma_f32 v[72:73], v[56:57], v[46:47], v[78:79] op_sel:[1,1,0] op_sel_hi:[0,1,1] neg_lo:[1,0,0]
    v_cvt_pk_bf16_f32 v82, v60, v61
    v_cvt_pk_bf16_f32 v83, v62, v63
    ds_write2_b32 v138, v82, v83 offset0:0 offset1:68
    v_cvt_pk_bf16_f32 v80, v64, v65
    v_cvt_pk_bf16_f32 v81, v66, v67
    ds_write2_b32 v138, v80, v81 offset0:136 offset1:204
    v_pk_mul_f32 v[76:77], v[58:59], v[46:47] op_sel_hi:[1,0]
    v_pk_mul_f32 v[78:79], v[60:61], v[46:47] op_sel_hi:[1,0]
    v_pk_fma_f32 v[74:75], v[58:59], v[46:47], v[76:77] op_sel:[1,1,0] op_sel_hi:[0,1,1] neg_lo:[1,0,0]
    v_pk_fma_f32 v[68:69], v[60:61], v[46:47], v[78:79] op_sel:[1,1,0] op_sel_hi:[0,1,1] neg_lo:[1,0,0]
    v_cvt_pk_bf16_f32 v82, v72, v73
    v_cvt_pk_bf16_f32 v83, v74, v75
    ds_write2_b32 v139, v82, v83 offset0:136 offset1:204
    v_pk_mul_f32 v[76:77], v[62:63], v[46:47] op_sel_hi:[1,0]
    v_pk_mul_f32 v[78:79], v[64:65], v[46:47] op_sel_hi:[1,0]
    v_pk_fma_f32 v[70:71], v[62:63], v[46:47], v[76:77] op_sel:[1,1,0] op_sel_hi:[0,1,1] neg_lo:[1,0,0]
    v_pk_fma_f32 v[72:73], v[64:65], v[46:47], v[78:79] op_sel:[1,1,0] op_sel_hi:[0,1,1] neg_lo:[1,0,0]
    v_cvt_pk_bf16_f32 v80, v68, v69
    v_cvt_pk_bf16_f32 v81, v70, v71
    ds_write2_b32 v140, v80, v81 offset0:0 offset1:68
    v_pk_mul_f32 v[76:77], v[66:67], v[46:47] op_sel_hi:[1,0]
    v_pk_mul_f32 v[78:79], v[52:53], v[48:49] op_sel_hi:[1,0]
    v_pk_fma_f32 v[74:75], v[66:67], v[46:47], v[76:77] op_sel:[1,1,0] op_sel_hi:[0,1,1] neg_lo:[1,0,0]
    v_pk_fma_f32 v[68:69], v[52:53], v[48:49], v[78:79] op_sel:[1,1,0] op_sel_hi:[0,1,1] neg_lo:[1,0,0]
    v_cvt_pk_bf16_f32 v82, v72, v73
    v_cvt_pk_bf16_f32 v83, v74, v75
    ds_write2_b32 v140, v82, v83 offset0:136 offset1:204
    ds_read_b128 v[100:103], v129 offset:4352
    ds_read_b128 v[104:107], v129 offset:4416
    ds_read_b128 v[108:111], v129 offset:4480
    ds_read_b128 v[112:115], v129 offset:4544
    v_pk_mul_f32 v[76:77], v[56:57], v[48:49] op_sel_hi:[1,0]
    v_pk_mul_f32 v[78:79], v[60:61], v[48:49] op_sel_hi:[1,0]
    v_pk_fma_f32 v[70:71], v[56:57], v[48:49], v[76:77] op_sel:[1,1,0] op_sel_hi:[0,1,1] neg_lo:[1,0,0]
    v_pk_fma_f32 v[72:73], v[60:61], v[48:49], v[78:79] op_sel:[1,1,0] op_sel_hi:[0,1,1] neg_lo:[1,0,0]
    v_cvt_pk_bf16_f32 v80, v68, v69
    v_cvt_pk_bf16_f32 v81, v70, v71
    ds_write2_b32 v137, v80, v81 offset0:0 offset1:68
    v_pk_mul_f32 v[76:77], v[64:65], v[48:49] op_sel_hi:[1,0]
    v_pk_mul_f32 v[78:79], v[52:53], v[50:51] op_sel_hi:[1,0]
    v_pk_fma_f32 v[74:75], v[64:65], v[48:49], v[76:77] op_sel:[1,1,0] op_sel_hi:[0,1,1] neg_lo:[1,0,0]
    v_pk_fma_f32 v[68:69], v[52:53], v[50:51], v[78:79] op_sel:[1,1,0] op_sel_hi:[0,1,1] neg_lo:[1,0,0]
    v_cvt_pk_bf16_f32 v82, v72, v73
    v_cvt_pk_bf16_f32 v83, v74, v75
    ds_write2_b32 v137, v82, v83 offset0:136 offset1:204
    s_waitcnt lgkmcnt(0)
    v_mfma_f32_16x16x32_bf16 v[116:119], v[100:103], v[84:87], 0
    v_mfma_f32_16x16x32_bf16 v[116:119], v[104:107], v[88:91], v[116:119]
    v_mfma_f32_16x16x32_bf16 v[116:119], v[108:111], v[92:95], v[116:119]
    v_mfma_f32_16x16x32_bf16 v[116:119], v[112:115], v[96:99], v[116:119]
    v_pk_mul_f32 v[76:77], v[56:57], v[50:51] op_sel_hi:[1,0]
    v_pk_mul_f32 v[78:79], v[60:61], v[50:51] op_sel_hi:[1,0]
    v_pk_fma_f32 v[70:71], v[56:57], v[50:51], v[76:77] op_sel:[1,1,0] op_sel_hi:[0,1,1] neg_lo:[1,0,0]
    v_pk_fma_f32 v[72:73], v[60:61], v[50:51], v[78:79] op_sel:[1,1,0] op_sel_hi:[0,1,1] neg_lo:[1,0,0]
    v_cvt_pk_bf16_f32 v80, v68, v69
    v_cvt_pk_bf16_f32 v81, v70, v71
    ds_write2_b32 v138, v80, v81 offset0:0 offset1:68
    v_pk_mul_f32 v[76:77], v[64:65], v[50:51] op_sel_hi:[1,0]
    v_pk_mul_f32 v[78:79], v[50:51], v[46:47] op_sel_hi:[1,0]
    v_pk_fma_f32 v[74:75], v[64:65], v[50:51], v[76:77] op_sel:[1,1,0] op_sel_hi:[0,1,1] neg_lo:[1,0,0]
    v_pk_fma_f32 v[48:49], v[50:51], v[46:47], v[78:79] op_sel:[1,1,0] op_sel_hi:[0,1,1] neg_lo:[1,0,0]
    v_cvt_pk_bf16_f32 v82, v72, v73
    v_cvt_pk_bf16_f32 v83, v74, v75
    ds_write2_b32 v138, v82, v83 offset0:136 offset1:204
    v_pk_mul_f32 v[76:77], v[52:53], v[48:49] op_sel_hi:[1,0]
    v_pk_mul_f32 v[78:79], v[60:61], v[48:49] op_sel_hi:[1,0]
    v_pk_fma_f32 v[68:69], v[52:53], v[48:49], v[76:77] op_sel:[1,1,0] op_sel_hi:[0,1,1] neg_lo:[1,0,0]
    v_pk_fma_f32 v[70:71], v[60:61], v[48:49], v[78:79] op_sel:[1,1,0] op_sel_hi:[0,1,1] neg_lo:[1,0,0]
    v_pk_mul_f32 v[76:77], v[48:49], v[46:47] op_sel_hi:[1,0]
    v_pk_fma_f32 v[50:51], v[48:49], v[46:47], v[76:77] op_sel:[1,1,0] op_sel_hi:[0,1,1] neg_lo:[1,0,0]
    v_cvt_pk_bf16_f32 v80, v68, v69
    v_cvt_pk_bf16_f32 v81, v70, v71
    ds_write2_b32 v139, v80, v81 offset0:0 offset1:68
    v_pk_mul_f32 v[76:77], v[52:53], v[50:51] op_sel_hi:[1,0]
    v_pk_mul_f32 v[78:79], v[60:61], v[50:51] op_sel_hi:[1,0]
    v_pk_fma_f32 v[68:69], v[52:53], v[50:51], v[76:77] op_sel:[1,1,0] op_sel_hi:[0,1,1] neg_lo:[1,0,0]
    v_pk_fma_f32 v[70:71], v[60:61], v[50:51], v[78:79] op_sel:[1,1,0] op_sel_hi:[0,1,1] neg_lo:[1,0,0]
    v_pk_mul_f32 v[76:77], v[50:51], v[46:47] op_sel_hi:[1,0]
    v_pk_fma_f32 v[48:49], v[50:51], v[46:47], v[76:77] op_sel:[1,1,0] op_sel_hi:[0,1,1] neg_lo:[1,0,0]
    v_cvt_pk_bf16_f32 v82, v68, v69
    v_cvt_pk_bf16_f32 v83, v70, v71
    ds_write2_b32 v139, v82, v83 offset0:136 offset1:204
    v_pk_mul_f32 v[76:77], v[52:53], v[48:49] op_sel_hi:[1,0]
    v_pk_mul_f32 v[78:79], v[60:61], v[48:49] op_sel_hi:[1,0]
    v_pk_fma_f32 v[68:69], v[52:53], v[48:49], v[76:77] op_sel:[1,1,0] op_sel_hi:[0,1,1] neg_lo:[1,0,0]
    v_pk_fma_f32 v[70:71], v[60:61], v[48:49], v[78:79] op_sel:[1,1,0] op_sel_hi:[0,1,1] neg_lo:[1,0,0]
    v_pk_mul_f32 v[76:77], v[48:49], v[46:47] op_sel_hi:[1,0]
    v_pk_fma_f32 v[50:51], v[48:49], v[46:47], v[76:77] op_sel:[1,1,0] op_sel_hi:[0,1,1] neg_lo:[1,0,0]
    v_cvt_pk_bf16_f32 v80, v68, v69
    v_cvt_pk_bf16_f32 v81, v70, v71
    ds_write2_b32 v140, v80, v81 offset0:0 offset1:68
    v_pk_mul_f32 v[76:77], v[52:53], v[50:51] op_sel_hi:[1,0]
    v_pk_mul_f32 v[78:79], v[60:61], v[50:51] op_sel_hi:[1,0]
    v_pk_fma_f32 v[68:69], v[52:53], v[50:51], v[76:77] op_sel:[1,1,0] op_sel_hi:[0,1,1] neg_lo:[1,0,0]
    v_pk_fma_f32 v[70:71], v[60:61], v[50:51], v[78:79] op_sel:[1,1,0] op_sel_hi:[0,1,1] neg_lo:[1,0,0]
    v_pk_mul_f32 v[76:77], v[50:51], v[46:47] op_sel_hi:[1,0]
    v_pk_fma_f32 v[48:49], v[50:51], v[46:47], v[76:77] op_sel:[1,1,0] op_sel_hi:[0,1,1] neg_lo:[1,0,0]
    v_cvt_pk_bf16_f32 v82, v68, v69
    v_cvt_pk_bf16_f32 v83, v70, v71
    ds_write2_b32 v140, v82, v83 offset0:136 offset1:204
    ds_read_b128 v[100:103], v129 offset:4352
    ds_read_b128 v[104:107], v129 offset:4416
    ds_read_b128 v[108:111], v129 offset:4480
    ds_read_b128 v[112:115], v129 offset:4544
    v_pk_mul_f32 v[76:77], v[52:53], v[48:49] op_sel_hi:[1,0]
    v_pk_mul_f32 v[78:79], v[48:49], v[46:47] op_sel_hi:[1,0]
    v_pk_fma_f32 v[68:69], v[52:53], v[48:49], v[76:77] op_sel:[1,1,0] op_sel_hi:[0,1,1] neg_lo:[1,0,0]
    v_pk_fma_f32 v[50:51], v[48:49], v[46:47], v[78:79] op_sel:[1,1,0] op_sel_hi:[0,1,1] neg_lo:[1,0,0]
    v_pk_mul_f32 v[76:77], v[52:53], v[50:51] op_sel_hi:[1,0]
    v_pk_mul_f32 v[78:79], v[50:51], v[46:47] op_sel_hi:[1,0]
    v_pk_fma_f32 v[70:71], v[52:53], v[50:51], v[76:77] op_sel:[1,1,0] op_sel_hi:[0,1,1] neg_lo:[1,0,0]
    v_pk_fma_f32 v[48:49], v[50:51], v[46:47], v[78:79] op_sel:[1,1,0] op_sel_hi:[0,1,1] neg_lo:[1,0,0]
    v_cvt_pk_bf16_f32 v80, v68, v69
    v_cvt_pk_bf16_f32 v81, v70, v71
    ds_write2_b32 v137, v80, v81 offset0:0 offset1:68
    s_waitcnt lgkmcnt(0)
    v_mfma_f32_16x16x32_bf16 v[120:123], v[100:103], v[84:87], 0
    v_mfma_f32_16x16x32_bf16 v[120:123], v[104:107], v[88:91], v[120:123]
    v_mfma_f32_16x16x32_bf16 v[120:123], v[108:111], v[92:95], v[120:123]
    v_mfma_f32_16x16x32_bf16 v[120:123], v[112:115], v[96:99], v[120:123]
    v_pk_mul_f32 v[76:77], v[52:53], v[48:49] op_sel_hi:[1,0]
    v_pk_mul_f32 v[78:79], v[48:49], v[46:47] op_sel_hi:[1,0]
    v_pk_fma_f32 v[68:69], v[52:53], v[48:49], v[76:77] op_sel:[1,1,0] op_sel_hi:[0,1,1] neg_lo:[1,0,0]
    v_pk_fma_f32 v[50:51], v[48:49], v[46:47], v[78:79] op_sel:[1,1,0] op_sel_hi:[0,1,1] neg_lo:[1,0,0]
    v_pk_mul_f32 v[76:77], v[52:53], v[50:51] op_sel_hi:[1,0]
    v_pk_mul_f32 v[78:79], v[50:51], v[46:47] op_sel_hi:[1,0]
    v_pk_fma_f32 v[70:71], v[52:53], v[50:51], v[76:77] op_sel:[1,1,0] op_sel_hi:[0,1,1] neg_lo:[1,0,0]
    v_pk_fma_f32 v[48:49], v[50:51], v[46:47], v[78:79] op_sel:[1,1,0] op_sel_hi:[0,1,1] neg_lo:[1,0,0]
    v_cvt_pk_bf16_f32 v82, v68, v69
    v_cvt_pk_bf16_f32 v83, v70, v71
    ds_write2_b32 v137, v82, v83 offset0:136 offset1:204
    v_pk_mul_f32 v[76:77], v[52:53], v[48:49] op_sel_hi:[1,0]
    v_pk_mul_f32 v[78:79], v[48:49], v[46:47] op_sel_hi:[1,0]
    v_pk_fma_f32 v[68:69], v[52:53], v[48:49], v[76:77] op_sel:[1,1,0] op_sel_hi:[0,1,1] neg_lo:[1,0,0]
    v_pk_fma_f32 v[50:51], v[48:49], v[46:47], v[78:79] op_sel:[1,1,0] op_sel_hi:[0,1,1] neg_lo:[1,0,0]
    v_pk_mul_f32 v[76:77], v[52:53], v[50:51] op_sel_hi:[1,0]
    v_pk_mul_f32 v[78:79], v[50:51], v[46:47] op_sel_hi:[1,0]
    v_pk_fma_f32 v[70:71], v[52:53], v[50:51], v[76:77] op_sel:[1,1,0] op_sel_hi:[0,1,1] neg_lo:[1,0,0]
    v_pk_fma_f32 v[48:49], v[50:51], v[46:47], v[78:79] op_sel:[1,1,0] op_sel_hi:[0,1,1] neg_lo:[1,0,0]
    v_cvt_pk_bf16_f32 v80, v68, v69
    v_cvt_pk_bf16_f32 v81, v70, v71
    ds_write2_b32 v138, v80, v81 offset0:0 offset1:68
    v_pk_mul_f32 v[76:77], v[52:53], v[48:49] op_sel_hi:[1,0]
    v_pk_mul_f32 v[78:79], v[48:49], v[46:47] op_sel_hi:[1,0]
    v_pk_fma_f32 v[68:69], v[52:53], v[48:49], v[76:77] op_sel:[1,1,0] op_sel_hi:[0,1,1] neg_lo:[1,0,0]
    v_pk_fma_f32 v[50:51], v[48:49], v[46:47], v[78:79] op_sel:[1,1,0] op_sel_hi:[0,1,1] neg_lo:[1,0,0]
    v_pk_mul_f32 v[76:77], v[52:53], v[50:51] op_sel_hi:[1,0]
    v_pk_mul_f32 v[78:79], v[50:51], v[46:47] op_sel_hi:[1,0]
    v_pk_fma_f32 v[70:71], v[52:53], v[50:51], v[76:77] op_sel:[1,1,0] op_sel_hi:[0,1,1] neg_lo:[1,0,0]
    v_pk_fma_f32 v[48:49], v[50:51], v[46:47], v[78:79] op_sel:[1,1,0] op_sel_hi:[0,1,1] neg_lo:[1,0,0]
    v_cvt_pk_bf16_f32 v82, v68, v69
    v_cvt_pk_bf16_f32 v83, v70, v71
    ds_write2_b32 v138, v82, v83 offset0:136 offset1:204
    v_pk_mul_f32 v[76:77], v[52:53], v[48:49] op_sel_hi:[1,0]
    v_pk_fma_f32 v[68:69], v[52:53], v[48:49], v[76:77] op_sel:[1,1,0] op_sel_hi:[0,1,1] neg_lo:[1,0,0]
    v_cvt_pk_bf16_f32 v80, v68, v69
    ds_write_b32 v128, v80 offset:6528
    ds_read_b128 v[100:103], v129 offset:4352
    ds_read_b128 v[104:107], v129 offset:4416
    ds_read_b128 v[108:111], v129 offset:4480
    ds_read_b128 v[112:115], v129 offset:4544
    s_waitcnt lgkmcnt(0)
    v_mfma_f32_16x16x32_bf16 v[124:127], v[100:103], v[84:87], 0
    v_mfma_f32_16x16x32_bf16 v[124:127], v[104:107], v[88:91], v[124:127]
    v_mfma_f32_16x16x32_bf16 v[124:127], v[108:111], v[92:95], v[124:127]
    v_mfma_f32_16x16x32_bf16 v[124:127], v[112:115], v[96:99], v[124:127]
    v_lshlrev_b32 v132, 4, v1
    v_add_u32 v132, s78, v132
    ds_write_b128 v132, v[116:119] offset:0
    ds_write_b128 v132, v[120:123] offset:1024
    s_nop 3
    ds_write_b128 v132, v[124:127] offset:2048
    s_cmp_eq_u32 s21, 2
    s_cbranch_scc1 qkv_v_31
    s_lshl_b32 s27, s17, 5
    v_add_u32 v12, s27, v3
    v_mul_u32_u24 v12, 296, v12
    v_lshl_add_u32 v10, v2, 3, v12
    v_add_u32 v10, 0, v10
    s_barrier
    ds_read_b128 v[92:95], v4 offset:0
    ds_read_b128 v[96:99], v4 offset:1024
    ds_read_b64_tr_b16 v[100:101], v7 offset:8192
    ds_read_b64_tr_b16 v[102:103], v7 offset:10496
    ds_read_b64_tr_b16 v[104:105], v7 offset:8224
    ds_read_b64_tr_b16 v[106:107], v7 offset:10528
    ds_read_b64_tr_b16 v[108:109], v7 offset:8256
    ds_read_b64_tr_b16 v[110:111], v7 offset:10560
    ds_read_b64_tr_b16 v[112:113], v7 offset:8288
    ds_read_b64_tr_b16 v[114:115], v7 offset:10592
    ds_read_b64_tr_b16 v[116:117], v7 offset:8320
    ds_read_b64_tr_b16 v[118:119], v7 offset:10624
    ds_read_b64_tr_b16 v[120:121], v7 offset:8352
    ds_read_b64_tr_b16 v[122:123], v7 offset:10656
    ds_read_b64_tr_b16 v[124:125], v7 offset:8384
    ds_read_b64_tr_b16 v[126:127], v7 offset:10688
    ds_read_b64_tr_b16 v[128:129], v7 offset:8416
    ds_read_b64_tr_b16 v[130:131], v7 offset:10720
    ds_read_b64_tr_b16 v[132:133], v7 offset:8448
    ds_read_b64_tr_b16 v[134:135], v7 offset:10752
.p2align 6
    s_waitcnt lgkmcnt(0)
    s_barrier
    v_mfma_f32_16x16x32_bf16 v[20:23], v[100:103], v[92:95], 0
    ds_read_b128 v[136:139], v4 offset:17408
    ds_read_b128 v[140:143], v4 offset:18432
    v_mfma_f32_16x16x32_bf16 v[24:27], v[100:103], v[96:99], 0
    ds_read_b64_tr_b16 v[144:145], v7 offset:25600
    ds_read_b64_tr_b16 v[146:147], v7 offset:27904
    v_mfma_f32_16x16x32_bf16 v[28:31], v[104:107], v[92:95], 0
    ds_read_b64_tr_b16 v[148:149], v7 offset:25632
    v_mfma_f32_16x16x32_bf16 v[32:35], v[104:107], v[96:99], 0
    ds_read_b64_tr_b16 v[150:151], v7 offset:27936
    v_mfma_f32_16x16x32_bf16 v[36:39], v[108:111], v[92:95], 0
    ds_read_b64_tr_b16 v[152:153], v7 offset:25664
    v_mfma_f32_16x16x32_bf16 v[40:43], v[108:111], v[96:99], 0
    ds_read_b64_tr_b16 v[154:155], v7 offset:27968
    v_mfma_f32_16x16x32_bf16 v[44:47], v[112:115], v[92:95], 0
    ds_read_b64_tr_b16 v[156:157], v7 offset:25696
    v_mfma_f32_16x16x32_bf16 v[48:51], v[112:115], v[96:99], 0
    ds_read_b64_tr_b16 v[158:159], v7 offset:28000
    v_mfma_f32_16x16x32_bf16 v[52:55], v[116:119], v[92:95], 0
    ds_read_b64_tr_b16 v[160:161], v7 offset:25728
    v_mfma_f32_16x16x32_bf16 v[56:59], v[116:119], v[96:99], 0
    ds_read_b64_tr_b16 v[162:163], v7 offset:28032
    v_mfma_f32_16x16x32_bf16 v[60:63], v[120:123], v[92:95], 0
    ds_read_b64_tr_b16 v[164:165], v7 offset:25760
    v_mfma_f32_16x16x32_bf16 v[64:67], v[120:123], v[96:99], 0
    ds_read_b64_tr_b16 v[166:167], v7 offset:28064
    v_mfma_f32_16x16x32_bf16 v[68:71], v[124:127], v[92:95], 0
    ds_read_b64_tr_b16 v[168:169], v7 offset:25792
    v_mfma_f32_16x16x32_bf16 v[72:75], v[124:127], v[96:99], 0
    ds_read_b64_tr_b16 v[170:171], v7 offset:28096
    v_mfma_f32_16x16x32_bf16 v[76:79], v[128:131], v[92:95], 0
    ds_read_b64_tr_b16 v[172:173], v7 offset:25824
    v_mfma_f32_16x16x32_bf16 v[80:83], v[128:131], v[96:99], 0
    ds_read_b64_tr_b16 v[174:175], v7 offset:28128
    v_mfma_f32_16x16x32_bf16 v[84:87], v[132:135], v[92:95], 0
    ds_read_b64_tr_b16 v[176:177], v7 offset:25856
    v_mfma_f32_16x16x32_bf16 v[88:91], v[132:135], v[96:99], 0
    ds_read_b64_tr_b16 v[178:179], v7 offset:28160
    s_waitcnt lgkmcnt(0)
    s_barrier
    v_mfma_f32_16x16x32_bf16 v[20:23], v[144:147], v[136:139], v[20:23]
    ds_read_b128 v[92:95], v4 offset:34816
    ds_read_b128 v[96:99], v4 offset:35840
    v_mfma_f32_16x16x32_bf16 v[24:27], v[144:147], v[140:143], v[24:27]
    ds_read_b64_tr_b16 v[100:101], v7 offset:43008
    ds_read_b64_tr_b16 v[102:103], v7 offset:45312
    v_mfma_f32_16x16x32_bf16 v[28:31], v[148:151], v[136:139], v[28:31]
    ds_read_b64_tr_b16 v[104:105], v7 offset:43040
    v_mfma_f32_16x16x32_bf16 v[32:35], v[148:151], v[140:143], v[32:35]
    ds_read_b64_tr_b16 v[106:107], v7 offset:45344
    v_mfma_f32_16x16x32_bf16 v[36:39], v[152:155], v[136:139], v[36:39]
    ds_read_b64_tr_b16 v[108:109], v7 offset:43072
    v_mfma_f32_16x16x32_bf16 v[40:43], v[152:155], v[140:143], v[40:43]
    ds_read_b64_tr_b16 v[110:111], v7 offset:45376
    v_mfma_f32_16x16x32_bf16 v[44:47], v[156:159], v[136:139], v[44:47]
    ds_read_b64_tr_b16 v[112:113], v7 offset:43104
    v_mfma_f32_16x16x32_bf16 v[48:51], v[156:159], v[140:143], v[48:51]
    ds_read_b64_tr_b16 v[114:115], v7 offset:45408
    v_mfma_f32_16x16x32_bf16 v[52:55], v[160:163], v[136:139], v[52:55]
    ds_read_b64_tr_b16 v[116:117], v7 offset:43136
    v_mfma_f32_16x16x32_bf16 v[56:59], v[160:163], v[140:143], v[56:59]
    ds_read_b64_tr_b16 v[118:119], v7 offset:45440
    v_mfma_f32_16x16x32_bf16 v[60:63], v[164:167], v[136:139], v[60:63]
    ds_read_b64_tr_b16 v[120:121], v7 offset:43168
    v_mfma_f32_16x16x32_bf16 v[64:67], v[164:167], v[140:143], v[64:67]
    ds_read_b64_tr_b16 v[122:123], v7 offset:45472
    v_mfma_f32_16x16x32_bf16 v[68:71], v[168:171], v[136:139], v[68:71]
    ds_read_b64_tr_b16 v[124:125], v7 offset:43200
    v_mfma_f32_16x16x32_bf16 v[72:75], v[168:171], v[140:143], v[72:75]
    ds_read_b64_tr_b16 v[126:127], v7 offset:45504
    v_mfma_f32_16x16x32_bf16 v[76:79], v[172:175], v[136:139], v[76:79]
    ds_read_b64_tr_b16 v[128:129], v7 offset:43232
    v_mfma_f32_16x16x32_bf16 v[80:83], v[172:175], v[140:143], v[80:83]
    ds_read_b64_tr_b16 v[130:131], v7 offset:45536
    v_mfma_f32_16x16x32_bf16 v[84:87], v[176:179], v[136:139], v[84:87]
    ds_read_b64_tr_b16 v[132:133], v7 offset:43264
    v_mfma_f32_16x16x32_bf16 v[88:91], v[176:179], v[140:143], v[88:91]
    ds_read_b64_tr_b16 v[134:135], v7 offset:45568
    s_waitcnt lgkmcnt(0)
    s_barrier
    v_mfma_f32_16x16x32_bf16 v[20:23], v[100:103], v[92:95], v[20:23]
    ds_read_b128 v[136:139], v5 offset:0
    ds_read_b128 v[140:143], v5 offset:1024
    v_mfma_f32_16x16x32_bf16 v[24:27], v[100:103], v[96:99], v[24:27]
    ds_read_b64_tr_b16 v[144:145], v8 offset:8192
    ds_read_b64_tr_b16 v[146:147], v8 offset:10496
    v_mfma_f32_16x16x32_bf16 v[28:31], v[104:107], v[92:95], v[28:31]
    ds_read_b64_tr_b16 v[148:149], v8 offset:8224
    v_mfma_f32_16x16x32_bf16 v[32:35], v[104:107], v[96:99], v[32:35]
    ds_read_b64_tr_b16 v[150:151], v8 offset:10528
    v_mfma_f32_16x16x32_bf16 v[36:39], v[108:111], v[92:95], v[36:39]
    ds_read_b64_tr_b16 v[152:153], v8 offset:8256
    v_mfma_f32_16x16x32_bf16 v[40:43], v[108:111], v[96:99], v[40:43]
    ds_read_b64_tr_b16 v[154:155], v8 offset:10560
    v_mfma_f32_16x16x32_bf16 v[44:47], v[112:115], v[92:95], v[44:47]
    ds_read_b64_tr_b16 v[156:157], v8 offset:8288
    v_mfma_f32_16x16x32_bf16 v[48:51], v[112:115], v[96:99], v[48:51]
    ds_read_b64_tr_b16 v[158:159], v8 offset:10592
    v_mfma_f32_16x16x32_bf16 v[52:55], v[116:119], v[92:95], v[52:55]
    ds_read_b64_tr_b16 v[160:161], v8 offset:8320
    v_mfma_f32_16x16x32_bf16 v[56:59], v[116:119], v[96:99], v[56:59]
    ds_read_b64_tr_b16 v[162:163], v8 offset:10624
    v_mfma_f32_16x16x32_bf16 v[60:63], v[120:123], v[92:95], v[60:63]
    ds_read_b64_tr_b16 v[164:165], v8 offset:8352
    v_mfma_f32_16x16x32_bf16 v[64:67], v[120:123], v[96:99], v[64:67]
    ds_read_b64_tr_b16 v[166:167], v8 offset:10656
    v_mfma_f32_16x16x32_bf16 v[68:71], v[124:127], v[92:95], v[68:71]
    ds_read_b64_tr_b16 v[168:169], v8 offset:8384
    v_mfma_f32_16x16x32_bf16 v[72:75], v[124:127], v[96:99], v[72:75]
    ds_read_b64_tr_b16 v[170:171], v8 offset:10688
    v_mfma_f32_16x16x32_bf16 v[76:79], v[128:131], v[92:95], v[76:79]
    ds_read_b64_tr_b16 v[172:173], v8 offset:8416
    v_mfma_f32_16x16x32_bf16 v[80:83], v[128:131], v[96:99], v[80:83]
    ds_read_b64_tr_b16 v[174:175], v8 offset:10720
    v_mfma_f32_16x16x32_bf16 v[84:87], v[132:135], v[92:95], v[84:87]
    ds_read_b64_tr_b16 v[176:177], v8 offset:8448
    v_mfma_f32_16x16x32_bf16 v[88:91], v[132:135], v[96:99], v[88:91]
    ds_read_b64_tr_b16 v[178:179], v8 offset:10752
    s_waitcnt lgkmcnt(0)
    s_barrier
    v_mfma_f32_16x16x32_bf16 v[20:23], v[144:147], v[136:139], v[20:23]
    ds_read_b128 v[92:95], v5 offset:17408
    ds_read_b128 v[96:99], v5 offset:18432
    v_mfma_f32_16x16x32_bf16 v[24:27], v[144:147], v[140:143], v[24:27]
    ds_read_b64_tr_b16 v[100:101], v8 offset:25600
    ds_read_b64_tr_b16 v[102:103], v8 offset:27904
    v_mfma_f32_16x16x32_bf16 v[28:31], v[148:151], v[136:139], v[28:31]
    ds_read_b64_tr_b16 v[104:105], v8 offset:25632
    v_mfma_f32_16x16x32_bf16 v[32:35], v[148:151], v[140:143], v[32:35]
    ds_read_b64_tr_b16 v[106:107], v8 offset:27936
    v_mfma_f32_16x16x32_bf16 v[36:39], v[152:155], v[136:139], v[36:39]
    ds_read_b64_tr_b16 v[108:109], v8 offset:25664
    v_mfma_f32_16x16x32_bf16 v[40:43], v[152:155], v[140:143], v[40:43]
    ds_read_b64_tr_b16 v[110:111], v8 offset:27968
    v_mfma_f32_16x16x32_bf16 v[44:47], v[156:159], v[136:139], v[44:47]
    ds_read_b64_tr_b16 v[112:113], v8 offset:25696
    v_mfma_f32_16x16x32_bf16 v[48:51], v[156:159], v[140:143], v[48:51]
    ds_read_b64_tr_b16 v[114:115], v8 offset:28000
    v_mfma_f32_16x16x32_bf16 v[52:55], v[160:163], v[136:139], v[52:55]
    ds_read_b64_tr_b16 v[116:117], v8 offset:25728
    v_mfma_f32_16x16x32_bf16 v[56:59], v[160:163], v[140:143], v[56:59]
    ds_read_b64_tr_b16 v[118:119], v8 offset:28032
    v_mfma_f32_16x16x32_bf16 v[60:63], v[164:167], v[136:139], v[60:63]
    ds_read_b64_tr_b16 v[120:121], v8 offset:25760
    v_mfma_f32_16x16x32_bf16 v[64:67], v[164:167], v[140:143], v[64:67]
    ds_read_b64_tr_b16 v[122:123], v8 offset:28064
    v_mfma_f32_16x16x32_bf16 v[68:71], v[168:171], v[136:139], v[68:71]
    ds_read_b64_tr_b16 v[124:125], v8 offset:25792
    v_mfma_f32_16x16x32_bf16 v[72:75], v[168:171], v[140:143], v[72:75]
    ds_read_b64_tr_b16 v[126:127], v8 offset:28096
    v_mfma_f32_16x16x32_bf16 v[76:79], v[172:175], v[136:139], v[76:79]
    ds_read_b64_tr_b16 v[128:129], v8 offset:25824
    v_mfma_f32_16x16x32_bf16 v[80:83], v[172:175], v[140:143], v[80:83]
    ds_read_b64_tr_b16 v[130:131], v8 offset:28128
    v_mfma_f32_16x16x32_bf16 v[84:87], v[176:179], v[136:139], v[84:87]
    ds_read_b64_tr_b16 v[132:133], v8 offset:25856
    v_mfma_f32_16x16x32_bf16 v[88:91], v[176:179], v[140:143], v[88:91]
    ds_read_b64_tr_b16 v[134:135], v8 offset:28160
    s_waitcnt lgkmcnt(0)
    s_barrier
    v_mfma_f32_16x16x32_bf16 v[20:23], v[100:103], v[92:95], v[20:23]
    ds_read_b128 v[136:139], v5 offset:34816
    ds_read_b128 v[140:143], v5 offset:35840
    v_mfma_f32_16x16x32_bf16 v[24:27], v[100:103], v[96:99], v[24:27]
    ds_read_b64_tr_b16 v[144:145], v8 offset:43008
    ds_read_b64_tr_b16 v[146:147], v8 offset:45312
    v_mfma_f32_16x16x32_bf16 v[28:31], v[104:107], v[92:95], v[28:31]
    ds_read_b64_tr_b16 v[148:149], v8 offset:43040
    v_mfma_f32_16x16x32_bf16 v[32:35], v[104:107], v[96:99], v[32:35]
    ds_read_b64_tr_b16 v[150:151], v8 offset:45344
    v_mfma_f32_16x16x32_bf16 v[36:39], v[108:111], v[92:95], v[36:39]
    ds_read_b64_tr_b16 v[152:153], v8 offset:43072
    v_mfma_f32_16x16x32_bf16 v[40:43], v[108:111], v[96:99], v[40:43]
    ds_read_b64_tr_b16 v[154:155], v8 offset:45376
    v_mfma_f32_16x16x32_bf16 v[44:47], v[112:115], v[92:95], v[44:47]
    ds_read_b64_tr_b16 v[156:157], v8 offset:43104
    v_mfma_f32_16x16x32_bf16 v[48:51], v[112:115], v[96:99], v[48:51]
    ds_read_b64_tr_b16 v[158:159], v8 offset:45408
    v_mfma_f32_16x16x32_bf16 v[52:55], v[116:119], v[92:95], v[52:55]
    ds_read_b64_tr_b16 v[160:161], v8 offset:43136
    v_mfma_f32_16x16x32_bf16 v[56:59], v[116:119], v[96:99], v[56:59]
    ds_read_b64_tr_b16 v[162:163], v8 offset:45440
    v_mfma_f32_16x16x32_bf16 v[60:63], v[120:123], v[92:95], v[60:63]
    ds_read_b64_tr_b16 v[164:165], v8 offset:43168
    v_mfma_f32_16x16x32_bf16 v[64:67], v[120:123], v[96:99], v[64:67]
    ds_read_b64_tr_b16 v[166:167], v8 offset:45472
    v_mfma_f32_16x16x32_bf16 v[68:71], v[124:127], v[92:95], v[68:71]
    ds_read_b64_tr_b16 v[168:169], v8 offset:43200
    v_mfma_f32_16x16x32_bf16 v[72:75], v[124:127], v[96:99], v[72:75]
    ds_read_b64_tr_b16 v[170:171], v8 offset:45504
    v_mfma_f32_16x16x32_bf16 v[76:79], v[128:131], v[92:95], v[76:79]
    ds_read_b64_tr_b16 v[172:173], v8 offset:43232
    v_mfma_f32_16x16x32_bf16 v[80:83], v[128:131], v[96:99], v[80:83]
    ds_read_b64_tr_b16 v[174:175], v8 offset:45536
    v_mfma_f32_16x16x32_bf16 v[84:87], v[132:135], v[92:95], v[84:87]
    ds_read_b64_tr_b16 v[176:177], v8 offset:43264
    v_mfma_f32_16x16x32_bf16 v[88:91], v[132:135], v[96:99], v[88:91]
    ds_read_b64_tr_b16 v[178:179], v8 offset:45568
    s_waitcnt lgkmcnt(0)
    s_barrier
    v_mfma_f32_16x16x32_bf16 v[20:23], v[144:147], v[136:139], v[20:23]
    ds_read_b128 v[92:95], v4 offset:0
    ds_read_b128 v[96:99], v4 offset:1024
    v_mfma_f32_16x16x32_bf16 v[24:27], v[144:147], v[140:143], v[24:27]
    ds_read_b64_tr_b16 v[100:101], v7 offset:8192
    ds_read_b64_tr_b16 v[102:103], v7 offset:10496
    v_mfma_f32_16x16x32_bf16 v[28:31], v[148:151], v[136:139], v[28:31]
    ds_read_b64_tr_b16 v[104:105], v7 offset:8224
    v_mfma_f32_16x16x32_bf16 v[32:35], v[148:151], v[140:143], v[32:35]
    ds_read_b64_tr_b16 v[106:107], v7 offset:10528
    v_mfma_f32_16x16x32_bf16 v[36:39], v[152:155], v[136:139], v[36:39]
    ds_read_b64_tr_b16 v[108:109], v7 offset:8256
    v_mfma_f32_16x16x32_bf16 v[40:43], v[152:155], v[140:143], v[40:43]
    ds_read_b64_tr_b16 v[110:111], v7 offset:10560
    v_mfma_f32_16x16x32_bf16 v[44:47], v[156:159], v[136:139], v[44:47]
    ds_read_b64_tr_b16 v[112:113], v7 offset:8288
    v_mfma_f32_16x16x32_bf16 v[48:51], v[156:159], v[140:143], v[48:51]
    ds_read_b64_tr_b16 v[114:115], v7 offset:10592
    v_mfma_f32_16x16x32_bf16 v[52:55], v[160:163], v[136:139], v[52:55]
    ds_read_b64_tr_b16 v[116:117], v7 offset:8320
    v_mfma_f32_16x16x32_bf16 v[56:59], v[160:163], v[140:143], v[56:59]
    ds_read_b64_tr_b16 v[118:119], v7 offset:10624
    v_mfma_f32_16x16x32_bf16 v[60:63], v[164:167], v[136:139], v[60:63]
    ds_read_b64_tr_b16 v[120:121], v7 offset:8352
    v_mfma_f32_16x16x32_bf16 v[64:67], v[164:167], v[140:143], v[64:67]
    ds_read_b64_tr_b16 v[122:123], v7 offset:10656
    v_mfma_f32_16x16x32_bf16 v[68:71], v[168:171], v[136:139], v[68:71]
    ds_read_b64_tr_b16 v[124:125], v7 offset:8384
    v_mfma_f32_16x16x32_bf16 v[72:75], v[168:171], v[140:143], v[72:75]
    ds_read_b64_tr_b16 v[126:127], v7 offset:10688
    v_mfma_f32_16x16x32_bf16 v[76:79], v[172:175], v[136:139], v[76:79]
    ds_read_b64_tr_b16 v[128:129], v7 offset:8416
    v_mfma_f32_16x16x32_bf16 v[80:83], v[172:175], v[140:143], v[80:83]
    ds_read_b64_tr_b16 v[130:131], v7 offset:10720
    v_mfma_f32_16x16x32_bf16 v[84:87], v[176:179], v[136:139], v[84:87]
    ds_read_b64_tr_b16 v[132:133], v7 offset:8448
    v_mfma_f32_16x16x32_bf16 v[88:91], v[176:179], v[140:143], v[88:91]
    ds_read_b64_tr_b16 v[134:135], v7 offset:10752
    s_waitcnt lgkmcnt(0)
    s_barrier
    v_mfma_f32_16x16x32_bf16 v[20:23], v[100:103], v[92:95], v[20:23]
    ds_read_b128 v[136:139], v4 offset:17408
    ds_read_b128 v[140:143], v4 offset:18432
    v_mfma_f32_16x16x32_bf16 v[24:27], v[100:103], v[96:99], v[24:27]
    ds_read_b64_tr_b16 v[144:145], v7 offset:25600
    ds_read_b64_tr_b16 v[146:147], v7 offset:27904
    v_mfma_f32_16x16x32_bf16 v[28:31], v[104:107], v[92:95], v[28:31]
    ds_read_b64_tr_b16 v[148:149], v7 offset:25632
    v_mfma_f32_16x16x32_bf16 v[32:35], v[104:107], v[96:99], v[32:35]
    ds_read_b64_tr_b16 v[150:151], v7 offset:27936
    v_mfma_f32_16x16x32_bf16 v[36:39], v[108:111], v[92:95], v[36:39]
    ds_read_b64_tr_b16 v[152:153], v7 offset:25664
    v_mfma_f32_16x16x32_bf16 v[40:43], v[108:111], v[96:99], v[40:43]
    ds_read_b64_tr_b16 v[154:155], v7 offset:27968
    v_mfma_f32_16x16x32_bf16 v[44:47], v[112:115], v[92:95], v[44:47]
    ds_read_b64_tr_b16 v[156:157], v7 offset:25696
    v_mfma_f32_16x16x32_bf16 v[48:51], v[112:115], v[96:99], v[48:51]
    ds_read_b64_tr_b16 v[158:159], v7 offset:28000
    v_mfma_f32_16x16x32_bf16 v[52:55], v[116:119], v[92:95], v[52:55]
    ds_read_b64_tr_b16 v[160:161], v7 offset:25728
    v_mfma_f32_16x16x32_bf16 v[56:59], v[116:119], v[96:99], v[56:59]
    ds_read_b64_tr_b16 v[162:163], v7 offset:28032
    v_mfma_f32_16x16x32_bf16 v[60:63], v[120:123], v[92:95], v[60:63]
    ds_read_b64_tr_b16 v[164:165], v7 offset:25760
    v_mfma_f32_16x16x32_bf16 v[64:67], v[120:123], v[96:99], v[64:67]
    ds_read_b64_tr_b16 v[166:167], v7 offset:28064
    v_mfma_f32_16x16x32_bf16 v[68:71], v[124:127], v[92:95], v[68:71]
    ds_read_b64_tr_b16 v[168:169], v7 offset:25792
    v_mfma_f32_16x16x32_bf16 v[72:75], v[124:127], v[96:99], v[72:75]
    ds_read_b64_tr_b16 v[170:171], v7 offset:28096
    v_mfma_f32_16x16x32_bf16 v[76:79], v[128:131], v[92:95], v[76:79]
    ds_read_b64_tr_b16 v[172:173], v7 offset:25824
    v_mfma_f32_16x16x32_bf16 v[80:83], v[128:131], v[96:99], v[80:83]
    ds_read_b64_tr_b16 v[174:175], v7 offset:28128
    v_mfma_f32_16x16x32_bf16 v[84:87], v[132:135], v[92:95], v[84:87]
    ds_read_b64_tr_b16 v[176:177], v7 offset:25856
    v_mfma_f32_16x16x32_bf16 v[88:91], v[132:135], v[96:99], v[88:91]
    ds_read_b64_tr_b16 v[178:179], v7 offset:28160
    s_waitcnt lgkmcnt(0)
    s_barrier
    v_mfma_f32_16x16x32_bf16 v[20:23], v[144:147], v[136:139], v[20:23]
    ds_read_b128 v[92:95], v4 offset:34816
    ds_read_b128 v[96:99], v4 offset:35840
    v_mfma_f32_16x16x32_bf16 v[24:27], v[144:147], v[140:143], v[24:27]
    ds_read_b64_tr_b16 v[100:101], v7 offset:43008
    ds_read_b64_tr_b16 v[102:103], v7 offset:45312
    v_mfma_f32_16x16x32_bf16 v[28:31], v[148:151], v[136:139], v[28:31]
    ds_read_b64_tr_b16 v[104:105], v7 offset:43040
    v_mfma_f32_16x16x32_bf16 v[32:35], v[148:151], v[140:143], v[32:35]
    ds_read_b64_tr_b16 v[106:107], v7 offset:45344
    v_mfma_f32_16x16x32_bf16 v[36:39], v[152:155], v[136:139], v[36:39]
    ds_read_b64_tr_b16 v[108:109], v7 offset:43072
    v_mfma_f32_16x16x32_bf16 v[40:43], v[152:155], v[140:143], v[40:43]
    ds_read_b64_tr_b16 v[110:111], v7 offset:45376
    v_mfma_f32_16x16x32_bf16 v[44:47], v[156:159], v[136:139], v[44:47]
    ds_read_b64_tr_b16 v[112:113], v7 offset:43104
    v_mfma_f32_16x16x32_bf16 v[48:51], v[156:159], v[140:143], v[48:51]
    ds_read_b64_tr_b16 v[114:115], v7 offset:45408
    v_mfma_f32_16x16x32_bf16 v[52:55], v[160:163], v[136:139], v[52:55]
    ds_read_b64_tr_b16 v[116:117], v7 offset:43136
    v_mfma_f32_16x16x32_bf16 v[56:59], v[160:163], v[140:143], v[56:59]
    ds_read_b64_tr_b16 v[118:119], v7 offset:45440
    v_mfma_f32_16x16x32_bf16 v[60:63], v[164:167], v[136:139], v[60:63]
    ds_read_b64_tr_b16 v[120:121], v7 offset:43168
    v_mfma_f32_16x16x32_bf16 v[64:67], v[164:167], v[140:143], v[64:67]
    ds_read_b64_tr_b16 v[122:123], v7 offset:45472
    v_mfma_f32_16x16x32_bf16 v[68:71], v[168:171], v[136:139], v[68:71]
    ds_read_b64_tr_b16 v[124:125], v7 offset:43200
    v_mfma_f32_16x16x32_bf16 v[72:75], v[168:171], v[140:143], v[72:75]
    ds_read_b64_tr_b16 v[126:127], v7 offset:45504
    v_mfma_f32_16x16x32_bf16 v[76:79], v[172:175], v[136:139], v[76:79]
    ds_read_b64_tr_b16 v[128:129], v7 offset:43232
    v_mfma_f32_16x16x32_bf16 v[80:83], v[172:175], v[140:143], v[80:83]
    ds_read_b64_tr_b16 v[130:131], v7 offset:45536
    v_mfma_f32_16x16x32_bf16 v[84:87], v[176:179], v[136:139], v[84:87]
    ds_read_b64_tr_b16 v[132:133], v7 offset:43264
    v_mfma_f32_16x16x32_bf16 v[88:91], v[176:179], v[140:143], v[88:91]
    ds_read_b64_tr_b16 v[134:135], v7 offset:45568
    s_waitcnt lgkmcnt(0)
    s_barrier
    v_mfma_f32_16x16x32_bf16 v[20:23], v[100:103], v[92:95], v[20:23]
    ds_read_b128 v[136:139], v5 offset:0
    ds_read_b128 v[140:143], v5 offset:1024
    v_mfma_f32_16x16x32_bf16 v[24:27], v[100:103], v[96:99], v[24:27]
    ds_read_b64_tr_b16 v[144:145], v8 offset:8192
    ds_read_b64_tr_b16 v[146:147], v8 offset:10496
    v_mfma_f32_16x16x32_bf16 v[28:31], v[104:107], v[92:95], v[28:31]
    ds_read_b64_tr_b16 v[148:149], v8 offset:8224
    v_mfma_f32_16x16x32_bf16 v[32:35], v[104:107], v[96:99], v[32:35]
    ds_read_b64_tr_b16 v[150:151], v8 offset:10528
    v_mfma_f32_16x16x32_bf16 v[36:39], v[108:111], v[92:95], v[36:39]
    ds_read_b64_tr_b16 v[152:153], v8 offset:8256
    v_mfma_f32_16x16x32_bf16 v[40:43], v[108:111], v[96:99], v[40:43]
    ds_read_b64_tr_b16 v[154:155], v8 offset:10560
    v_mfma_f32_16x16x32_bf16 v[44:47], v[112:115], v[92:95], v[44:47]
    ds_read_b64_tr_b16 v[156:157], v8 offset:8288
    v_mfma_f32_16x16x32_bf16 v[48:51], v[112:115], v[96:99], v[48:51]
    ds_read_b64_tr_b16 v[158:159], v8 offset:10592
    v_mfma_f32_16x16x32_bf16 v[52:55], v[116:119], v[92:95], v[52:55]
    ds_read_b64_tr_b16 v[160:161], v8 offset:8320
    v_mfma_f32_16x16x32_bf16 v[56:59], v[116:119], v[96:99], v[56:59]
    ds_read_b64_tr_b16 v[162:163], v8 offset:10624
    v_mfma_f32_16x16x32_bf16 v[60:63], v[120:123], v[92:95], v[60:63]
    ds_read_b64_tr_b16 v[164:165], v8 offset:8352
    v_mfma_f32_16x16x32_bf16 v[64:67], v[120:123], v[96:99], v[64:67]
    ds_read_b64_tr_b16 v[166:167], v8 offset:10656
    v_mfma_f32_16x16x32_bf16 v[68:71], v[124:127], v[92:95], v[68:71]
    ds_read_b64_tr_b16 v[168:169], v8 offset:8384
    v_mfma_f32_16x16x32_bf16 v[72:75], v[124:127], v[96:99], v[72:75]
    ds_read_b64_tr_b16 v[170:171], v8 offset:10688
    v_mfma_f32_16x16x32_bf16 v[76:79], v[128:131], v[92:95], v[76:79]
    ds_read_b64_tr_b16 v[172:173], v8 offset:8416
    v_mfma_f32_16x16x32_bf16 v[80:83], v[128:131], v[96:99], v[80:83]
    ds_read_b64_tr_b16 v[174:175], v8 offset:10720
    v_mfma_f32_16x16x32_bf16 v[84:87], v[132:135], v[92:95], v[84:87]
    ds_read_b64_tr_b16 v[176:177], v8 offset:8448
    v_mfma_f32_16x16x32_bf16 v[88:91], v[132:135], v[96:99], v[88:91]
    ds_read_b64_tr_b16 v[178:179], v8 offset:10752
    s_waitcnt lgkmcnt(0)
    s_barrier
    v_mfma_f32_16x16x32_bf16 v[20:23], v[144:147], v[136:139], v[20:23]
    ds_read_b128 v[92:95], v5 offset:17408
    ds_read_b128 v[96:99], v5 offset:18432
    v_mfma_f32_16x16x32_bf16 v[24:27], v[144:147], v[140:143], v[24:27]
    ds_read_b64_tr_b16 v[100:101], v8 offset:25600
    ds_read_b64_tr_b16 v[102:103], v8 offset:27904
    v_mfma_f32_16x16x32_bf16 v[28:31], v[148:151], v[136:139], v[28:31]
    ds_read_b64_tr_b16 v[104:105], v8 offset:25632
    v_mfma_f32_16x16x32_bf16 v[32:35], v[148:151], v[140:143], v[32:35]
    ds_read_b64_tr_b16 v[106:107], v8 offset:27936
    v_mfma_f32_16x16x32_bf16 v[36:39], v[152:155], v[136:139], v[36:39]
    ds_read_b64_tr_b16 v[108:109], v8 offset:25664
    v_mfma_f32_16x16x32_bf16 v[40:43], v[152:155], v[140:143], v[40:43]
    ds_read_b64_tr_b16 v[110:111], v8 offset:27968
    v_mfma_f32_16x16x32_bf16 v[44:47], v[156:159], v[136:139], v[44:47]
    ds_read_b64_tr_b16 v[112:113], v8 offset:25696
    v_mfma_f32_16x16x32_bf16 v[48:51], v[156:159], v[140:143], v[48:51]
    ds_read_b64_tr_b16 v[114:115], v8 offset:28000
    v_mfma_f32_16x16x32_bf16 v[52:55], v[160:163], v[136:139], v[52:55]
    ds_read_b64_tr_b16 v[116:117], v8 offset:25728
    v_mfma_f32_16x16x32_bf16 v[56:59], v[160:163], v[140:143], v[56:59]
    ds_read_b64_tr_b16 v[118:119], v8 offset:28032
    v_mfma_f32_16x16x32_bf16 v[60:63], v[164:167], v[136:139], v[60:63]
    ds_read_b64_tr_b16 v[120:121], v8 offset:25760
    v_mfma_f32_16x16x32_bf16 v[64:67], v[164:167], v[140:143], v[64:67]
    ds_read_b64_tr_b16 v[122:123], v8 offset:28064
    v_mfma_f32_16x16x32_bf16 v[68:71], v[168:171], v[136:139], v[68:71]
    ds_read_b64_tr_b16 v[124:125], v8 offset:25792
    v_mfma_f32_16x16x32_bf16 v[72:75], v[168:171], v[140:143], v[72:75]
    ds_read_b64_tr_b16 v[126:127], v8 offset:28096
    v_mfma_f32_16x16x32_bf16 v[76:79], v[172:175], v[136:139], v[76:79]
    ds_read_b64_tr_b16 v[128:129], v8 offset:25824
    v_mfma_f32_16x16x32_bf16 v[80:83], v[172:175], v[140:143], v[80:83]
    ds_read_b64_tr_b16 v[130:131], v8 offset:28128
    v_mfma_f32_16x16x32_bf16 v[84:87], v[176:179], v[136:139], v[84:87]
    ds_read_b64_tr_b16 v[132:133], v8 offset:25856
    v_mfma_f32_16x16x32_bf16 v[88:91], v[176:179], v[140:143], v[88:91]
    ds_read_b64_tr_b16 v[134:135], v8 offset:28160
    s_waitcnt lgkmcnt(0)
    s_barrier
    v_mfma_f32_16x16x32_bf16 v[20:23], v[100:103], v[92:95], v[20:23]
    ds_read_b128 v[136:139], v5 offset:34816
    ds_read_b128 v[140:143], v5 offset:35840
    v_mfma_f32_16x16x32_bf16 v[24:27], v[100:103], v[96:99], v[24:27]
    ds_read_b64_tr_b16 v[144:145], v8 offset:43008
    ds_read_b64_tr_b16 v[146:147], v8 offset:45312
    v_mfma_f32_16x16x32_bf16 v[28:31], v[104:107], v[92:95], v[28:31]
    ds_read_b64_tr_b16 v[148:149], v8 offset:43040
    v_mfma_f32_16x16x32_bf16 v[32:35], v[104:107], v[96:99], v[32:35]
    ds_read_b64_tr_b16 v[150:151], v8 offset:45344
    v_mfma_f32_16x16x32_bf16 v[36:39], v[108:111], v[92:95], v[36:39]
    ds_read_b64_tr_b16 v[152:153], v8 offset:43072
    v_mfma_f32_16x16x32_bf16 v[40:43], v[108:111], v[96:99], v[40:43]
    ds_read_b64_tr_b16 v[154:155], v8 offset:45376
    v_mfma_f32_16x16x32_bf16 v[44:47], v[112:115], v[92:95], v[44:47]
    ds_read_b64_tr_b16 v[156:157], v8 offset:43104
    v_mfma_f32_16x16x32_bf16 v[48:51], v[112:115], v[96:99], v[48:51]
    ds_read_b64_tr_b16 v[158:159], v8 offset:45408
    v_mfma_f32_16x16x32_bf16 v[52:55], v[116:119], v[92:95], v[52:55]
    ds_read_b64_tr_b16 v[160:161], v8 offset:43136
    v_mfma_f32_16x16x32_bf16 v[56:59], v[116:119], v[96:99], v[56:59]
    ds_read_b64_tr_b16 v[162:163], v8 offset:45440
    v_mfma_f32_16x16x32_bf16 v[60:63], v[120:123], v[92:95], v[60:63]
    ds_read_b64_tr_b16 v[164:165], v8 offset:43168
    v_mfma_f32_16x16x32_bf16 v[64:67], v[120:123], v[96:99], v[64:67]
    ds_read_b64_tr_b16 v[166:167], v8 offset:45472
    v_mfma_f32_16x16x32_bf16 v[68:71], v[124:127], v[92:95], v[68:71]
    ds_read_b64_tr_b16 v[168:169], v8 offset:43200
    v_mfma_f32_16x16x32_bf16 v[72:75], v[124:127], v[96:99], v[72:75]
    ds_read_b64_tr_b16 v[170:171], v8 offset:45504
    v_mfma_f32_16x16x32_bf16 v[76:79], v[128:131], v[92:95], v[76:79]
    ds_read_b64_tr_b16 v[172:173], v8 offset:43232
    v_mfma_f32_16x16x32_bf16 v[80:83], v[128:131], v[96:99], v[80:83]
    ds_read_b64_tr_b16 v[174:175], v8 offset:45536
    v_mfma_f32_16x16x32_bf16 v[84:87], v[132:135], v[92:95], v[84:87]
    ds_read_b64_tr_b16 v[176:177], v8 offset:43264
    v_mfma_f32_16x16x32_bf16 v[88:91], v[132:135], v[96:99], v[88:91]
    ds_read_b64_tr_b16 v[178:179], v8 offset:45568
    s_waitcnt lgkmcnt(0)
    s_barrier
    v_mfma_f32_16x16x32_bf16 v[20:23], v[144:147], v[136:139], v[20:23]
    ds_read_b128 v[92:95], v4 offset:0
    ds_read_b128 v[96:99], v4 offset:1024
    v_mfma_f32_16x16x32_bf16 v[24:27], v[144:147], v[140:143], v[24:27]
    ds_read_b64_tr_b16 v[100:101], v7 offset:8192
    ds_read_b64_tr_b16 v[102:103], v7 offset:10496
    v_mfma_f32_16x16x32_bf16 v[28:31], v[148:151], v[136:139], v[28:31]
    ds_read_b64_tr_b16 v[104:105], v7 offset:8224
    v_mfma_f32_16x16x32_bf16 v[32:35], v[148:151], v[140:143], v[32:35]
    ds_read_b64_tr_b16 v[106:107], v7 offset:10528
    v_mfma_f32_16x16x32_bf16 v[36:39], v[152:155], v[136:139], v[36:39]
    ds_read_b64_tr_b16 v[108:109], v7 offset:8256
    v_mfma_f32_16x16x32_bf16 v[40:43], v[152:155], v[140:143], v[40:43]
    ds_read_b64_tr_b16 v[110:111], v7 offset:10560
    v_mfma_f32_16x16x32_bf16 v[44:47], v[156:159], v[136:139], v[44:47]
    ds_read_b64_tr_b16 v[112:113], v7 offset:8288
    v_mfma_f32_16x16x32_bf16 v[48:51], v[156:159], v[140:143], v[48:51]
    ds_read_b64_tr_b16 v[114:115], v7 offset:10592
    v_mfma_f32_16x16x32_bf16 v[52:55], v[160:163], v[136:139], v[52:55]
    ds_read_b64_tr_b16 v[116:117], v7 offset:8320
    v_mfma_f32_16x16x32_bf16 v[56:59], v[160:163], v[140:143], v[56:59]
    ds_read_b64_tr_b16 v[118:119], v7 offset:10624
    v_mfma_f32_16x16x32_bf16 v[60:63], v[164:167], v[136:139], v[60:63]
    ds_read_b64_tr_b16 v[120:121], v7 offset:8352
    v_mfma_f32_16x16x32_bf16 v[64:67], v[164:167], v[140:143], v[64:67]
    ds_read_b64_tr_b16 v[122:123], v7 offset:10656
    v_mfma_f32_16x16x32_bf16 v[68:71], v[168:171], v[136:139], v[68:71]
    ds_read_b64_tr_b16 v[124:125], v7 offset:8384
    v_mfma_f32_16x16x32_bf16 v[72:75], v[168:171], v[140:143], v[72:75]
    ds_read_b64_tr_b16 v[126:127], v7 offset:10688
    v_mfma_f32_16x16x32_bf16 v[76:79], v[172:175], v[136:139], v[76:79]
    ds_read_b64_tr_b16 v[128:129], v7 offset:8416
    v_mfma_f32_16x16x32_bf16 v[80:83], v[172:175], v[140:143], v[80:83]
    ds_read_b64_tr_b16 v[130:131], v7 offset:10720
    v_mfma_f32_16x16x32_bf16 v[84:87], v[176:179], v[136:139], v[84:87]
    ds_read_b64_tr_b16 v[132:133], v7 offset:8448
    v_mfma_f32_16x16x32_bf16 v[88:91], v[176:179], v[140:143], v[88:91]
    ds_read_b64_tr_b16 v[134:135], v7 offset:10752
    s_waitcnt lgkmcnt(0)
    s_barrier
    v_mfma_f32_16x16x32_bf16 v[20:23], v[100:103], v[92:95], v[20:23]
    ds_read_b128 v[136:139], v4 offset:17408
    ds_read_b128 v[140:143], v4 offset:18432
    v_mfma_f32_16x16x32_bf16 v[24:27], v[100:103], v[96:99], v[24:27]
    ds_read_b64_tr_b16 v[144:145], v7 offset:25600
    ds_read_b64_tr_b16 v[146:147], v7 offset:27904
    v_mfma_f32_16x16x32_bf16 v[28:31], v[104:107], v[92:95], v[28:31]
    ds_read_b64_tr_b16 v[148:149], v7 offset:25632
    v_mfma_f32_16x16x32_bf16 v[32:35], v[104:107], v[96:99], v[32:35]
    ds_read_b64_tr_b16 v[150:151], v7 offset:27936
    v_mfma_f32_16x16x32_bf16 v[36:39], v[108:111], v[92:95], v[36:39]
    ds_read_b64_tr_b16 v[152:153], v7 offset:25664
    v_mfma_f32_16x16x32_bf16 v[40:43], v[108:111], v[96:99], v[40:43]
    ds_read_b64_tr_b16 v[154:155], v7 offset:27968
    v_mfma_f32_16x16x32_bf16 v[44:47], v[112:115], v[92:95], v[44:47]
    ds_read_b64_tr_b16 v[156:157], v7 offset:25696
    v_mfma_f32_16x16x32_bf16 v[48:51], v[112:115], v[96:99], v[48:51]
    ds_read_b64_tr_b16 v[158:159], v7 offset:28000
    v_mfma_f32_16x16x32_bf16 v[52:55], v[116:119], v[92:95], v[52:55]
    ds_read_b64_tr_b16 v[160:161], v7 offset:25728
    v_mfma_f32_16x16x32_bf16 v[56:59], v[116:119], v[96:99], v[56:59]
    ds_read_b64_tr_b16 v[162:163], v7 offset:28032
    v_mfma_f32_16x16x32_bf16 v[60:63], v[120:123], v[92:95], v[60:63]
    ds_read_b64_tr_b16 v[164:165], v7 offset:25760
    v_mfma_f32_16x16x32_bf16 v[64:67], v[120:123], v[96:99], v[64:67]
    ds_read_b64_tr_b16 v[166:167], v7 offset:28064
    v_mfma_f32_16x16x32_bf16 v[68:71], v[124:127], v[92:95], v[68:71]
    ds_read_b64_tr_b16 v[168:169], v7 offset:25792
    v_mfma_f32_16x16x32_bf16 v[72:75], v[124:127], v[96:99], v[72:75]
    ds_read_b64_tr_b16 v[170:171], v7 offset:28096
    v_mfma_f32_16x16x32_bf16 v[76:79], v[128:131], v[92:95], v[76:79]
    ds_read_b64_tr_b16 v[172:173], v7 offset:25824
    v_mfma_f32_16x16x32_bf16 v[80:83], v[128:131], v[96:99], v[80:83]
    ds_read_b64_tr_b16 v[174:175], v7 offset:28128
    v_mfma_f32_16x16x32_bf16 v[84:87], v[132:135], v[92:95], v[84:87]
    ds_read_b64_tr_b16 v[176:177], v7 offset:25856
    v_mfma_f32_16x16x32_bf16 v[88:91], v[132:135], v[96:99], v[88:91]
    ds_read_b64_tr_b16 v[178:179], v7 offset:28160
    s_waitcnt lgkmcnt(0)
    s_barrier
    v_mfma_f32_16x16x32_bf16 v[20:23], v[144:147], v[136:139], v[20:23]
    ds_read_b128 v[92:95], v4 offset:34816
    ds_read_b128 v[96:99], v4 offset:35840
    v_mfma_f32_16x16x32_bf16 v[24:27], v[144:147], v[140:143], v[24:27]
    ds_read_b64_tr_b16 v[100:101], v7 offset:43008
    ds_read_b64_tr_b16 v[102:103], v7 offset:45312
    v_mfma_f32_16x16x32_bf16 v[28:31], v[148:151], v[136:139], v[28:31]
    ds_read_b64_tr_b16 v[104:105], v7 offset:43040
    v_mfma_f32_16x16x32_bf16 v[32:35], v[148:151], v[140:143], v[32:35]
    ds_read_b64_tr_b16 v[106:107], v7 offset:45344
    v_mfma_f32_16x16x32_bf16 v[36:39], v[152:155], v[136:139], v[36:39]
    ds_read_b64_tr_b16 v[108:109], v7 offset:43072
    v_mfma_f32_16x16x32_bf16 v[40:43], v[152:155], v[140:143], v[40:43]
    ds_read_b64_tr_b16 v[110:111], v7 offset:45376
    v_mfma_f32_16x16x32_bf16 v[44:47], v[156:159], v[136:139], v[44:47]
    ds_read_b64_tr_b16 v[112:113], v7 offset:43104
    v_mfma_f32_16x16x32_bf16 v[48:51], v[156:159], v[140:143], v[48:51]
    ds_read_b64_tr_b16 v[114:115], v7 offset:45408
    v_mfma_f32_16x16x32_bf16 v[52:55], v[160:163], v[136:139], v[52:55]
    ds_read_b64_tr_b16 v[116:117], v7 offset:43136
    v_mfma_f32_16x16x32_bf16 v[56:59], v[160:163], v[140:143], v[56:59]
    ds_read_b64_tr_b16 v[118:119], v7 offset:45440
    v_mfma_f32_16x16x32_bf16 v[60:63], v[164:167], v[136:139], v[60:63]
    ds_read_b64_tr_b16 v[120:121], v7 offset:43168
    v_mfma_f32_16x16x32_bf16 v[64:67], v[164:167], v[140:143], v[64:67]
    ds_read_b64_tr_b16 v[122:123], v7 offset:45472
    v_mfma_f32_16x16x32_bf16 v[68:71], v[168:171], v[136:139], v[68:71]
    ds_read_b64_tr_b16 v[124:125], v7 offset:43200
    v_mfma_f32_16x16x32_bf16 v[72:75], v[168:171], v[140:143], v[72:75]
    ds_read_b64_tr_b16 v[126:127], v7 offset:45504
    v_mfma_f32_16x16x32_bf16 v[76:79], v[172:175], v[136:139], v[76:79]
    ds_read_b64_tr_b16 v[128:129], v7 offset:43232
    v_mfma_f32_16x16x32_bf16 v[80:83], v[172:175], v[140:143], v[80:83]
    ds_read_b64_tr_b16 v[130:131], v7 offset:45536
    v_mfma_f32_16x16x32_bf16 v[84:87], v[176:179], v[136:139], v[84:87]
    ds_read_b64_tr_b16 v[132:133], v7 offset:43264
    v_mfma_f32_16x16x32_bf16 v[88:91], v[176:179], v[140:143], v[88:91]
    ds_read_b64_tr_b16 v[134:135], v7 offset:45568
    s_waitcnt lgkmcnt(0)
    s_barrier
    v_mfma_f32_16x16x32_bf16 v[20:23], v[100:103], v[92:95], v[20:23]
    ds_read_b128 v[136:139], v5 offset:0
    ds_read_b128 v[140:143], v5 offset:1024
    v_mfma_f32_16x16x32_bf16 v[24:27], v[100:103], v[96:99], v[24:27]
    ds_read_b64_tr_b16 v[144:145], v8 offset:8192
    ds_read_b64_tr_b16 v[146:147], v8 offset:10496
    v_mfma_f32_16x16x32_bf16 v[28:31], v[104:107], v[92:95], v[28:31]
    ds_read_b64_tr_b16 v[148:149], v8 offset:8224
    v_mfma_f32_16x16x32_bf16 v[32:35], v[104:107], v[96:99], v[32:35]
    ds_read_b64_tr_b16 v[150:151], v8 offset:10528
    v_mfma_f32_16x16x32_bf16 v[36:39], v[108:111], v[92:95], v[36:39]
    ds_read_b64_tr_b16 v[152:153], v8 offset:8256
    v_mfma_f32_16x16x32_bf16 v[40:43], v[108:111], v[96:99], v[40:43]
    ds_read_b64_tr_b16 v[154:155], v8 offset:10560
    v_mfma_f32_16x16x32_bf16 v[44:47], v[112:115], v[92:95], v[44:47]
    ds_read_b64_tr_b16 v[156:157], v8 offset:8288
    v_mfma_f32_16x16x32_bf16 v[48:51], v[112:115], v[96:99], v[48:51]
    ds_read_b64_tr_b16 v[158:159], v8 offset:10592
    v_mfma_f32_16x16x32_bf16 v[52:55], v[116:119], v[92:95], v[52:55]
    ds_read_b64_tr_b16 v[160:161], v8 offset:8320
    v_mfma_f32_16x16x32_bf16 v[56:59], v[116:119], v[96:99], v[56:59]
    ds_read_b64_tr_b16 v[162:163], v8 offset:10624
    v_mfma_f32_16x16x32_bf16 v[60:63], v[120:123], v[92:95], v[60:63]
    ds_read_b64_tr_b16 v[164:165], v8 offset:8352
    v_mfma_f32_16x16x32_bf16 v[64:67], v[120:123], v[96:99], v[64:67]
    ds_read_b64_tr_b16 v[166:167], v8 offset:10656
    v_mfma_f32_16x16x32_bf16 v[68:71], v[124:127], v[92:95], v[68:71]
    ds_read_b64_tr_b16 v[168:169], v8 offset:8384
    v_mfma_f32_16x16x32_bf16 v[72:75], v[124:127], v[96:99], v[72:75]
    ds_read_b64_tr_b16 v[170:171], v8 offset:10688
    v_mfma_f32_16x16x32_bf16 v[76:79], v[128:131], v[92:95], v[76:79]
    ds_read_b64_tr_b16 v[172:173], v8 offset:8416
    v_mfma_f32_16x16x32_bf16 v[80:83], v[128:131], v[96:99], v[80:83]
    ds_read_b64_tr_b16 v[174:175], v8 offset:10720
    v_mfma_f32_16x16x32_bf16 v[84:87], v[132:135], v[92:95], v[84:87]
    ds_read_b64_tr_b16 v[176:177], v8 offset:8448
    v_mfma_f32_16x16x32_bf16 v[88:91], v[132:135], v[96:99], v[88:91]
    ds_read_b64_tr_b16 v[178:179], v8 offset:10752
    s_waitcnt lgkmcnt(0)
    s_barrier
    v_mfma_f32_16x16x32_bf16 v[20:23], v[144:147], v[136:139], v[20:23]
    ds_read_b128 v[92:95], v5 offset:17408
    ds_read_b128 v[96:99], v5 offset:18432
    v_mfma_f32_16x16x32_bf16 v[24:27], v[144:147], v[140:143], v[24:27]
    ds_read_b64_tr_b16 v[100:101], v8 offset:25600
    ds_read_b64_tr_b16 v[102:103], v8 offset:27904
    v_mfma_f32_16x16x32_bf16 v[28:31], v[148:151], v[136:139], v[28:31]
    ds_read_b64_tr_b16 v[104:105], v8 offset:25632
    v_mfma_f32_16x16x32_bf16 v[32:35], v[148:151], v[140:143], v[32:35]
    ds_read_b64_tr_b16 v[106:107], v8 offset:27936
    v_mfma_f32_16x16x32_bf16 v[36:39], v[152:155], v[136:139], v[36:39]
    ds_read_b64_tr_b16 v[108:109], v8 offset:25664
    v_mfma_f32_16x16x32_bf16 v[40:43], v[152:155], v[140:143], v[40:43]
    ds_read_b64_tr_b16 v[110:111], v8 offset:27968
    v_mfma_f32_16x16x32_bf16 v[44:47], v[156:159], v[136:139], v[44:47]
    ds_read_b64_tr_b16 v[112:113], v8 offset:25696
    v_mfma_f32_16x16x32_bf16 v[48:51], v[156:159], v[140:143], v[48:51]
    ds_read_b64_tr_b16 v[114:115], v8 offset:28000
    v_mfma_f32_16x16x32_bf16 v[52:55], v[160:163], v[136:139], v[52:55]
    ds_read_b64_tr_b16 v[116:117], v8 offset:25728
    v_mfma_f32_16x16x32_bf16 v[56:59], v[160:163], v[140:143], v[56:59]
    ds_read_b64_tr_b16 v[118:119], v8 offset:28032
    v_mfma_f32_16x16x32_bf16 v[60:63], v[164:167], v[136:139], v[60:63]
    ds_read_b64_tr_b16 v[120:121], v8 offset:25760
    v_mfma_f32_16x16x32_bf16 v[64:67], v[164:167], v[140:143], v[64:67]
    ds_read_b64_tr_b16 v[122:123], v8 offset:28064
    v_mfma_f32_16x16x32_bf16 v[68:71], v[168:171], v[136:139], v[68:71]
    ds_read_b64_tr_b16 v[124:125], v8 offset:25792
    v_mfma_f32_16x16x32_bf16 v[72:75], v[168:171], v[140:143], v[72:75]
    ds_read_b64_tr_b16 v[126:127], v8 offset:28096
    v_mfma_f32_16x16x32_bf16 v[76:79], v[172:175], v[136:139], v[76:79]
    ds_read_b64_tr_b16 v[128:129], v8 offset:25824
    v_mfma_f32_16x16x32_bf16 v[80:83], v[172:175], v[140:143], v[80:83]
    ds_read_b64_tr_b16 v[130:131], v8 offset:28128
    v_mfma_f32_16x16x32_bf16 v[84:87], v[176:179], v[136:139], v[84:87]
    ds_read_b64_tr_b16 v[132:133], v8 offset:25856
    v_mfma_f32_16x16x32_bf16 v[88:91], v[176:179], v[140:143], v[88:91]
    ds_read_b64_tr_b16 v[134:135], v8 offset:28160
    s_waitcnt lgkmcnt(0)
    s_barrier
    v_mfma_f32_16x16x32_bf16 v[20:23], v[100:103], v[92:95], v[20:23]
    ds_read_b128 v[136:139], v5 offset:34816
    ds_read_b128 v[140:143], v5 offset:35840
    v_mfma_f32_16x16x32_bf16 v[24:27], v[100:103], v[96:99], v[24:27]
    ds_read_b64_tr_b16 v[144:145], v8 offset:43008
    ds_read_b64_tr_b16 v[146:147], v8 offset:45312
    v_mfma_f32_16x16x32_bf16 v[28:31], v[104:107], v[92:95], v[28:31]
    ds_read_b64_tr_b16 v[148:149], v8 offset:43040
    v_mfma_f32_16x16x32_bf16 v[32:35], v[104:107], v[96:99], v[32:35]
    ds_read_b64_tr_b16 v[150:151], v8 offset:45344
    v_mfma_f32_16x16x32_bf16 v[36:39], v[108:111], v[92:95], v[36:39]
    ds_read_b64_tr_b16 v[152:153], v8 offset:43072
    v_mfma_f32_16x16x32_bf16 v[40:43], v[108:111], v[96:99], v[40:43]
    ds_read_b64_tr_b16 v[154:155], v8 offset:45376
    v_mfma_f32_16x16x32_bf16 v[44:47], v[112:115], v[92:95], v[44:47]
    ds_read_b64_tr_b16 v[156:157], v8 offset:43104
    v_mfma_f32_16x16x32_bf16 v[48:51], v[112:115], v[96:99], v[48:51]
    ds_read_b64_tr_b16 v[158:159], v8 offset:45408
    v_mfma_f32_16x16x32_bf16 v[52:55], v[116:119], v[92:95], v[52:55]
    ds_read_b64_tr_b16 v[160:161], v8 offset:43136
    v_mfma_f32_16x16x32_bf16 v[56:59], v[116:119], v[96:99], v[56:59]
    ds_read_b64_tr_b16 v[162:163], v8 offset:45440
    v_mfma_f32_16x16x32_bf16 v[60:63], v[120:123], v[92:95], v[60:63]
    ds_read_b64_tr_b16 v[164:165], v8 offset:43168
    v_mfma_f32_16x16x32_bf16 v[64:67], v[120:123], v[96:99], v[64:67]
    ds_read_b64_tr_b16 v[166:167], v8 offset:45472
    v_mfma_f32_16x16x32_bf16 v[68:71], v[124:127], v[92:95], v[68:71]
    ds_read_b64_tr_b16 v[168:169], v8 offset:43200
    v_mfma_f32_16x16x32_bf16 v[72:75], v[124:127], v[96:99], v[72:75]
    ds_read_b64_tr_b16 v[170:171], v8 offset:45504
    v_mfma_f32_16x16x32_bf16 v[76:79], v[128:131], v[92:95], v[76:79]
    ds_read_b64_tr_b16 v[172:173], v8 offset:43232
    v_mfma_f32_16x16x32_bf16 v[80:83], v[128:131], v[96:99], v[80:83]
    ds_read_b64_tr_b16 v[174:175], v8 offset:45536
    v_mfma_f32_16x16x32_bf16 v[84:87], v[132:135], v[92:95], v[84:87]
    ds_read_b64_tr_b16 v[176:177], v8 offset:43264
    v_mfma_f32_16x16x32_bf16 v[88:91], v[132:135], v[96:99], v[88:91]
    ds_read_b64_tr_b16 v[178:179], v8 offset:45568
    s_waitcnt lgkmcnt(0)
    s_cmp_eq_u32 s21, 0
    s_cbranch_scc1 g1_q_32
    v_mfma_f32_16x16x32_bf16 v[20:23], v[144:147], v[136:139], v[20:23]
    v_mfma_f32_16x16x32_bf16 v[24:27], v[144:147], v[140:143], v[24:27]
    v_mfma_f32_16x16x32_bf16 v[28:31], v[148:151], v[136:139], v[28:31]
    v_mfma_f32_16x16x32_bf16 v[32:35], v[148:151], v[140:143], v[32:35]
    v_mfma_f32_16x16x32_bf16 v[36:39], v[152:155], v[136:139], v[36:39]
    s_nop 3
    v_cvt_pk_bf16_f32 v20, v20, v21
    v_cvt_pk_bf16_f32 v21, v22, v23
    ds_write_b64 v10, v[20:21] offset:0
    v_mfma_f32_16x16x32_bf16 v[40:43], v[152:155], v[140:143], v[40:43]
    v_cvt_pk_bf16_f32 v24, v24, v25
    v_cvt_pk_bf16_f32 v25, v26, v27
    ds_write_b64 v10, v[24:25] offset:4736
    v_mfma_f32_16x16x32_bf16 v[44:47], v[156:159], v[136:139], v[44:47]
    v_cvt_pk_bf16_f32 v28, v28, v29
    v_cvt_pk_bf16_f32 v29, v30, v31
    ds_write_b64 v10, v[28:29] offset:32
    v_mfma_f32_16x16x32_bf16 v[48:51], v[156:159], v[140:143], v[48:51]
    v_cvt_pk_bf16_f32 v32, v32, v33
    v_cvt_pk_bf16_f32 v33, v34, v35
    ds_write_b64 v10, v[32:33] offset:4768
    v_mfma_f32_16x16x32_bf16 v[52:55], v[160:163], v[136:139], v[52:55]
    v_cvt_pk_bf16_f32 v36, v36, v37
    v_cvt_pk_bf16_f32 v37, v38, v39
    ds_write_b64 v10, v[36:37] offset:64
    v_mfma_f32_16x16x32_bf16 v[56:59], v[160:163], v[140:143], v[56:59]
    v_cvt_pk_bf16_f32 v40, v40, v41
    v_cvt_pk_bf16_f32 v41, v42, v43
    ds_write_b64 v10, v[40:41] offset:4800
    v_mfma_f32_16x16x32_bf16 v[60:63], v[164:167], v[136:139], v[60:63]
    v_cvt_pk_bf16_f32 v44, v44, v45
    v_cvt_pk_bf16_f32 v45, v46, v47
    ds_write_b64 v10, v[44:45] offset:96
    v_mfma_f32_16x16x32_bf16 v[64:67], v[164:167], v[140:143], v[64:67]
    v_cvt_pk_bf16_f32 v48, v48, v49
    v_cvt_pk_bf16_f32 v49, v50, v51
    ds_write_b64 v10, v[48:49] offset:4832
    v_mfma_f32_16x16x32_bf16 v[68:71], v[168:171], v[136:139], v[68:71]
    v_cvt_pk_bf16_f32 v52, v52, v53
    v_cvt_pk_bf16_f32 v53, v54, v55
    ds_write_b64 v10, v[52:53] offset:128
    v_mfma_f32_16x16x32_bf16 v[72:75], v[168:171], v[140:143], v[72:75]
    v_cvt_pk_bf16_f32 v56, v56, v57
    v_cvt_pk_bf16_f32 v57, v58, v59
    ds_write_b64 v10, v[56:57] offset:4864
    v_mfma_f32_16x16x32_bf16 v[76:79], v[172:175], v[136:139], v[76:79]
    v_cvt_pk_bf16_f32 v60, v60, v61
    v_cvt_pk_bf16_f32 v61, v62, v63
    ds_write_b64 v10, v[60:61] offset:160
    v_mfma_f32_16x16x32_bf16 v[80:83], v[172:175], v[140:143], v[80:83]
    v_cvt_pk_bf16_f32 v64, v64, v65
    v_cvt_pk_bf16_f32 v65, v66, v67
    ds_write_b64 v10, v[64:65] offset:4896
    v_mfma_f32_16x16x32_bf16 v[84:87], v[176:179], v[136:139], v[84:87]
    v_cvt_pk_bf16_f32 v68, v68, v69
    v_cvt_pk_bf16_f32 v69, v70, v71
    ds_write_b64 v10, v[68:69] offset:192
    v_mfma_f32_16x16x32_bf16 v[88:91], v[176:179], v[140:143], v[88:91]
    v_cvt_pk_bf16_f32 v72, v72, v73
    v_cvt_pk_bf16_f32 v73, v74, v75
    ds_write_b64 v10, v[72:73] offset:4928
    v_cvt_pk_bf16_f32 v76, v76, v77
    v_cvt_pk_bf16_f32 v77, v78, v79
    ds_write_b64 v10, v[76:77] offset:224
    v_cvt_pk_bf16_f32 v80, v80, v81
    v_cvt_pk_bf16_f32 v81, v82, v83
    ds_write_b64 v10, v[80:81] offset:4960
    v_cvt_pk_bf16_f32 v84, v84, v85
    v_cvt_pk_bf16_f32 v85, v86, v87
    ds_write_b64 v10, v[84:85] offset:256
    v_cvt_pk_bf16_f32 v88, v88, v89
    v_cvt_pk_bf16_f32 v89, v90, v91
    ds_write_b64 v10, v[88:89] offset:4992
    s_branch g1_z_33
g1_q_32:
    s_mov_b32 s30, 0x3eae1a93
    v_mfma_f32_16x16x32_bf16 v[20:23], v[144:147], v[136:139], v[20:23]
    v_mfma_f32_16x16x32_bf16 v[24:27], v[144:147], v[140:143], v[24:27]
    v_mfma_f32_16x16x32_bf16 v[28:31], v[148:151], v[136:139], v[28:31]
    v_mfma_f32_16x16x32_bf16 v[32:35], v[148:151], v[140:143], v[32:35]
    v_mfma_f32_16x16x32_bf16 v[36:39], v[152:155], v[136:139], v[36:39]
    s_nop 3
    v_pk_mul_f32 v[20:21], v[20:21], s[30:31] op_sel_hi:[1,0]
    v_pk_mul_f32 v[22:23], v[22:23], s[30:31] op_sel_hi:[1,0]
    v_cvt_pk_bf16_f32 v20, v20, v21
    v_cvt_pk_bf16_f32 v21, v22, v23
    ds_write_b64 v10, v[20:21] offset:0
    v_mfma_f32_16x16x32_bf16 v[40:43], v[152:155], v[140:143], v[40:43]
    v_pk_mul_f32 v[24:25], v[24:25], s[30:31] op_sel_hi:[1,0]
    v_pk_mul_f32 v[26:27], v[26:27], s[30:31] op_sel_hi:[1,0]
    v_cvt_pk_bf16_f32 v24, v24, v25
    v_cvt_pk_bf16_f32 v25, v26, v27
    ds_write_b64 v10, v[24:25] offset:4736
    v_mfma_f32_16x16x32_bf16 v[44:47], v[156:159], v[136:139], v[44:47]
    v_pk_mul_f32 v[28:29], v[28:29], s[30:31] op_sel_hi:[1,0]
    v_pk_mul_f32 v[30:31], v[30:31], s[30:31] op_sel_hi:[1,0]
    v_cvt_pk_bf16_f32 v28, v28, v29
    v_cvt_pk_bf16_f32 v29, v30, v31
    ds_write_b64 v10, v[28:29] offset:32
    v_mfma_f32_16x16x32_bf16 v[48:51], v[156:159], v[140:143], v[48:51]
    v_pk_mul_f32 v[32:33], v[32:33], s[30:31] op_sel_hi:[1,0]
    v_pk_mul_f32 v[34:35], v[34:35], s[30:31] op_sel_hi:[1,0]
    v_cvt_pk_bf16_f32 v32, v32, v33
    v_cvt_pk_bf16_f32 v33, v34, v35
    ds_write_b64 v10, v[32:33] offset:4768
    v_mfma_f32_16x16x32_bf16 v[52:55], v[160:163], v[136:139], v[52:55]
    v_pk_mul_f32 v[36:37], v[36:37], s[30:31] op_sel_hi:[1,0]
    v_pk_mul_f32 v[38:39], v[38:39], s[30:31] op_sel_hi:[1,0]
    v_cvt_pk_bf16_f32 v36, v36, v37
    v_cvt_pk_bf16_f32 v37, v38, v39
    ds_write_b64 v10, v[36:37] offset:64
    v_mfma_f32_16x16x32_bf16 v[56:59], v[160:163], v[140:143], v[56:59]
    v_pk_mul_f32 v[40:41], v[40:41], s[30:31] op_sel_hi:[1,0]
    v_pk_mul_f32 v[42:43], v[42:43], s[30:31] op_sel_hi:[1,0]
    v_cvt_pk_bf16_f32 v40, v40, v41
    v_cvt_pk_bf16_f32 v41, v42, v43
    ds_write_b64 v10, v[40:41] offset:4800
    v_mfma_f32_16x16x32_bf16 v[60:63], v[164:167], v[136:139], v[60:63]
    v_pk_mul_f32 v[44:45], v[44:45], s[30:31] op_sel_hi:[1,0]
    v_pk_mul_f32 v[46:47], v[46:47], s[30:31] op_sel_hi:[1,0]
    v_cvt_pk_bf16_f32 v44, v44, v45
    v_cvt_pk_bf16_f32 v45, v46, v47
    ds_write_b64 v10, v[44:45] offset:96
    v_mfma_f32_16x16x32_bf16 v[64:67], v[164:167], v[140:143], v[64:67]
    v_pk_mul_f32 v[48:49], v[48:49], s[30:31] op_sel_hi:[1,0]
    v_pk_mul_f32 v[50:51], v[50:51], s[30:31] op_sel_hi:[1,0]
    v_cvt_pk_bf16_f32 v48, v48, v49
    v_cvt_pk_bf16_f32 v49, v50, v51
    ds_write_b64 v10, v[48:49] offset:4832
    v_mfma_f32_16x16x32_bf16 v[68:71], v[168:171], v[136:139], v[68:71]
    v_pk_mul_f32 v[52:53], v[52:53], s[30:31] op_sel_hi:[1,0]
    v_pk_mul_f32 v[54:55], v[54:55], s[30:31] op_sel_hi:[1,0]
    v_cvt_pk_bf16_f32 v52, v52, v53
    v_cvt_pk_bf16_f32 v53, v54, v55
    ds_write_b64 v10, v[52:53] offset:128
    v_mfma_f32_16x16x32_bf16 v[72:75], v[168:171], v[140:143], v[72:75]
    v_pk_mul_f32 v[56:57], v[56:57], s[30:31] op_sel_hi:[1,0]
    v_pk_mul_f32 v[58:59], v[58:59], s[30:31] op_sel_hi:[1,0]
    v_cvt_pk_bf16_f32 v56, v56, v57
    v_cvt_pk_bf16_f32 v57, v58, v59
    ds_write_b64 v10, v[56:57] offset:4864
    v_mfma_f32_16x16x32_bf16 v[76:79], v[172:175], v[136:139], v[76:79]
    v_pk_mul_f32 v[60:61], v[60:61], s[30:31] op_sel_hi:[1,0]
    v_pk_mul_f32 v[62:63], v[62:63], s[30:31] op_sel_hi:[1,0]
    v_cvt_pk_bf16_f32 v60, v60, v61
    v_cvt_pk_bf16_f32 v61, v62, v63
    ds_write_b64 v10, v[60:61] offset:160
    v_mfma_f32_16x16x32_bf16 v[80:83], v[172:175], v[140:143], v[80:83]
    v_pk_mul_f32 v[64:65], v[64:65], s[30:31] op_sel_hi:[1,0]
    v_pk_mul_f32 v[66:67], v[66:67], s[30:31] op_sel_hi:[1,0]
    v_cvt_pk_bf16_f32 v64, v64, v65
    v_cvt_pk_bf16_f32 v65, v66, v67
    ds_write_b64 v10, v[64:65] offset:4896
    v_mfma_f32_16x16x32_bf16 v[84:87], v[176:179], v[136:139], v[84:87]
    v_pk_mul_f32 v[68:69], v[68:69], s[30:31] op_sel_hi:[1,0]
    v_pk_mul_f32 v[70:71], v[70:71], s[30:31] op_sel_hi:[1,0]
    v_cvt_pk_bf16_f32 v68, v68, v69
    v_cvt_pk_bf16_f32 v69, v70, v71
    ds_write_b64 v10, v[68:69] offset:192
    v_mfma_f32_16x16x32_bf16 v[88:91], v[176:179], v[140:143], v[88:91]
    v_pk_mul_f32 v[72:73], v[72:73], s[30:31] op_sel_hi:[1,0]
    v_pk_mul_f32 v[74:75], v[74:75], s[30:31] op_sel_hi:[1,0]
    v_cvt_pk_bf16_f32 v72, v72, v73
    v_cvt_pk_bf16_f32 v73, v74, v75
    ds_write_b64 v10, v[72:73] offset:4928
    v_pk_mul_f32 v[76:77], v[76:77], s[30:31] op_sel_hi:[1,0]
    v_pk_mul_f32 v[78:79], v[78:79], s[30:31] op_sel_hi:[1,0]
    v_cvt_pk_bf16_f32 v76, v76, v77
    v_cvt_pk_bf16_f32 v77, v78, v79
    ds_write_b64 v10, v[76:77] offset:224
    v_pk_mul_f32 v[80:81], v[80:81], s[30:31] op_sel_hi:[1,0]
    v_pk_mul_f32 v[82:83], v[82:83], s[30:31] op_sel_hi:[1,0]
    v_cvt_pk_bf16_f32 v80, v80, v81
    v_cvt_pk_bf16_f32 v81, v82, v83
    ds_write_b64 v10, v[80:81] offset:4960
    v_pk_mul_f32 v[84:85], v[84:85], s[30:31] op_sel_hi:[1,0]
    v_pk_mul_f32 v[86:87], v[86:87], s[30:31] op_sel_hi:[1,0]
    v_cvt_pk_bf16_f32 v84, v84, v85
    v_cvt_pk_bf16_f32 v85, v86, v87
    ds_write_b64 v10, v[84:85] offset:256
    v_pk_mul_f32 v[88:89], v[88:89], s[30:31] op_sel_hi:[1,0]
    v_pk_mul_f32 v[90:91], v[90:91], s[30:31] op_sel_hi:[1,0]
    v_cvt_pk_bf16_f32 v88, v88, v89
    v_cvt_pk_bf16_f32 v89, v90, v91
    ds_write_b64 v10, v[88:89] offset:4992
g1_z_33:
    s_branch qk_epi_4
qkv_v_31:
    v_mul_u32_u24 v12, 264, v3
    v_lshl_add_u32 v12, v2, 3, v12
    s_lshl_b32 s27, s17, 6
    s_add_u32 s27, s27, 0
    v_add_u32 v10, s27, v12
    s_barrier
    ds_read_b128 v[92:95], v4 offset:0
    ds_read_b128 v[96:99], v4 offset:1024
    ds_read_b64_tr_b16 v[100:101], v7 offset:8192
    ds_read_b64_tr_b16 v[102:103], v7 offset:10496
    ds_read_b64_tr_b16 v[104:105], v7 offset:8224
    ds_read_b64_tr_b16 v[106:107], v7 offset:10528
    ds_read_b64_tr_b16 v[108:109], v7 offset:8256
    ds_read_b64_tr_b16 v[110:111], v7 offset:10560
    ds_read_b64_tr_b16 v[112:113], v7 offset:8288
    ds_read_b64_tr_b16 v[114:115], v7 offset:10592
    ds_read_b64_tr_b16 v[116:117], v7 offset:8320
    ds_read_b64_tr_b16 v[118:119], v7 offset:10624
    ds_read_b64_tr_b16 v[120:121], v7 offset:8352
    ds_read_b64_tr_b16 v[122:123], v7 offset:10656
    ds_read_b64_tr_b16 v[124:125], v7 offset:8384
    ds_read_b64_tr_b16 v[126:127], v7 offset:10688
    ds_read_b64_tr_b16 v[128:129], v7 offset:8416
    ds_read_b64_tr_b16 v[130:131], v7 offset:10720
    ds_read_b64_tr_b16 v[132:133], v7 offset:8448
    ds_read_b64_tr_b16 v[134:135], v7 offset:10752
.p2align 6
    s_waitcnt lgkmcnt(0)
    s_barrier
    v_mfma_f32_16x16x32_bf16 v[20:23], v[92:95], v[100:103], 0
    ds_read_b128 v[136:139], v4 offset:17408
    ds_read_b128 v[140:143], v4 offset:18432
    v_mfma_f32_16x16x32_bf16 v[24:27], v[96:99], v[100:103], 0
    ds_read_b64_tr_b16 v[144:145], v7 offset:25600
    ds_read_b64_tr_b16 v[146:147], v7 offset:27904
    v_mfma_f32_16x16x32_bf16 v[28:31], v[92:95], v[104:107], 0
    ds_read_b64_tr_b16 v[148:149], v7 offset:25632
    v_mfma_f32_16x16x32_bf16 v[32:35], v[96:99], v[104:107], 0
    ds_read_b64_tr_b16 v[150:151], v7 offset:27936
    v_mfma_f32_16x16x32_bf16 v[36:39], v[92:95], v[108:111], 0
    ds_read_b64_tr_b16 v[152:153], v7 offset:25664
    v_mfma_f32_16x16x32_bf16 v[40:43], v[96:99], v[108:111], 0
    ds_read_b64_tr_b16 v[154:155], v7 offset:27968
    v_mfma_f32_16x16x32_bf16 v[44:47], v[92:95], v[112:115], 0
    ds_read_b64_tr_b16 v[156:157], v7 offset:25696
    v_mfma_f32_16x16x32_bf16 v[48:51], v[96:99], v[112:115], 0
    ds_read_b64_tr_b16 v[158:159], v7 offset:28000
    v_mfma_f32_16x16x32_bf16 v[52:55], v[92:95], v[116:119], 0
    ds_read_b64_tr_b16 v[160:161], v7 offset:25728
    v_mfma_f32_16x16x32_bf16 v[56:59], v[96:99], v[116:119], 0
    ds_read_b64_tr_b16 v[162:163], v7 offset:28032
    v_mfma_f32_16x16x32_bf16 v[60:63], v[92:95], v[120:123], 0
    ds_read_b64_tr_b16 v[164:165], v7 offset:25760
    v_mfma_f32_16x16x32_bf16 v[64:67], v[96:99], v[120:123], 0
    ds_read_b64_tr_b16 v[166:167], v7 offset:28064
    v_mfma_f32_16x16x32_bf16 v[68:71], v[92:95], v[124:127], 0
    ds_read_b64_tr_b16 v[168:169], v7 offset:25792
    v_mfma_f32_16x16x32_bf16 v[72:75], v[96:99], v[124:127], 0
    ds_read_b64_tr_b16 v[170:171], v7 offset:28096
    v_mfma_f32_16x16x32_bf16 v[76:79], v[92:95], v[128:131], 0
    ds_read_b64_tr_b16 v[172:173], v7 offset:25824
    v_mfma_f32_16x16x32_bf16 v[80:83], v[96:99], v[128:131], 0
    ds_read_b64_tr_b16 v[174:175], v7 offset:28128
    v_mfma_f32_16x16x32_bf16 v[84:87], v[92:95], v[132:135], 0
    ds_read_b64_tr_b16 v[176:177], v7 offset:25856
    v_mfma_f32_16x16x32_bf16 v[88:91], v[96:99], v[132:135], 0
    ds_read_b64_tr_b16 v[178:179], v7 offset:28160
    s_waitcnt lgkmcnt(0)
    s_barrier
    v_mfma_f32_16x16x32_bf16 v[20:23], v[136:139], v[144:147], v[20:23]
    ds_read_b128 v[92:95], v4 offset:34816
    ds_read_b128 v[96:99], v4 offset:35840
    v_mfma_f32_16x16x32_bf16 v[24:27], v[140:143], v[144:147], v[24:27]
    ds_read_b64_tr_b16 v[100:101], v7 offset:43008
    ds_read_b64_tr_b16 v[102:103], v7 offset:45312
    v_mfma_f32_16x16x32_bf16 v[28:31], v[136:139], v[148:151], v[28:31]
    ds_read_b64_tr_b16 v[104:105], v7 offset:43040
    v_mfma_f32_16x16x32_bf16 v[32:35], v[140:143], v[148:151], v[32:35]
    ds_read_b64_tr_b16 v[106:107], v7 offset:45344
    v_mfma_f32_16x16x32_bf16 v[36:39], v[136:139], v[152:155], v[36:39]
    ds_read_b64_tr_b16 v[108:109], v7 offset:43072
    v_mfma_f32_16x16x32_bf16 v[40:43], v[140:143], v[152:155], v[40:43]
    ds_read_b64_tr_b16 v[110:111], v7 offset:45376
    v_mfma_f32_16x16x32_bf16 v[44:47], v[136:139], v[156:159], v[44:47]
    ds_read_b64_tr_b16 v[112:113], v7 offset:43104
    v_mfma_f32_16x16x32_bf16 v[48:51], v[140:143], v[156:159], v[48:51]
    ds_read_b64_tr_b16 v[114:115], v7 offset:45408
    v_mfma_f32_16x16x32_bf16 v[52:55], v[136:139], v[160:163], v[52:55]
    ds_read_b64_tr_b16 v[116:117], v7 offset:43136
    v_mfma_f32_16x16x32_bf16 v[56:59], v[140:143], v[160:163], v[56:59]
    ds_read_b64_tr_b16 v[118:119], v7 offset:45440
    v_mfma_f32_16x16x32_bf16 v[60:63], v[136:139], v[164:167], v[60:63]
    ds_read_b64_tr_b16 v[120:121], v7 offset:43168
    v_mfma_f32_16x16x32_bf16 v[64:67], v[140:143], v[164:167], v[64:67]
    ds_read_b64_tr_b16 v[122:123], v7 offset:45472
    v_mfma_f32_16x16x32_bf16 v[68:71], v[136:139], v[168:171], v[68:71]
    ds_read_b64_tr_b16 v[124:125], v7 offset:43200
    v_mfma_f32_16x16x32_bf16 v[72:75], v[140:143], v[168:171], v[72:75]
    ds_read_b64_tr_b16 v[126:127], v7 offset:45504
    v_mfma_f32_16x16x32_bf16 v[76:79], v[136:139], v[172:175], v[76:79]
    ds_read_b64_tr_b16 v[128:129], v7 offset:43232
    v_mfma_f32_16x16x32_bf16 v[80:83], v[140:143], v[172:175], v[80:83]
    ds_read_b64_tr_b16 v[130:131], v7 offset:45536
    v_mfma_f32_16x16x32_bf16 v[84:87], v[136:139], v[176:179], v[84:87]
    ds_read_b64_tr_b16 v[132:133], v7 offset:43264
    v_mfma_f32_16x16x32_bf16 v[88:91], v[140:143], v[176:179], v[88:91]
    ds_read_b64_tr_b16 v[134:135], v7 offset:45568
    s_waitcnt lgkmcnt(0)
    s_barrier
    v_mfma_f32_16x16x32_bf16 v[20:23], v[92:95], v[100:103], v[20:23]
    ds_read_b128 v[136:139], v5 offset:0
    ds_read_b128 v[140:143], v5 offset:1024
    v_mfma_f32_16x16x32_bf16 v[24:27], v[96:99], v[100:103], v[24:27]
    ds_read_b64_tr_b16 v[144:145], v8 offset:8192
    ds_read_b64_tr_b16 v[146:147], v8 offset:10496
    v_mfma_f32_16x16x32_bf16 v[28:31], v[92:95], v[104:107], v[28:31]
    ds_read_b64_tr_b16 v[148:149], v8 offset:8224
    v_mfma_f32_16x16x32_bf16 v[32:35], v[96:99], v[104:107], v[32:35]
    ds_read_b64_tr_b16 v[150:151], v8 offset:10528
    v_mfma_f32_16x16x32_bf16 v[36:39], v[92:95], v[108:111], v[36:39]
    ds_read_b64_tr_b16 v[152:153], v8 offset:8256
    v_mfma_f32_16x16x32_bf16 v[40:43], v[96:99], v[108:111], v[40:43]
    ds_read_b64_tr_b16 v[154:155], v8 offset:10560
    v_mfma_f32_16x16x32_bf16 v[44:47], v[92:95], v[112:115], v[44:47]
    ds_read_b64_tr_b16 v[156:157], v8 offset:8288
    v_mfma_f32_16x16x32_bf16 v[48:51], v[96:99], v[112:115], v[48:51]
    ds_read_b64_tr_b16 v[158:159], v8 offset:10592
    v_mfma_f32_16x16x32_bf16 v[52:55], v[92:95], v[116:119], v[52:55]
    ds_read_b64_tr_b16 v[160:161], v8 offset:8320
    v_mfma_f32_16x16x32_bf16 v[56:59], v[96:99], v[116:119], v[56:59]
    ds_read_b64_tr_b16 v[162:163], v8 offset:10624
    v_mfma_f32_16x16x32_bf16 v[60:63], v[92:95], v[120:123], v[60:63]
    ds_read_b64_tr_b16 v[164:165], v8 offset:8352
    v_mfma_f32_16x16x32_bf16 v[64:67], v[96:99], v[120:123], v[64:67]
    ds_read_b64_tr_b16 v[166:167], v8 offset:10656
    v_mfma_f32_16x16x32_bf16 v[68:71], v[92:95], v[124:127], v[68:71]
    ds_read_b64_tr_b16 v[168:169], v8 offset:8384
    v_mfma_f32_16x16x32_bf16 v[72:75], v[96:99], v[124:127], v[72:75]
    ds_read_b64_tr_b16 v[170:171], v8 offset:10688
    v_mfma_f32_16x16x32_bf16 v[76:79], v[92:95], v[128:131], v[76:79]
    ds_read_b64_tr_b16 v[172:173], v8 offset:8416
    v_mfma_f32_16x16x32_bf16 v[80:83], v[96:99], v[128:131], v[80:83]
    ds_read_b64_tr_b16 v[174:175], v8 offset:10720
    v_mfma_f32_16x16x32_bf16 v[84:87], v[92:95], v[132:135], v[84:87]
    ds_read_b64_tr_b16 v[176:177], v8 offset:8448
    v_mfma_f32_16x16x32_bf16 v[88:91], v[96:99], v[132:135], v[88:91]
    ds_read_b64_tr_b16 v[178:179], v8 offset:10752
    s_waitcnt lgkmcnt(0)
    s_barrier
    v_mfma_f32_16x16x32_bf16 v[20:23], v[136:139], v[144:147], v[20:23]
    ds_read_b128 v[92:95], v5 offset:17408
    ds_read_b128 v[96:99], v5 offset:18432
    v_mfma_f32_16x16x32_bf16 v[24:27], v[140:143], v[144:147], v[24:27]
    ds_read_b64_tr_b16 v[100:101], v8 offset:25600
    ds_read_b64_tr_b16 v[102:103], v8 offset:27904
    v_mfma_f32_16x16x32_bf16 v[28:31], v[136:139], v[148:151], v[28:31]
    ds_read_b64_tr_b16 v[104:105], v8 offset:25632
    v_mfma_f32_16x16x32_bf16 v[32:35], v[140:143], v[148:151], v[32:35]
    ds_read_b64_tr_b16 v[106:107], v8 offset:27936
    v_mfma_f32_16x16x32_bf16 v[36:39], v[136:139], v[152:155], v[36:39]
    ds_read_b64_tr_b16 v[108:109], v8 offset:25664
    v_mfma_f32_16x16x32_bf16 v[40:43], v[140:143], v[152:155], v[40:43]
    ds_read_b64_tr_b16 v[110:111], v8 offset:27968
    v_mfma_f32_16x16x32_bf16 v[44:47], v[136:139], v[156:159], v[44:47]
    ds_read_b64_tr_b16 v[112:113], v8 offset:25696
    v_mfma_f32_16x16x32_bf16 v[48:51], v[140:143], v[156:159], v[48:51]
    ds_read_b64_tr_b16 v[114:115], v8 offset:28000
    v_mfma_f32_16x16x32_bf16 v[52:55], v[136:139], v[160:163], v[52:55]
    ds_read_b64_tr_b16 v[116:117], v8 offset:25728
    v_mfma_f32_16x16x32_bf16 v[56:59], v[140:143], v[160:163], v[56:59]
    ds_read_b64_tr_b16 v[118:119], v8 offset:28032
    v_mfma_f32_16x16x32_bf16 v[60:63], v[136:139], v[164:167], v[60:63]
    ds_read_b64_tr_b16 v[120:121], v8 offset:25760
    v_mfma_f32_16x16x32_bf16 v[64:67], v[140:143], v[164:167], v[64:67]
    ds_read_b64_tr_b16 v[122:123], v8 offset:28064
    v_mfma_f32_16x16x32_bf16 v[68:71], v[136:139], v[168:171], v[68:71]
    ds_read_b64_tr_b16 v[124:125], v8 offset:25792
    v_mfma_f32_16x16x32_bf16 v[72:75], v[140:143], v[168:171], v[72:75]
    ds_read_b64_tr_b16 v[126:127], v8 offset:28096
    v_mfma_f32_16x16x32_bf16 v[76:79], v[136:139], v[172:175], v[76:79]
    ds_read_b64_tr_b16 v[128:129], v8 offset:25824
    v_mfma_f32_16x16x32_bf16 v[80:83], v[140:143], v[172:175], v[80:83]
    ds_read_b64_tr_b16 v[130:131], v8 offset:28128
    v_mfma_f32_16x16x32_bf16 v[84:87], v[136:139], v[176:179], v[84:87]
    ds_read_b64_tr_b16 v[132:133], v8 offset:25856
    v_mfma_f32_16x16x32_bf16 v[88:91], v[140:143], v[176:179], v[88:91]
    ds_read_b64_tr_b16 v[134:135], v8 offset:28160
    s_waitcnt lgkmcnt(0)
    s_barrier
    v_mfma_f32_16x16x32_bf16 v[20:23], v[92:95], v[100:103], v[20:23]
    ds_read_b128 v[136:139], v5 offset:34816
    ds_read_b128 v[140:143], v5 offset:35840
    v_mfma_f32_16x16x32_bf16 v[24:27], v[96:99], v[100:103], v[24:27]
    ds_read_b64_tr_b16 v[144:145], v8 offset:43008
    ds_read_b64_tr_b16 v[146:147], v8 offset:45312
    v_mfma_f32_16x16x32_bf16 v[28:31], v[92:95], v[104:107], v[28:31]
    ds_read_b64_tr_b16 v[148:149], v8 offset:43040
    v_mfma_f32_16x16x32_bf16 v[32:35], v[96:99], v[104:107], v[32:35]
    ds_read_b64_tr_b16 v[150:151], v8 offset:45344
    v_mfma_f32_16x16x32_bf16 v[36:39], v[92:95], v[108:111], v[36:39]
    ds_read_b64_tr_b16 v[152:153], v8 offset:43072
    v_mfma_f32_16x16x32_bf16 v[40:43], v[96:99], v[108:111], v[40:43]
    ds_read_b64_tr_b16 v[154:155], v8 offset:45376
    v_mfma_f32_16x16x32_bf16 v[44:47], v[92:95], v[112:115], v[44:47]
    ds_read_b64_tr_b16 v[156:157], v8 offset:43104
    v_mfma_f32_16x16x32_bf16 v[48:51], v[96:99], v[112:115], v[48:51]
    ds_read_b64_tr_b16 v[158:159], v8 offset:45408
    v_mfma_f32_16x16x32_bf16 v[52:55], v[92:95], v[116:119], v[52:55]
    ds_read_b64_tr_b16 v[160:161], v8 offset:43136
    v_mfma_f32_16x16x32_bf16 v[56:59], v[96:99], v[116:119], v[56:59]
    ds_read_b64_tr_b16 v[162:163], v8 offset:45440
    v_mfma_f32_16x16x32_bf16 v[60:63], v[92:95], v[120:123], v[60:63]
    ds_read_b64_tr_b16 v[164:165], v8 offset:43168
    v_mfma_f32_16x16x32_bf16 v[64:67], v[96:99], v[120:123], v[64:67]
    ds_read_b64_tr_b16 v[166:167], v8 offset:45472
    v_mfma_f32_16x16x32_bf16 v[68:71], v[92:95], v[124:127], v[68:71]
    ds_read_b64_tr_b16 v[168:169], v8 offset:43200
    v_mfma_f32_16x16x32_bf16 v[72:75], v[96:99], v[124:127], v[72:75]
    ds_read_b64_tr_b16 v[170:171], v8 offset:45504
    v_mfma_f32_16x16x32_bf16 v[76:79], v[92:95], v[128:131], v[76:79]
    ds_read_b64_tr_b16 v[172:173], v8 offset:43232
    v_mfma_f32_16x16x32_bf16 v[80:83], v[96:99], v[128:131], v[80:83]
    ds_read_b64_tr_b16 v[174:175], v8 offset:45536
    v_mfma_f32_16x16x32_bf16 v[84:87], v[92:95], v[132:135], v[84:87]
    ds_read_b64_tr_b16 v[176:177], v8 offset:43264
    v_mfma_f32_16x16x32_bf16 v[88:91], v[96:99], v[132:135], v[88:91]
    ds_read_b64_tr_b16 v[178:179], v8 offset:45568
    s_waitcnt lgkmcnt(0)
    s_barrier
    v_mfma_f32_16x16x32_bf16 v[20:23], v[136:139], v[144:147], v[20:23]
    ds_read_b128 v[92:95], v4 offset:0
    ds_read_b128 v[96:99], v4 offset:1024
    v_mfma_f32_16x16x32_bf16 v[24:27], v[140:143], v[144:147], v[24:27]
    ds_read_b64_tr_b16 v[100:101], v7 offset:8192
    ds_read_b64_tr_b16 v[102:103], v7 offset:10496
    v_mfma_f32_16x16x32_bf16 v[28:31], v[136:139], v[148:151], v[28:31]
    ds_read_b64_tr_b16 v[104:105], v7 offset:8224
    v_mfma_f32_16x16x32_bf16 v[32:35], v[140:143], v[148:151], v[32:35]
    ds_read_b64_tr_b16 v[106:107], v7 offset:10528
    v_mfma_f32_16x16x32_bf16 v[36:39], v[136:139], v[152:155], v[36:39]
    ds_read_b64_tr_b16 v[108:109], v7 offset:8256
    v_mfma_f32_16x16x32_bf16 v[40:43], v[140:143], v[152:155], v[40:43]
    ds_read_b64_tr_b16 v[110:111], v7 offset:10560
    v_mfma_f32_16x16x32_bf16 v[44:47], v[136:139], v[156:159], v[44:47]
    ds_read_b64_tr_b16 v[112:113], v7 offset:8288
    v_mfma_f32_16x16x32_bf16 v[48:51], v[140:143], v[156:159], v[48:51]
    ds_read_b64_tr_b16 v[114:115], v7 offset:10592
    v_mfma_f32_16x16x32_bf16 v[52:55], v[136:139], v[160:163], v[52:55]
    ds_read_b64_tr_b16 v[116:117], v7 offset:8320
    v_mfma_f32_16x16x32_bf16 v[56:59], v[140:143], v[160:163], v[56:59]
    ds_read_b64_tr_b16 v[118:119], v7 offset:10624
    v_mfma_f32_16x16x32_bf16 v[60:63], v[136:139], v[164:167], v[60:63]
    ds_read_b64_tr_b16 v[120:121], v7 offset:8352
    v_mfma_f32_16x16x32_bf16 v[64:67], v[140:143], v[164:167], v[64:67]
    ds_read_b64_tr_b16 v[122:123], v7 offset:10656
    v_mfma_f32_16x16x32_bf16 v[68:71], v[136:139], v[168:171], v[68:71]
    ds_read_b64_tr_b16 v[124:125], v7 offset:8384
    v_mfma_f32_16x16x32_bf16 v[72:75], v[140:143], v[168:171], v[72:75]
    ds_read_b64_tr_b16 v[126:127], v7 offset:10688
    v_mfma_f32_16x16x32_bf16 v[76:79], v[136:139], v[172:175], v[76:79]
    ds_read_b64_tr_b16 v[128:129], v7 offset:8416
    v_mfma_f32_16x16x32_bf16 v[80:83], v[140:143], v[172:175], v[80:83]
    ds_read_b64_tr_b16 v[130:131], v7 offset:10720
    v_mfma_f32_16x16x32_bf16 v[84:87], v[136:139], v[176:179], v[84:87]
    ds_read_b64_tr_b16 v[132:133], v7 offset:8448
    v_mfma_f32_16x16x32_bf16 v[88:91], v[140:143], v[176:179], v[88:91]
    ds_read_b64_tr_b16 v[134:135], v7 offset:10752
    s_waitcnt lgkmcnt(0)
    s_barrier
    v_mfma_f32_16x16x32_bf16 v[20:23], v[92:95], v[100:103], v[20:23]
    ds_read_b128 v[136:139], v4 offset:17408
    ds_read_b128 v[140:143], v4 offset:18432
    v_mfma_f32_16x16x32_bf16 v[24:27], v[96:99], v[100:103], v[24:27]
    ds_read_b64_tr_b16 v[144:145], v7 offset:25600
    ds_read_b64_tr_b16 v[146:147], v7 offset:27904
    v_mfma_f32_16x16x32_bf16 v[28:31], v[92:95], v[104:107], v[28:31]
    ds_read_b64_tr_b16 v[148:149], v7 offset:25632
    v_mfma_f32_16x16x32_bf16 v[32:35], v[96:99], v[104:107], v[32:35]
    ds_read_b64_tr_b16 v[150:151], v7 offset:27936
    v_mfma_f32_16x16x32_bf16 v[36:39], v[92:95], v[108:111], v[36:39]
    ds_read_b64_tr_b16 v[152:153], v7 offset:25664
    v_mfma_f32_16x16x32_bf16 v[40:43], v[96:99], v[108:111], v[40:43]
    ds_read_b64_tr_b16 v[154:155], v7 offset:27968
    v_mfma_f32_16x16x32_bf16 v[44:47], v[92:95], v[112:115], v[44:47]
    ds_read_b64_tr_b16 v[156:157], v7 offset:25696
    v_mfma_f32_16x16x32_bf16 v[48:51], v[96:99], v[112:115], v[48:51]
    ds_read_b64_tr_b16 v[158:159], v7 offset:28000
    v_mfma_f32_16x16x32_bf16 v[52:55], v[92:95], v[116:119], v[52:55]
    ds_read_b64_tr_b16 v[160:161], v7 offset:25728
    v_mfma_f32_16x16x32_bf16 v[56:59], v[96:99], v[116:119], v[56:59]
    ds_read_b64_tr_b16 v[162:163], v7 offset:28032
    v_mfma_f32_16x16x32_bf16 v[60:63], v[92:95], v[120:123], v[60:63]
    ds_read_b64_tr_b16 v[164:165], v7 offset:25760
    v_mfma_f32_16x16x32_bf16 v[64:67], v[96:99], v[120:123], v[64:67]
    ds_read_b64_tr_b16 v[166:167], v7 offset:28064
    v_mfma_f32_16x16x32_bf16 v[68:71], v[92:95], v[124:127], v[68:71]
    ds_read_b64_tr_b16 v[168:169], v7 offset:25792
    v_mfma_f32_16x16x32_bf16 v[72:75], v[96:99], v[124:127], v[72:75]
    ds_read_b64_tr_b16 v[170:171], v7 offset:28096
    v_mfma_f32_16x16x32_bf16 v[76:79], v[92:95], v[128:131], v[76:79]
    ds_read_b64_tr_b16 v[172:173], v7 offset:25824
    v_mfma_f32_16x16x32_bf16 v[80:83], v[96:99], v[128:131], v[80:83]
    ds_read_b64_tr_b16 v[174:175], v7 offset:28128
    v_mfma_f32_16x16x32_bf16 v[84:87], v[92:95], v[132:135], v[84:87]
    ds_read_b64_tr_b16 v[176:177], v7 offset:25856
    v_mfma_f32_16x16x32_bf16 v[88:91], v[96:99], v[132:135], v[88:91]
    ds_read_b64_tr_b16 v[178:179], v7 offset:28160
    s_waitcnt lgkmcnt(0)
    s_barrier
    v_mfma_f32_16x16x32_bf16 v[20:23], v[136:139], v[144:147], v[20:23]
    ds_read_b128 v[92:95], v4 offset:34816
    ds_read_b128 v[96:99], v4 offset:35840
    v_mfma_f32_16x16x32_bf16 v[24:27], v[140:143], v[144:147], v[24:27]
    ds_read_b64_tr_b16 v[100:101], v7 offset:43008
    ds_read_b64_tr_b16 v[102:103], v7 offset:45312
    v_mfma_f32_16x16x32_bf16 v[28:31], v[136:139], v[148:151], v[28:31]
    ds_read_b64_tr_b16 v[104:105], v7 offset:43040
    v_mfma_f32_16x16x32_bf16 v[32:35], v[140:143], v[148:151], v[32:35]
    ds_read_b64_tr_b16 v[106:107], v7 offset:45344
    v_mfma_f32_16x16x32_bf16 v[36:39], v[136:139], v[152:155], v[36:39]
    ds_read_b64_tr_b16 v[108:109], v7 offset:43072
    v_mfma_f32_16x16x32_bf16 v[40:43], v[140:143], v[152:155], v[40:43]
    ds_read_b64_tr_b16 v[110:111], v7 offset:45376
    v_mfma_f32_16x16x32_bf16 v[44:47], v[136:139], v[156:159], v[44:47]
    ds_read_b64_tr_b16 v[112:113], v7 offset:43104
    v_mfma_f32_16x16x32_bf16 v[48:51], v[140:143], v[156:159], v[48:51]
    ds_read_b64_tr_b16 v[114:115], v7 offset:45408
    v_mfma_f32_16x16x32_bf16 v[52:55], v[136:139], v[160:163], v[52:55]
    ds_read_b64_tr_b16 v[116:117], v7 offset:43136
    v_mfma_f32_16x16x32_bf16 v[56:59], v[140:143], v[160:163], v[56:59]
    ds_read_b64_tr_b16 v[118:119], v7 offset:45440
    v_mfma_f32_16x16x32_bf16 v[60:63], v[136:139], v[164:167], v[60:63]
    ds_read_b64_tr_b16 v[120:121], v7 offset:43168
    v_mfma_f32_16x16x32_bf16 v[64:67], v[140:143], v[164:167], v[64:67]
    ds_read_b64_tr_b16 v[122:123], v7 offset:45472
    v_mfma_f32_16x16x32_bf16 v[68:71], v[136:139], v[168:171], v[68:71]
    ds_read_b64_tr_b16 v[124:125], v7 offset:43200
    v_mfma_f32_16x16x32_bf16 v[72:75], v[140:143], v[168:171], v[72:75]
    ds_read_b64_tr_b16 v[126:127], v7 offset:45504
    v_mfma_f32_16x16x32_bf16 v[76:79], v[136:139], v[172:175], v[76:79]
    ds_read_b64_tr_b16 v[128:129], v7 offset:43232
    v_mfma_f32_16x16x32_bf16 v[80:83], v[140:143], v[172:175], v[80:83]
    ds_read_b64_tr_b16 v[130:131], v7 offset:45536
    v_mfma_f32_16x16x32_bf16 v[84:87], v[136:139], v[176:179], v[84:87]
    ds_read_b64_tr_b16 v[132:133], v7 offset:43264
    v_mfma_f32_16x16x32_bf16 v[88:91], v[140:143], v[176:179], v[88:91]
    ds_read_b64_tr_b16 v[134:135], v7 offset:45568
    s_waitcnt lgkmcnt(0)
    s_barrier
    v_mfma_f32_16x16x32_bf16 v[20:23], v[92:95], v[100:103], v[20:23]
    ds_read_b128 v[136:139], v5 offset:0
    ds_read_b128 v[140:143], v5 offset:1024
    v_mfma_f32_16x16x32_bf16 v[24:27], v[96:99], v[100:103], v[24:27]
    ds_read_b64_tr_b16 v[144:145], v8 offset:8192
    ds_read_b64_tr_b16 v[146:147], v8 offset:10496
    v_mfma_f32_16x16x32_bf16 v[28:31], v[92:95], v[104:107], v[28:31]
    ds_read_b64_tr_b16 v[148:149], v8 offset:8224
    v_mfma_f32_16x16x32_bf16 v[32:35], v[96:99], v[104:107], v[32:35]
    ds_read_b64_tr_b16 v[150:151], v8 offset:10528
    v_mfma_f32_16x16x32_bf16 v[36:39], v[92:95], v[108:111], v[36:39]
    ds_read_b64_tr_b16 v[152:153], v8 offset:8256
    v_mfma_f32_16x16x32_bf16 v[40:43], v[96:99], v[108:111], v[40:43]
    ds_read_b64_tr_b16 v[154:155], v8 offset:10560
    v_mfma_f32_16x16x32_bf16 v[44:47], v[92:95], v[112:115], v[44:47]
    ds_read_b64_tr_b16 v[156:157], v8 offset:8288
    v_mfma_f32_16x16x32_bf16 v[48:51], v[96:99], v[112:115], v[48:51]
    ds_read_b64_tr_b16 v[158:159], v8 offset:10592
    v_mfma_f32_16x16x32_bf16 v[52:55], v[92:95], v[116:119], v[52:55]
    ds_read_b64_tr_b16 v[160:161], v8 offset:8320
    v_mfma_f32_16x16x32_bf16 v[56:59], v[96:99], v[116:119], v[56:59]
    ds_read_b64_tr_b16 v[162:163], v8 offset:10624
    v_mfma_f32_16x16x32_bf16 v[60:63], v[92:95], v[120:123], v[60:63]
    ds_read_b64_tr_b16 v[164:165], v8 offset:8352
    v_mfma_f32_16x16x32_bf16 v[64:67], v[96:99], v[120:123], v[64:67]
    ds_read_b64_tr_b16 v[166:167], v8 offset:10656
    v_mfma_f32_16x16x32_bf16 v[68:71], v[92:95], v[124:127], v[68:71]
    ds_read_b64_tr_b16 v[168:169], v8 offset:8384
    v_mfma_f32_16x16x32_bf16 v[72:75], v[96:99], v[124:127], v[72:75]
    ds_read_b64_tr_b16 v[170:171], v8 offset:10688
    v_mfma_f32_16x16x32_bf16 v[76:79], v[92:95], v[128:131], v[76:79]
    ds_read_b64_tr_b16 v[172:173], v8 offset:8416
    v_mfma_f32_16x16x32_bf16 v[80:83], v[96:99], v[128:131], v[80:83]
    ds_read_b64_tr_b16 v[174:175], v8 offset:10720
    v_mfma_f32_16x16x32_bf16 v[84:87], v[92:95], v[132:135], v[84:87]
    ds_read_b64_tr_b16 v[176:177], v8 offset:8448
    v_mfma_f32_16x16x32_bf16 v[88:91], v[96:99], v[132:135], v[88:91]
    ds_read_b64_tr_b16 v[178:179], v8 offset:10752
    s_waitcnt lgkmcnt(0)
    s_barrier
    v_mfma_f32_16x16x32_bf16 v[20:23], v[136:139], v[144:147], v[20:23]
    ds_read_b128 v[92:95], v5 offset:17408
    ds_read_b128 v[96:99], v5 offset:18432
    v_mfma_f32_16x16x32_bf16 v[24:27], v[140:143], v[144:147], v[24:27]
    ds_read_b64_tr_b16 v[100:101], v8 offset:25600
    ds_read_b64_tr_b16 v[102:103], v8 offset:27904
    v_mfma_f32_16x16x32_bf16 v[28:31], v[136:139], v[148:151], v[28:31]
    ds_read_b64_tr_b16 v[104:105], v8 offset:25632
    v_mfma_f32_16x16x32_bf16 v[32:35], v[140:143], v[148:151], v[32:35]
    ds_read_b64_tr_b16 v[106:107], v8 offset:27936
    v_mfma_f32_16x16x32_bf16 v[36:39], v[136:139], v[152:155], v[36:39]
    ds_read_b64_tr_b16 v[108:109], v8 offset:25664
    v_mfma_f32_16x16x32_bf16 v[40:43], v[140:143], v[152:155], v[40:43]
    ds_read_b64_tr_b16 v[110:111], v8 offset:27968
    v_mfma_f32_16x16x32_bf16 v[44:47], v[136:139], v[156:159], v[44:47]
    ds_read_b64_tr_b16 v[112:113], v8 offset:25696
    v_mfma_f32_16x16x32_bf16 v[48:51], v[140:143], v[156:159], v[48:51]
    ds_read_b64_tr_b16 v[114:115], v8 offset:28000
    v_mfma_f32_16x16x32_bf16 v[52:55], v[136:139], v[160:163], v[52:55]
    ds_read_b64_tr_b16 v[116:117], v8 offset:25728
    v_mfma_f32_16x16x32_bf16 v[56:59], v[140:143], v[160:163], v[56:59]
    ds_read_b64_tr_b16 v[118:119], v8 offset:28032
    v_mfma_f32_16x16x32_bf16 v[60:63], v[136:139], v[164:167], v[60:63]
    ds_read_b64_tr_b16 v[120:121], v8 offset:25760
    v_mfma_f32_16x16x32_bf16 v[64:67], v[140:143], v[164:167], v[64:67]
    ds_read_b64_tr_b16 v[122:123], v8 offset:28064
    v_mfma_f32_16x16x32_bf16 v[68:71], v[136:139], v[168:171], v[68:71]
    ds_read_b64_tr_b16 v[124:125], v8 offset:25792
    v_mfma_f32_16x16x32_bf16 v[72:75], v[140:143], v[168:171], v[72:75]
    ds_read_b64_tr_b16 v[126:127], v8 offset:28096
    v_mfma_f32_16x16x32_bf16 v[76:79], v[136:139], v[172:175], v[76:79]
    ds_read_b64_tr_b16 v[128:129], v8 offset:25824
    v_mfma_f32_16x16x32_bf16 v[80:83], v[140:143], v[172:175], v[80:83]
    ds_read_b64_tr_b16 v[130:131], v8 offset:28128
    v_mfma_f32_16x16x32_bf16 v[84:87], v[136:139], v[176:179], v[84:87]
    ds_read_b64_tr_b16 v[132:133], v8 offset:25856
    v_mfma_f32_16x16x32_bf16 v[88:91], v[140:143], v[176:179], v[88:91]
    ds_read_b64_tr_b16 v[134:135], v8 offset:28160
    s_waitcnt lgkmcnt(0)
    s_barrier
    v_mfma_f32_16x16x32_bf16 v[20:23], v[92:95], v[100:103], v[20:23]
    ds_read_b128 v[136:139], v5 offset:34816
    ds_read_b128 v[140:143], v5 offset:35840
    v_mfma_f32_16x16x32_bf16 v[24:27], v[96:99], v[100:103], v[24:27]
    ds_read_b64_tr_b16 v[144:145], v8 offset:43008
    ds_read_b64_tr_b16 v[146:147], v8 offset:45312
    v_mfma_f32_16x16x32_bf16 v[28:31], v[92:95], v[104:107], v[28:31]
    ds_read_b64_tr_b16 v[148:149], v8 offset:43040
    v_mfma_f32_16x16x32_bf16 v[32:35], v[96:99], v[104:107], v[32:35]
    ds_read_b64_tr_b16 v[150:151], v8 offset:45344
    v_mfma_f32_16x16x32_bf16 v[36:39], v[92:95], v[108:111], v[36:39]
    ds_read_b64_tr_b16 v[152:153], v8 offset:43072
    v_mfma_f32_16x16x32_bf16 v[40:43], v[96:99], v[108:111], v[40:43]
    ds_read_b64_tr_b16 v[154:155], v8 offset:45376
    v_mfma_f32_16x16x32_bf16 v[44:47], v[92:95], v[112:115], v[44:47]
    ds_read_b64_tr_b16 v[156:157], v8 offset:43104
    v_mfma_f32_16x16x32_bf16 v[48:51], v[96:99], v[112:115], v[48:51]
    ds_read_b64_tr_b16 v[158:159], v8 offset:45408
    v_mfma_f32_16x16x32_bf16 v[52:55], v[92:95], v[116:119], v[52:55]
    ds_read_b64_tr_b16 v[160:161], v8 offset:43136
    v_mfma_f32_16x16x32_bf16 v[56:59], v[96:99], v[116:119], v[56:59]
    ds_read_b64_tr_b16 v[162:163], v8 offset:45440
    v_mfma_f32_16x16x32_bf16 v[60:63], v[92:95], v[120:123], v[60:63]
    ds_read_b64_tr_b16 v[164:165], v8 offset:43168
    v_mfma_f32_16x16x32_bf16 v[64:67], v[96:99], v[120:123], v[64:67]
    ds_read_b64_tr_b16 v[166:167], v8 offset:45472
    v_mfma_f32_16x16x32_bf16 v[68:71], v[92:95], v[124:127], v[68:71]
    ds_read_b64_tr_b16 v[168:169], v8 offset:43200
    v_mfma_f32_16x16x32_bf16 v[72:75], v[96:99], v[124:127], v[72:75]
    ds_read_b64_tr_b16 v[170:171], v8 offset:45504
    v_mfma_f32_16x16x32_bf16 v[76:79], v[92:95], v[128:131], v[76:79]
    ds_read_b64_tr_b16 v[172:173], v8 offset:43232
    v_mfma_f32_16x16x32_bf16 v[80:83], v[96:99], v[128:131], v[80:83]
    ds_read_b64_tr_b16 v[174:175], v8 offset:45536
    v_mfma_f32_16x16x32_bf16 v[84:87], v[92:95], v[132:135], v[84:87]
    ds_read_b64_tr_b16 v[176:177], v8 offset:43264
    v_mfma_f32_16x16x32_bf16 v[88:91], v[96:99], v[132:135], v[88:91]
    ds_read_b64_tr_b16 v[178:179], v8 offset:45568
    s_waitcnt lgkmcnt(0)
    s_barrier
    v_mfma_f32_16x16x32_bf16 v[20:23], v[136:139], v[144:147], v[20:23]
    ds_read_b128 v[92:95], v4 offset:0
    ds_read_b128 v[96:99], v4 offset:1024
    v_mfma_f32_16x16x32_bf16 v[24:27], v[140:143], v[144:147], v[24:27]
    ds_read_b64_tr_b16 v[100:101], v7 offset:8192
    ds_read_b64_tr_b16 v[102:103], v7 offset:10496
    v_mfma_f32_16x16x32_bf16 v[28:31], v[136:139], v[148:151], v[28:31]
    ds_read_b64_tr_b16 v[104:105], v7 offset:8224
    v_mfma_f32_16x16x32_bf16 v[32:35], v[140:143], v[148:151], v[32:35]
    ds_read_b64_tr_b16 v[106:107], v7 offset:10528
    v_mfma_f32_16x16x32_bf16 v[36:39], v[136:139], v[152:155], v[36:39]
    ds_read_b64_tr_b16 v[108:109], v7 offset:8256
    v_mfma_f32_16x16x32_bf16 v[40:43], v[140:143], v[152:155], v[40:43]
    ds_read_b64_tr_b16 v[110:111], v7 offset:10560
    v_mfma_f32_16x16x32_bf16 v[44:47], v[136:139], v[156:159], v[44:47]
    ds_read_b64_tr_b16 v[112:113], v7 offset:8288
    v_mfma_f32_16x16x32_bf16 v[48:51], v[140:143], v[156:159], v[48:51]
    ds_read_b64_tr_b16 v[114:115], v7 offset:10592
    v_mfma_f32_16x16x32_bf16 v[52:55], v[136:139], v[160:163], v[52:55]
    ds_read_b64_tr_b16 v[116:117], v7 offset:8320
    v_mfma_f32_16x16x32_bf16 v[56:59], v[140:143], v[160:163], v[56:59]
    ds_read_b64_tr_b16 v[118:119], v7 offset:10624
    v_mfma_f32_16x16x32_bf16 v[60:63], v[136:139], v[164:167], v[60:63]
    ds_read_b64_tr_b16 v[120:121], v7 offset:8352
    v_mfma_f32_16x16x32_bf16 v[64:67], v[140:143], v[164:167], v[64:67]
    ds_read_b64_tr_b16 v[122:123], v7 offset:10656
    v_mfma_f32_16x16x32_bf16 v[68:71], v[136:139], v[168:171], v[68:71]
    ds_read_b64_tr_b16 v[124:125], v7 offset:8384
    v_mfma_f32_16x16x32_bf16 v[72:75], v[140:143], v[168:171], v[72:75]
    ds_read_b64_tr_b16 v[126:127], v7 offset:10688
    v_mfma_f32_16x16x32_bf16 v[76:79], v[136:139], v[172:175], v[76:79]
    ds_read_b64_tr_b16 v[128:129], v7 offset:8416
    v_mfma_f32_16x16x32_bf16 v[80:83], v[140:143], v[172:175], v[80:83]
    ds_read_b64_tr_b16 v[130:131], v7 offset:10720
    v_mfma_f32_16x16x32_bf16 v[84:87], v[136:139], v[176:179], v[84:87]
    ds_read_b64_tr_b16 v[132:133], v7 offset:8448
    v_mfma_f32_16x16x32_bf16 v[88:91], v[140:143], v[176:179], v[88:91]
    ds_read_b64_tr_b16 v[134:135], v7 offset:10752
    s_waitcnt lgkmcnt(0)
    s_barrier
    v_mfma_f32_16x16x32_bf16 v[20:23], v[92:95], v[100:103], v[20:23]
    ds_read_b128 v[136:139], v4 offset:17408
    ds_read_b128 v[140:143], v4 offset:18432
    v_mfma_f32_16x16x32_bf16 v[24:27], v[96:99], v[100:103], v[24:27]
    ds_read_b64_tr_b16 v[144:145], v7 offset:25600
    ds_read_b64_tr_b16 v[146:147], v7 offset:27904
    v_mfma_f32_16x16x32_bf16 v[28:31], v[92:95], v[104:107], v[28:31]
    ds_read_b64_tr_b16 v[148:149], v7 offset:25632
    v_mfma_f32_16x16x32_bf16 v[32:35], v[96:99], v[104:107], v[32:35]
    ds_read_b64_tr_b16 v[150:151], v7 offset:27936
    v_mfma_f32_16x16x32_bf16 v[36:39], v[92:95], v[108:111], v[36:39]
    ds_read_b64_tr_b16 v[152:153], v7 offset:25664
    v_mfma_f32_16x16x32_bf16 v[40:43], v[96:99], v[108:111], v[40:43]
    ds_read_b64_tr_b16 v[154:155], v7 offset:27968
    v_mfma_f32_16x16x32_bf16 v[44:47], v[92:95], v[112:115], v[44:47]
    ds_read_b64_tr_b16 v[156:157], v7 offset:25696
    v_mfma_f32_16x16x32_bf16 v[48:51], v[96:99], v[112:115], v[48:51]
    ds_read_b64_tr_b16 v[158:159], v7 offset:28000
    v_mfma_f32_16x16x32_bf16 v[52:55], v[92:95], v[116:119], v[52:55]
    ds_read_b64_tr_b16 v[160:161], v7 offset:25728
    v_mfma_f32_16x16x32_bf16 v[56:59], v[96:99], v[116:119], v[56:59]
    ds_read_b64_tr_b16 v[162:163], v7 offset:28032
    v_mfma_f32_16x16x32_bf16 v[60:63], v[92:95], v[120:123], v[60:63]
    ds_read_b64_tr_b16 v[164:165], v7 offset:25760
    v_mfma_f32_16x16x32_bf16 v[64:67], v[96:99], v[120:123], v[64:67]
    ds_read_b64_tr_b16 v[166:167], v7 offset:28064
    v_mfma_f32_16x16x32_bf16 v[68:71], v[92:95], v[124:127], v[68:71]
    ds_read_b64_tr_b16 v[168:169], v7 offset:25792
    v_mfma_f32_16x16x32_bf16 v[72:75], v[96:99], v[124:127], v[72:75]
    ds_read_b64_tr_b16 v[170:171], v7 offset:28096
    v_mfma_f32_16x16x32_bf16 v[76:79], v[92:95], v[128:131], v[76:79]
    ds_read_b64_tr_b16 v[172:173], v7 offset:25824
    v_mfma_f32_16x16x32_bf16 v[80:83], v[96:99], v[128:131], v[80:83]
    ds_read_b64_tr_b16 v[174:175], v7 offset:28128
    v_mfma_f32_16x16x32_bf16 v[84:87], v[92:95], v[132:135], v[84:87]
    ds_read_b64_tr_b16 v[176:177], v7 offset:25856
    v_mfma_f32_16x16x32_bf16 v[88:91], v[96:99], v[132:135], v[88:91]
    ds_read_b64_tr_b16 v[178:179], v7 offset:28160
    s_waitcnt lgkmcnt(0)
    s_barrier
    v_mfma_f32_16x16x32_bf16 v[20:23], v[136:139], v[144:147], v[20:23]
    ds_read_b128 v[92:95], v4 offset:34816
    ds_read_b128 v[96:99], v4 offset:35840
    v_mfma_f32_16x16x32_bf16 v[24:27], v[140:143], v[144:147], v[24:27]
    ds_read_b64_tr_b16 v[100:101], v7 offset:43008
    ds_read_b64_tr_b16 v[102:103], v7 offset:45312
    v_mfma_f32_16x16x32_bf16 v[28:31], v[136:139], v[148:151], v[28:31]
    ds_read_b64_tr_b16 v[104:105], v7 offset:43040
    v_mfma_f32_16x16x32_bf16 v[32:35], v[140:143], v[148:151], v[32:35]
    ds_read_b64_tr_b16 v[106:107], v7 offset:45344
    v_mfma_f32_16x16x32_bf16 v[36:39], v[136:139], v[152:155], v[36:39]
    ds_read_b64_tr_b16 v[108:109], v7 offset:43072
    v_mfma_f32_16x16x32_bf16 v[40:43], v[140:143], v[152:155], v[40:43]
    ds_read_b64_tr_b16 v[110:111], v7 offset:45376
    v_mfma_f32_16x16x32_bf16 v[44:47], v[136:139], v[156:159], v[44:47]
    ds_read_b64_tr_b16 v[112:113], v7 offset:43104
    v_mfma_f32_16x16x32_bf16 v[48:51], v[140:143], v[156:159], v[48:51]
    ds_read_b64_tr_b16 v[114:115], v7 offset:45408
    v_mfma_f32_16x16x32_bf16 v[52:55], v[136:139], v[160:163], v[52:55]
    ds_read_b64_tr_b16 v[116:117], v7 offset:43136
    v_mfma_f32_16x16x32_bf16 v[56:59], v[140:143], v[160:163], v[56:59]
    ds_read_b64_tr_b16 v[118:119], v7 offset:45440
    v_mfma_f32_16x16x32_bf16 v[60:63], v[136:139], v[164:167], v[60:63]
    ds_read_b64_tr_b16 v[120:121], v7 offset:43168
    v_mfma_f32_16x16x32_bf16 v[64:67], v[140:143], v[164:167], v[64:67]
    ds_read_b64_tr_b16 v[122:123], v7 offset:45472
    v_mfma_f32_16x16x32_bf16 v[68:71], v[136:139], v[168:171], v[68:71]
    ds_read_b64_tr_b16 v[124:125], v7 offset:43200
    v_mfma_f32_16x16x32_bf16 v[72:75], v[140:143], v[168:171], v[72:75]
    ds_read_b64_tr_b16 v[126:127], v7 offset:45504
    v_mfma_f32_16x16x32_bf16 v[76:79], v[136:139], v[172:175], v[76:79]
    ds_read_b64_tr_b16 v[128:129], v7 offset:43232
    v_mfma_f32_16x16x32_bf16 v[80:83], v[140:143], v[172:175], v[80:83]
    ds_read_b64_tr_b16 v[130:131], v7 offset:45536
    v_mfma_f32_16x16x32_bf16 v[84:87], v[136:139], v[176:179], v[84:87]
    ds_read_b64_tr_b16 v[132:133], v7 offset:43264
    v_mfma_f32_16x16x32_bf16 v[88:91], v[140:143], v[176:179], v[88:91]
    ds_read_b64_tr_b16 v[134:135], v7 offset:45568
    s_waitcnt lgkmcnt(0)
    s_barrier
    v_mfma_f32_16x16x32_bf16 v[20:23], v[92:95], v[100:103], v[20:23]
    ds_read_b128 v[136:139], v5 offset:0
    ds_read_b128 v[140:143], v5 offset:1024
    v_mfma_f32_16x16x32_bf16 v[24:27], v[96:99], v[100:103], v[24:27]
    ds_read_b64_tr_b16 v[144:145], v8 offset:8192
    ds_read_b64_tr_b16 v[146:147], v8 offset:10496
    v_mfma_f32_16x16x32_bf16 v[28:31], v[92:95], v[104:107], v[28:31]
    ds_read_b64_tr_b16 v[148:149], v8 offset:8224
    v_mfma_f32_16x16x32_bf16 v[32:35], v[96:99], v[104:107], v[32:35]
    ds_read_b64_tr_b16 v[150:151], v8 offset:10528
    v_mfma_f32_16x16x32_bf16 v[36:39], v[92:95], v[108:111], v[36:39]
    ds_read_b64_tr_b16 v[152:153], v8 offset:8256
    v_mfma_f32_16x16x32_bf16 v[40:43], v[96:99], v[108:111], v[40:43]
    ds_read_b64_tr_b16 v[154:155], v8 offset:10560
    v_mfma_f32_16x16x32_bf16 v[44:47], v[92:95], v[112:115], v[44:47]
    ds_read_b64_tr_b16 v[156:157], v8 offset:8288
    v_mfma_f32_16x16x32_bf16 v[48:51], v[96:99], v[112:115], v[48:51]
    ds_read_b64_tr_b16 v[158:159], v8 offset:10592
    v_mfma_f32_16x16x32_bf16 v[52:55], v[92:95], v[116:119], v[52:55]
    ds_read_b64_tr_b16 v[160:161], v8 offset:8320
    v_mfma_f32_16x16x32_bf16 v[56:59], v[96:99], v[116:119], v[56:59]
    ds_read_b64_tr_b16 v[162:163], v8 offset:10624
    v_mfma_f32_16x16x32_bf16 v[60:63], v[92:95], v[120:123], v[60:63]
    ds_read_b64_tr_b16 v[164:165], v8 offset:8352
    v_mfma_f32_16x16x32_bf16 v[64:67], v[96:99], v[120:123], v[64:67]
    ds_read_b64_tr_b16 v[166:167], v8 offset:10656
    v_mfma_f32_16x16x32_bf16 v[68:71], v[92:95], v[124:127], v[68:71]
    ds_read_b64_tr_b16 v[168:169], v8 offset:8384
    v_mfma_f32_16x16x32_bf16 v[72:75], v[96:99], v[124:127], v[72:75]
    ds_read_b64_tr_b16 v[170:171], v8 offset:10688
    v_mfma_f32_16x16x32_bf16 v[76:79], v[92:95], v[128:131], v[76:79]
    ds_read_b64_tr_b16 v[172:173], v8 offset:8416
    v_mfma_f32_16x16x32_bf16 v[80:83], v[96:99], v[128:131], v[80:83]
    ds_read_b64_tr_b16 v[174:175], v8 offset:10720
    v_mfma_f32_16x16x32_bf16 v[84:87], v[92:95], v[132:135], v[84:87]
    ds_read_b64_tr_b16 v[176:177], v8 offset:8448
    v_mfma_f32_16x16x32_bf16 v[88:91], v[96:99], v[132:135], v[88:91]
    ds_read_b64_tr_b16 v[178:179], v8 offset:10752
    s_waitcnt lgkmcnt(0)
    s_barrier
    v_mfma_f32_16x16x32_bf16 v[20:23], v[136:139], v[144:147], v[20:23]
    ds_read_b128 v[92:95], v5 offset:17408
    ds_read_b128 v[96:99], v5 offset:18432
    v_mfma_f32_16x16x32_bf16 v[24:27], v[140:143], v[144:147], v[24:27]
    ds_read_b64_tr_b16 v[100:101], v8 offset:25600
    ds_read_b64_tr_b16 v[102:103], v8 offset:27904
    v_mfma_f32_16x16x32_bf16 v[28:31], v[136:139], v[148:151], v[28:31]
    ds_read_b64_tr_b16 v[104:105], v8 offset:25632
    v_mfma_f32_16x16x32_bf16 v[32:35], v[140:143], v[148:151], v[32:35]
    ds_read_b64_tr_b16 v[106:107], v8 offset:27936
    v_mfma_f32_16x16x32_bf16 v[36:39], v[136:139], v[152:155], v[36:39]
    ds_read_b64_tr_b16 v[108:109], v8 offset:25664
    v_mfma_f32_16x16x32_bf16 v[40:43], v[140:143], v[152:155], v[40:43]
    ds_read_b64_tr_b16 v[110:111], v8 offset:27968
    v_mfma_f32_16x16x32_bf16 v[44:47], v[136:139], v[156:159], v[44:47]
    ds_read_b64_tr_b16 v[112:113], v8 offset:25696
    v_mfma_f32_16x16x32_bf16 v[48:51], v[140:143], v[156:159], v[48:51]
    ds_read_b64_tr_b16 v[114:115], v8 offset:28000
    v_mfma_f32_16x16x32_bf16 v[52:55], v[136:139], v[160:163], v[52:55]
    ds_read_b64_tr_b16 v[116:117], v8 offset:25728
    v_mfma_f32_16x16x32_bf16 v[56:59], v[140:143], v[160:163], v[56:59]
    ds_read_b64_tr_b16 v[118:119], v8 offset:28032
    v_mfma_f32_16x16x32_bf16 v[60:63], v[136:139], v[164:167], v[60:63]
    ds_read_b64_tr_b16 v[120:121], v8 offset:25760
    v_mfma_f32_16x16x32_bf16 v[64:67], v[140:143], v[164:167], v[64:67]
    ds_read_b64_tr_b16 v[122:123], v8 offset:28064
    v_mfma_f32_16x16x32_bf16 v[68:71], v[136:139], v[168:171], v[68:71]
    ds_read_b64_tr_b16 v[124:125], v8 offset:25792
    v_mfma_f32_16x16x32_bf16 v[72:75], v[140:143], v[168:171], v[72:75]
    ds_read_b64_tr_b16 v[126:127], v8 offset:28096
    v_mfma_f32_16x16x32_bf16 v[76:79], v[136:139], v[172:175], v[76:79]
    ds_read_b64_tr_b16 v[128:129], v8 offset:25824
    v_mfma_f32_16x16x32_bf16 v[80:83], v[140:143], v[172:175], v[80:83]
    ds_read_b64_tr_b16 v[130:131], v8 offset:28128
    v_mfma_f32_16x16x32_bf16 v[84:87], v[136:139], v[176:179], v[84:87]
    ds_read_b64_tr_b16 v[132:133], v8 offset:25856
    v_mfma_f32_16x16x32_bf16 v[88:91], v[140:143], v[176:179], v[88:91]
    ds_read_b64_tr_b16 v[134:135], v8 offset:28160
    s_waitcnt lgkmcnt(0)
    s_barrier
    v_mfma_f32_16x16x32_bf16 v[20:23], v[92:95], v[100:103], v[20:23]
    ds_read_b128 v[136:139], v5 offset:34816
    ds_read_b128 v[140:143], v5 offset:35840
    v_mfma_f32_16x16x32_bf16 v[24:27], v[96:99], v[100:103], v[24:27]
    ds_read_b64_tr_b16 v[144:145], v8 offset:43008
    ds_read_b64_tr_b16 v[146:147], v8 offset:45312
    v_mfma_f32_16x16x32_bf16 v[28:31], v[92:95], v[104:107], v[28:31]
    ds_read_b64_tr_b16 v[148:149], v8 offset:43040
    v_mfma_f32_16x16x32_bf16 v[32:35], v[96:99], v[104:107], v[32:35]
    ds_read_b64_tr_b16 v[150:151], v8 offset:45344
    v_mfma_f32_16x16x32_bf16 v[36:39], v[92:95], v[108:111], v[36:39]
    ds_read_b64_tr_b16 v[152:153], v8 offset:43072
    v_mfma_f32_16x16x32_bf16 v[40:43], v[96:99], v[108:111], v[40:43]
    ds_read_b64_tr_b16 v[154:155], v8 offset:45376
    v_mfma_f32_16x16x32_bf16 v[44:47], v[92:95], v[112:115], v[44:47]
    ds_read_b64_tr_b16 v[156:157], v8 offset:43104
    v_mfma_f32_16x16x32_bf16 v[48:51], v[96:99], v[112:115], v[48:51]
    ds_read_b64_tr_b16 v[158:159], v8 offset:45408
    v_mfma_f32_16x16x32_bf16 v[52:55], v[92:95], v[116:119], v[52:55]
    ds_read_b64_tr_b16 v[160:161], v8 offset:43136
    v_mfma_f32_16x16x32_bf16 v[56:59], v[96:99], v[116:119], v[56:59]
    ds_read_b64_tr_b16 v[162:163], v8 offset:45440
    v_mfma_f32_16x16x32_bf16 v[60:63], v[92:95], v[120:123], v[60:63]
    ds_read_b64_tr_b16 v[164:165], v8 offset:43168
    v_mfma_f32_16x16x32_bf16 v[64:67], v[96:99], v[120:123], v[64:67]
    ds_read_b64_tr_b16 v[166:167], v8 offset:45472
    v_mfma_f32_16x16x32_bf16 v[68:71], v[92:95], v[124:127], v[68:71]
    ds_read_b64_tr_b16 v[168:169], v8 offset:43200
    v_mfma_f32_16x16x32_bf16 v[72:75], v[96:99], v[124:127], v[72:75]
    ds_read_b64_tr_b16 v[170:171], v8 offset:45504
    v_mfma_f32_16x16x32_bf16 v[76:79], v[92:95], v[128:131], v[76:79]
    ds_read_b64_tr_b16 v[172:173], v8 offset:43232
    v_mfma_f32_16x16x32_bf16 v[80:83], v[96:99], v[128:131], v[80:83]
    ds_read_b64_tr_b16 v[174:175], v8 offset:45536
    v_mfma_f32_16x16x32_bf16 v[84:87], v[92:95], v[132:135], v[84:87]
    ds_read_b64_tr_b16 v[176:177], v8 offset:43264
    v_mfma_f32_16x16x32_bf16 v[88:91], v[96:99], v[132:135], v[88:91]
    ds_read_b64_tr_b16 v[178:179], v8 offset:45568
    s_waitcnt lgkmcnt(0)
    v_mfma_f32_16x16x32_bf16 v[20:23], v[136:139], v[144:147], v[20:23]
    v_mfma_f32_16x16x32_bf16 v[24:27], v[140:143], v[144:147], v[24:27]
    v_mfma_f32_16x16x32_bf16 v[28:31], v[136:139], v[148:151], v[28:31]
    v_mfma_f32_16x16x32_bf16 v[32:35], v[140:143], v[148:151], v[32:35]
    v_mfma_f32_16x16x32_bf16 v[36:39], v[136:139], v[152:155], v[36:39]
    s_nop 3
    v_cvt_pk_bf16_f32 v20, v20, v21
    v_cvt_pk_bf16_f32 v21, v22, v23
    ds_write_b64 v10, v[20:21] offset:0
    v_mfma_f32_16x16x32_bf16 v[40:43], v[140:143], v[152:155], v[40:43]
    v_cvt_pk_bf16_f32 v24, v24, v25
    v_cvt_pk_bf16_f32 v25, v26, v27
    ds_write_b64 v10, v[24:25] offset:32
    v_mfma_f32_16x16x32_bf16 v[44:47], v[136:139], v[156:159], v[44:47]
    v_cvt_pk_bf16_f32 v28, v28, v29
    v_cvt_pk_bf16_f32 v29, v30, v31
    ds_write_b64 v10, v[28:29] offset:4224
    v_mfma_f32_16x16x32_bf16 v[48:51], v[140:143], v[156:159], v[48:51]
    v_cvt_pk_bf16_f32 v32, v32, v33
    v_cvt_pk_bf16_f32 v33, v34, v35
    ds_write_b64 v10, v[32:33] offset:4256
    v_mfma_f32_16x16x32_bf16 v[52:55], v[136:139], v[160:163], v[52:55]
    v_cvt_pk_bf16_f32 v36, v36, v37
    v_cvt_pk_bf16_f32 v37, v38, v39
    ds_write_b64 v10, v[36:37] offset:8448
    v_mfma_f32_16x16x32_bf16 v[56:59], v[140:143], v[160:163], v[56:59]
    v_cvt_pk_bf16_f32 v40, v40, v41
    v_cvt_pk_bf16_f32 v41, v42, v43
    ds_write_b64 v10, v[40:41] offset:8480
    v_mfma_f32_16x16x32_bf16 v[60:63], v[136:139], v[164:167], v[60:63]
    v_cvt_pk_bf16_f32 v44, v44, v45
    v_cvt_pk_bf16_f32 v45, v46, v47
    ds_write_b64 v10, v[44:45] offset:12672
    v_mfma_f32_16x16x32_bf16 v[64:67], v[140:143], v[164:167], v[64:67]
    v_cvt_pk_bf16_f32 v48, v48, v49
    v_cvt_pk_bf16_f32 v49, v50, v51
    ds_write_b64 v10, v[48:49] offset:12704
    v_mfma_f32_16x16x32_bf16 v[68:71], v[136:139], v[168:171], v[68:71]
    v_cvt_pk_bf16_f32 v52, v52, v53
    v_cvt_pk_bf16_f32 v53, v54, v55
    ds_write_b64 v10, v[52:53] offset:16896
    v_mfma_f32_16x16x32_bf16 v[72:75], v[140:143], v[168:171], v[72:75]
    v_cvt_pk_bf16_f32 v56, v56, v57
    v_cvt_pk_bf16_f32 v57, v58, v59
    ds_write_b64 v10, v[56:57] offset:16928
    v_mfma_f32_16x16x32_bf16 v[76:79], v[136:139], v[172:175], v[76:79]
    v_cvt_pk_bf16_f32 v60, v60, v61
    v_cvt_pk_bf16_f32 v61, v62, v63
    ds_write_b64 v10, v[60:61] offset:21120
    v_mfma_f32_16x16x32_bf16 v[80:83], v[140:143], v[172:175], v[80:83]
    v_cvt_pk_bf16_f32 v64, v64, v65
    v_cvt_pk_bf16_f32 v65, v66, v67
    ds_write_b64 v10, v[64:65] offset:21152
    v_mfma_f32_16x16x32_bf16 v[84:87], v[136:139], v[176:179], v[84:87]
    v_cvt_pk_bf16_f32 v68, v68, v69
    v_cvt_pk_bf16_f32 v69, v70, v71
    ds_write_b64 v10, v[68:69] offset:25344
    v_mfma_f32_16x16x32_bf16 v[88:91], v[140:143], v[176:179], v[88:91]
    v_cvt_pk_bf16_f32 v72, v72, v73
    v_cvt_pk_bf16_f32 v73, v74, v75
    ds_write_b64 v10, v[72:73] offset:25376
    v_cvt_pk_bf16_f32 v76, v76, v77
    v_cvt_pk_bf16_f32 v77, v78, v79
    ds_write_b64 v10, v[76:77] offset:29568
    v_cvt_pk_bf16_f32 v80, v80, v81
    v_cvt_pk_bf16_f32 v81, v82, v83
    ds_write_b64 v10, v[80:81] offset:29600
    v_cvt_pk_bf16_f32 v84, v84, v85
    v_cvt_pk_bf16_f32 v85, v86, v87
    ds_write_b64 v10, v[84:85] offset:33792
    v_cvt_pk_bf16_f32 v88, v88, v89
    v_cvt_pk_bf16_f32 v89, v90, v91
    ds_write_b64 v10, v[88:89] offset:33824
    s_branch v_epi_5
qk_epi_4:
    s_cmp_eq_u32 s21, 0
    s_mov_b32 s31, 2368
    s_cselect_b32 s31, 1152, s31
    s_and_b32 s27, s20, 3
    s_lshl_b32 s27, s27, 3
    s_add_u32 s27, s27, s16
    s_lshl_b32 s27, s27, 6
    s_lshl_b32 s28, s19, 2
    s_add_u32 s27, s27, s28
    s_mul_i32 s32, s27, s31
    s_cmp_eq_u32 s21, 0
    s_cselect_b32 s28, 5242880, 0
    s_add_u32 s32, s32, s28
    s_cmp_eq_u32 s21, 2
    s_cselect_b32 s28, 1152, 0
    s_add_u32 s32, s32, s28
    v_and_b32 v12, 31, v1
    v_mul_u32_u24 v12, 296, v12
    v_lshrrev_b32 v13, 5, v1
    v_lshl_add_u32 v12, v13, 4, v12
    s_mul_i32 s27, s16, 36
    s_add_u32 s27, s27, 0
    v_add_u32 v12, s27, v12
    v_lshlrev_b32 v13, 4, v1
    v_lshrrev_b32 v14, 3, v1
    v_and_b32 v15, 7, v1
    v_mul_lo_u32 v16, v14, s31
    v_lshl_add_u32 v16, v15, 4, v16
    v_add_u32 v16, 1024, v16
    v_lshlrev_b32 v14, 5, v14
    v_lshl_add_u32 v14, v15, 2, v14
    v_mul_u32_u24 v14, 296, v14
    s_add_u32 s27, s27, 32
    v_add_u32 v14, s27, v14
    s_waitcnt lgkmcnt(0)
    s_barrier
    ds_read2_b32 v[200:201], v12 offset0:0 offset1:1
    ds_read2_b32 v[202:203], v12 offset0:2 offset1:3
    v_add_u32 v12, 9472, v12
    ds_read2_b32 v[204:205], v12 offset0:0 offset1:1
    ds_read2_b32 v[206:207], v12 offset0:2 offset1:3
    v_add_u32 v12, 9472, v12
    ds_read2_b32 v[208:209], v12 offset0:0 offset1:1
    ds_read2_b32 v[210:211], v12 offset0:2 offset1:3
    v_add_u32 v12, 9472, v12
    ds_read2_b32 v[212:213], v12 offset0:0 offset1:1
    ds_read2_b32 v[214:215], v12 offset0:2 offset1:3
    s_mov_b32 exec_lo, -1
    s_mov_b32 exec_hi, 0x0
    ds_read2_b32 v[216:217], v14 offset0:0 offset1:74
    ds_read2_b32 v[218:219], v14 offset0:148 offset1:222
    s_mov_b64 exec, -1
    s_waitcnt lgkmcnt(8)
    buffer_store_dwordx4 v[200:203], v13, s[12:15], s32 offen sc1
    s_add_u32 s32, s32, s31
    s_waitcnt lgkmcnt(6)
    buffer_store_dwordx4 v[204:207], v13, s[12:15], s32 offen sc1
    s_add_u32 s32, s32, s31
    s_waitcnt lgkmcnt(4)
    buffer_store_dwordx4 v[208:211], v13, s[12:15], s32 offen sc1
    s_add_u32 s32, s32, s31
    s_waitcnt lgkmcnt(2)
    buffer_store_dwordx4 v[212:215], v13, s[12:15], s32 offen sc1
    s_mul_i32 s27, s31, 3
    s_sub_u32 s32, s32, s27
    s_waitcnt lgkmcnt(0)
    s_mov_b32 exec_lo, -1
    s_mov_b32 exec_hi, 0x0
    buffer_store_dwordx4 v[216:219], v16, s[12:15], s32 offen sc1
    s_mov_b64 exec, -1
    s_endpgm
v_epi_5:
    s_cmp_eq_u32 s21, 0
    s_mov_b32 s31, 2368
    s_cselect_b32 s31, 1152, s31
    s_and_b32 s27, s20, 3
    s_lshl_b32 s27, s27, 3
    s_add_u32 s27, s27, s16
    s_lshl_b32 s27, s27, 6
    s_lshl_b32 s28, s19, 2
    s_add_u32 s27, s27, s28
    s_mul_i32 s32, s27, s31
    s_cmp_eq_u32 s21, 0
    s_cselect_b32 s28, 5242880, 0
    s_add_u32 s32, s32, s28
    s_cmp_eq_u32 s21, 2
    s_cselect_b32 s28, 1152, 0
    s_add_u32 s32, s32, s28
    v_mov_b32 v18, 0x3f803f80
    v_mov_b32 v19, 0x3f803f80
    v_lshlrev_b32 v12, 3, v1
    v_add_u32 v12, 38016, v12
    s_mov_b32 exec_lo, -1
    s_mov_b32 exec_hi, 0x0
    ds_write_b64 v12, v[18:19]
    s_mov_b64 exec, -1
    s_mul_i32 s27, s16, 18
    v_add_u32 v16, 0, v1
    v_mul_u32_u24 v17, 3450, v16
    v_lshrrev_b32 v17, 16, v17
    v_mul_u32_u24 v18, 19, v17
    v_sub_u32 v18, v16, v18
    v_add_u32 v16, s27, v18
    v_cmp_eq_u32 vcc, 18, v18
    v_mov_b32 v18, 144
    v_lshrrev_b32 v19, 1, v17
    v_cndmask_b32 v16, v16, v18, vcc
    v_mul_u32_u24 v16, 264, v16
    v_lshl_add_u32 v16, v19, 5, v16
    v_and_b32 v17, 1, v17
    v_lshl_add_u32 v12, v17, 3, v16
    v_add_u32 v12, 0, v12
    v_add_u32 v16, 64, v1
    v_mul_u32_u24 v17, 3450, v16
    v_lshrrev_b32 v17, 16, v17
    v_mul_u32_u24 v18, 19, v17
    v_sub_u32 v18, v16, v18
    v_add_u32 v16, s27, v18
    v_cmp_eq_u32 vcc, 18, v18
    v_mov_b32 v18, 144
    v_lshrrev_b32 v19, 1, v17
    v_cndmask_b32 v16, v16, v18, vcc
    v_mul_u32_u24 v16, 264, v16
    v_lshl_add_u32 v16, v19, 5, v16
    v_and_b32 v17, 1, v17
    v_lshl_add_u32 v13, v17, 3, v16
    v_add_u32 v13, 0, v13
    v_lshlrev_b32 v14, 4, v1
    s_waitcnt lgkmcnt(0)
    s_barrier
    ds_read2_b64 v[200:203], v12 offset0:0 offset1:2
    ds_read2_b64 v[204:207], v13 offset0:0 offset1:2
    ds_read2_b64 v[208:211], v12 offset0:8 offset1:10
    ds_read2_b64 v[212:215], v13 offset0:8 offset1:10
    ds_read2_b64 v[216:219], v12 offset0:16 offset1:18
    ds_read2_b64 v[220:223], v13 offset0:16 offset1:18
    ds_read2_b64 v[224:227], v12 offset0:24 offset1:26
    ds_read2_b64 v[228:231], v13 offset0:24 offset1:26
    s_waitcnt lgkmcnt(6)
    buffer_store_dwordx4 v[200:203], v14, s[12:15], s32 offen sc1
    s_mov_b64 exec, 0xfff
    buffer_store_dwordx4 v[204:207], v14, s[12:15], s32 offen offset:1024 sc1
    s_mov_b64 exec, -1
    s_add_u32 s32, s32, s31
    s_waitcnt lgkmcnt(4)
    buffer_store_dwordx4 v[208:211], v14, s[12:15], s32 offen sc1
    s_mov_b64 exec, 0xfff
    buffer_store_dwordx4 v[212:215], v14, s[12:15], s32 offen offset:1024 sc1
    s_mov_b64 exec, -1
    s_add_u32 s32, s32, s31
    s_waitcnt lgkmcnt(2)
    buffer_store_dwordx4 v[216:219], v14, s[12:15], s32 offen sc1
    s_mov_b64 exec, 0xfff
    buffer_store_dwordx4 v[220:223], v14, s[12:15], s32 offen offset:1024 sc1
    s_mov_b64 exec, -1
    s_add_u32 s32, s32, s31
    s_waitcnt lgkmcnt(0)
    buffer_store_dwordx4 v[224:227], v14, s[12:15], s32 offen sc1
    s_mov_b64 exec, 0xfff
    buffer_store_dwordx4 v[228:231], v14, s[12:15], s32 offen offset:1024 sc1
    s_mov_b64 exec, -1
    s_endpgm
k1_role1:
    s_sub_u32 s2, s2, 192
    v_lshrrev_b32 v2, 6, v0
    v_and_b32 v1, 63, v0
    v_readfirstlane_b32 s16, v2
    s_nop 0
    s_cmp_lt_u32 s16, 6
    s_cbranch_scc1 aux_cpf2_35
    s_cmp_eq_u32 s16, 7
    s_cbranch_scc1 aux_cpf_34
    s_getpc_b64 s[84:85]
pc_36:
    s_sub_u32 s84, s84, pc_36-k1_role0
    s_subb_u32 s85, s85, 0
    v_and_b32 v104, 63, v0
    v_lshlrev_b32 v104, 7, v104
    v_min_u32 v105, k1_role1-k1_role0-4, v104
    global_load_dword v106, v105, s[84:85]
    v_add_u32 v104, 8192, v104
    v_min_u32 v105, k1_role1-k1_role0-4, v104
    global_load_dword v107, v105, s[84:85]
    v_add_u32 v104, 8192, v104
    v_min_u32 v105, k1_role1-k1_role0-4, v104
    global_load_dword v108, v105, s[84:85]
    s_branch aux_cpf2_35
aux_cpf_34:
    s_getpc_b64 s[84:85]
pc_37:
    s_add_u32 s84, s84, k2_kernel-pc_37
    s_addc_u32 s85, s85, 0
    v_and_b32 v104, 63, v0
    v_lshlrev_b32 v104, 7, v104
    v_min_u32 v105, k3_exit-k2_kernel-4, v104
    global_load_dword v106, v105, s[84:85]
    v_add_u32 v104, 8192, v104
    v_min_u32 v105, k3_exit-k2_kernel-4, v104
    global_load_dword v107, v105, s[84:85]
aux_cpf2_35:
    s_load_dwordx2 s[38:39], s[0:1], 8
    s_load_dwordx2 s[40:41], s[0:1], 16
    s_load_dwordx2 s[42:43], s[0:1], 24
    s_load_dwordx2 s[44:45], s[0:1], 32
    s_load_dwordx2 s[46:47], s[0:1], 40
    s_lshr_b32 s17, s16, 1
    s_mul_i32 s76, s2, 3
    s_add_u32 s76, s76, s17
    s_add_u32 s76, s76, 384
    s_min_u32 s76, s76, 575
    s_and_b32 s77, s16, 1
    s_mul_i32 s78, s16, 8704
    s_mul_i32 s79, s17, 1344
    s_add_u32 s79, s79, 52224
    s_waitcnt lgkmcnt(0)
    s_lshl_b32 s80, s76, 8
    s_lshl_b32 s81, s77, 7
    v_lshlrev_b32 v234, 1, v1
    s_add_u32 s83, s80, s81
    v_add_u32 v235, s83, v234
    s_lshl_b32 s80, s76, 1
    v_mov_b32 v234, s80
    global_load_ushort v132, v235, s[38:39]
    global_load_ushort v133, v235, s[40:41]
    global_load_ushort v134, v235, s[42:43]
    global_load_ushort v136, v235, s[44:45]
    global_load_ushort v140, v234, s[46:47]
    s_load_dwordx2 s[36:37], s[0:1], 0
    s_load_dwordx2 s[54:55], s[0:1], 72
    s_load_dwordx2 s[34:35], s[0:1], 96
    s_lshr_b32 s21, s16, 1
    s_lshl_b32 s21, s21, 6
    s_add_u32 s21, s21, s2
    s_cmp_lt_u32 s21, 144
    s_cselect_b32 s25, 1, 0
    s_lshr_b32 s22, s21, 4
    s_lshl_b32 s22, s22, 1
    s_and_b32 s17, s16, 1
    s_add_u32 s22, s22, s17
    s_and_b32 s21, s21, 15
    s_mul_i32 s17, s21, 147456
    s_lshl_b32 s18, s22, 6
    s_add_u32 s26, s17, s18
    s_mul_i32 s24, s22, 131072
    s_lshl_b32 s21, s21, 8
    s_add_u32 s24, s24, s21
    s_add_u32 s24, s24, 16777216
    v_and_b32 v4, 15, v1
    v_lshrrev_b32 v5, 4, v1
    v_mul_u32_u24 v2, 9216, v4
    v_lshl_add_u32 v2, v5, 4, v2
    v_lshlrev_b32 v3, 15, v5
    v_lshl_add_u32 v3, v4, 4, v3
    s_waitcnt lgkmcnt(0)
    s_mov_b32 s4, s34
    s_mov_b32 s5, s35
    s_mov_b32 s6, 24117248
    s_mov_b32 s7, 0x20000
    s_mov_b32 s8, s36
    s_mov_b32 s9, s37
    s_mov_b32 s10, 2359296
    s_mov_b32 s11, 0x20000
    s_mov_b32 s12, s54
    s_mov_b32 s13, s55
    s_mov_b32 s14, 663552
    s_mov_b32 s15, 0x20000
    s_cmp_ge_u32 s16, 6
    s_cbranch_scc1 aux_mv_38
    s_waitcnt vmcnt(0)
    v_lshlrev_b32 v232, 2, v1
    v_and_b32 v234, 15, v1
    v_add_u32 v232, s78, v232
    v_mul_u32_u24 v233, 272, v234
    v_lshrrev_b32 v234, 4, v1
    v_lshlrev_b32 v140, 16, v140
    v_lshl_add_u32 v233, v234, 4, v233
    v_mul_f32 v140, 0x3fb8aa3b, v140
    v_add_u32 v233, s78, v233
    v_lshlrev_b32 v132, 16, v132
    v_add_u32 v237, 0, v232
    v_add_u32 v238, 1088, v232
    v_add_u32 v239, 2176, v232
    v_add_u32 v240, 3264, v232
    v_add_u32 v241, 4352, v232
    v_add_u32 v242, 5440, v232
    v_add_u32 v243, 6528, v232
    v_add_u32 v244, 7616, v232
    v_exp_f32 v140, v140
    v_mul_f32 v132, 0x3fb8aa3b, v132
    v_lshlrev_b32 v133, 16, v133
    v_exp_f32 v132, v132
    v_cvt_pk_bf16_f32 v140, v140, v140
    v_lshlrev_b32 v134, 16, v134
    v_lshlrev_b32 v136, 16, v136
    v_lshlrev_b32 v140, 16, v140
    v_cvt_pk_bf16_f32 v132, v132, v132
    v_mul_f32 v133, v133, v140
    v_lshlrev_b32 v132, 16, v132
    v_add_f32 v235, v140, v140
    v_mul_f32 v132, v132, v140
    v_mul_f32 v139, 0.15915494, v133
    v_mul_f32 v142, v134, v235
    v_mul_f32 v143, v136, v235
    v_mul_f32 v138, 0xbfb8aa3b, v132
    v_mul_f32 v172, 0x3f800000, v138
    v_mul_f32 v173, 0x3f800000, v139
    v_mul_f32 v174, 0x41000000, v138
    v_mul_f32 v175, 0x41000000, v139
    v_mul_f32 v176, 0x43000000, v138
    v_mul_f32 v177, 0x43000000, v139
    v_exp_f32 v172, v172
    v_fract_f32 v173, v173
    v_exp_f32 v174, v174
    v_fract_f32 v175, v175
    v_exp_f32 v176, v176
    v_fract_f32 v177, v177
    v_cos_f32 v146, v173
    v_sin_f32 v147, v173
    v_cos_f32 v148, v175
    v_sin_f32 v149, v175
    v_cos_f32 v150, v177
    v_sin_f32 v151, v177
    v_mul_f32 v146, v146, v172
    v_mul_f32 v147, v147, v172
    v_mul_f32 v148, v148, v174
    v_mul_f32 v149, v149, v174
    v_mul_f32 v150, v150, v176
    v_mul_f32 v151, v151, v176
    v_mov_b32 v172, 1.0
    v_mov_b32 v173, 0
    v_mov_b32 v156, v142
    v_mov_b32 v157, v143
    v_pk_mul_f32 v[180:181], v[148:149], v[148:149] op_sel_hi:[1,0]
    v_pk_mul_f32 v[182:183], v[156:157], v[146:147] op_sel_hi:[1,0]
    v_pk_fma_f32 v[152:153], v[148:149], v[148:149], v[180:181] op_sel:[1,1,0] op_sel_hi:[0,1,1] neg_lo:[1,0,0]
    v_pk_fma_f32 v[158:159], v[156:157], v[146:147], v[182:183] op_sel:[1,1,0] op_sel_hi:[0,1,1] neg_lo:[1,0,0]
    v_cvt_pk_bf16_f32 v184, v172, -v173
    v_cvt_pk_bf16_f32 v185, v148, -v149
    ds_write2_b32 v237, v184, v185 offset0:0 offset1:68
    v_mov_b32 v172, v152
    v_mov_b32 v173, v153
    v_pk_mul_f32 v[180:181], v[148:149], v[152:153] op_sel_hi:[1,0]
    v_pk_mul_f32 v[182:183], v[158:159], v[146:147] op_sel_hi:[1,0]
    v_pk_fma_f32 v[174:175], v[148:149], v[152:153], v[180:181] op_sel:[1,1,0] op_sel_hi:[0,1,1] neg_lo:[1,0,0]
    v_pk_fma_f32 v[160:161], v[158:159], v[146:147], v[182:183] op_sel:[1,1,0] op_sel_hi:[0,1,1] neg_lo:[1,0,0]
    v_cvt_pk_bf16_f32 v186, v172, -v173
    v_cvt_pk_bf16_f32 v187, v174, -v175
    ds_write2_b32 v237, v186, v187 offset0:136 offset1:204
    v_pk_mul_f32 v[180:181], v[172:173], v[152:153] op_sel_hi:[1,0]
    v_pk_mul_f32 v[182:183], v[174:175], v[152:153] op_sel_hi:[1,0]
    v_pk_fma_f32 v[176:177], v[172:173], v[152:153], v[180:181] op_sel:[1,1,0] op_sel_hi:[0,1,1] neg_lo:[1,0,0]
    v_pk_fma_f32 v[178:179], v[174:175], v[152:153], v[182:183] op_sel:[1,1,0] op_sel_hi:[0,1,1] neg_lo:[1,0,0]
    v_cvt_pk_bf16_f32 v184, v176, -v177
    v_cvt_pk_bf16_f32 v185, v178, -v179
    ds_write2_b32 v238, v184, v185 offset0:0 offset1:68
    v_pk_mul_f32 v[180:181], v[176:177], v[152:153] op_sel_hi:[1,0]
    v_pk_mul_f32 v[182:183], v[178:179], v[152:153] op_sel_hi:[1,0]
    v_pk_fma_f32 v[172:173], v[176:177], v[152:153], v[180:181] op_sel:[1,1,0] op_sel_hi:[0,1,1] neg_lo:[1,0,0]
    v_pk_fma_f32 v[174:175], v[178:179], v[152:153], v[182:183] op_sel:[1,1,0] op_sel_hi:[0,1,1] neg_lo:[1,0,0]
    v_cvt_pk_bf16_f32 v186, v172, -v173
    v_cvt_pk_bf16_f32 v187, v174, -v175
    ds_write2_b32 v238, v186, v187 offset0:136 offset1:204
    v_pk_mul_f32 v[180:181], v[172:173], v[152:153] op_sel_hi:[1,0]
    v_pk_mul_f32 v[182:183], v[174:175], v[152:153] op_sel_hi:[1,0]
    v_pk_fma_f32 v[176:177], v[172:173], v[152:153], v[180:181] op_sel:[1,1,0] op_sel_hi:[0,1,1] neg_lo:[1,0,0]
    v_pk_fma_f32 v[178:179], v[174:175], v[152:153], v[182:183] op_sel:[1,1,0] op_sel_hi:[0,1,1] neg_lo:[1,0,0]
    v_cvt_pk_bf16_f32 v184, v176, -v177
    v_cvt_pk_bf16_f32 v185, v178, -v179
    ds_write2_b32 v239, v184, v185 offset0:0 offset1:68
    v_pk_mul_f32 v[180:181], v[176:177], v[152:153] op_sel_hi:[1,0]
    v_pk_mul_f32 v[182:183], v[178:179], v[152:153] op_sel_hi:[1,0]
    v_pk_fma_f32 v[172:173], v[176:177], v[152:153], v[180:181] op_sel:[1,1,0] op_sel_hi:[0,1,1] neg_lo:[1,0,0]
    v_pk_fma_f32 v[174:175], v[178:179], v[152:153], v[182:183] op_sel:[1,1,0] op_sel_hi:[0,1,1] neg_lo:[1,0,0]
    v_cvt_pk_bf16_f32 v186, v172, -v173
    v_cvt_pk_bf16_f32 v187, v174, -v175
    ds_write2_b32 v239, v186, v187 offset0:136 offset1:204
    v_pk_mul_f32 v[180:181], v[172:173], v[152:153] op_sel_hi:[1,0]
    v_pk_mul_f32 v[182:183], v[174:175], v[152:153] op_sel_hi:[1,0]
    v_pk_fma_f32 v[176:177], v[172:173], v[152:153], v[180:181] op_sel:[1,1,0] op_sel_hi:[0,1,1] neg_lo:[1,0,0]
    v_pk_fma_f32 v[178:179], v[174:175], v[152:153], v[182:183] op_sel:[1,1,0] op_sel_hi:[0,1,1] neg_lo:[1,0,0]
    v_cvt_pk_bf16_f32 v184, v176, -v177
    v_cvt_pk_bf16_f32 v185, v178, -v179
    ds_write2_b32 v240, v184, v185 offset0:0 offset1:68
    v_pk_mul_f32 v[180:181], v[176:177], v[152:153] op_sel_hi:[1,0]
    v_pk_mul_f32 v[182:183], v[178:179], v[152:153] op_sel_hi:[1,0]
    v_pk_fma_f32 v[172:173], v[176:177], v[152:153], v[180:181] op_sel:[1,1,0] op_sel_hi:[0,1,1] neg_lo:[1,0,0]
    v_pk_fma_f32 v[174:175], v[178:179], v[152:153], v[182:183] op_sel:[1,1,0] op_sel_hi:[0,1,1] neg_lo:[1,0,0]
    v_cvt_pk_bf16_f32 v186, v172, -v173
    v_cvt_pk_bf16_f32 v187, v174, -v175
    ds_write2_b32 v240, v186, v187 offset0:136 offset1:204
    ds_read_b128 v[188:191], v233 offset:0
    ds_read_b128 v[192:195], v233 offset:64
    ds_read_b128 v[196:199], v233 offset:128
    ds_read_b128 v[200:203], v233 offset:192
    v_pk_mul_f32 v[180:181], v[160:161], v[146:147] op_sel_hi:[1,0]
    v_pk_mul_f32 v[182:183], v[150:151], v[150:151] op_sel_hi:[1,0]
    v_pk_fma_f32 v[162:163], v[160:161], v[146:147], v[180:181] op_sel:[1,1,0] op_sel_hi:[0,1,1] neg_lo:[1,0,0]
    v_pk_fma_f32 v[152:153], v[150:151], v[150:151], v[182:183] op_sel:[1,1,0] op_sel_hi:[0,1,1] neg_lo:[1,0,0]
    v_pk_mul_f32 v[180:181], v[162:163], v[146:147] op_sel_hi:[1,0]
    v_pk_mul_f32 v[182:183], v[152:153], v[150:151] op_sel_hi:[1,0]
    v_pk_fma_f32 v[164:165], v[162:163], v[146:147], v[180:181] op_sel:[1,1,0] op_sel_hi:[0,1,1] neg_lo:[1,0,0]
    v_pk_fma_f32 v[154:155], v[152:153], v[150:151], v[182:183] op_sel:[1,1,0] op_sel_hi:[0,1,1] neg_lo:[1,0,0]
    v_pk_mul_f32 v[180:181], v[164:165], v[146:147] op_sel_hi:[1,0]
    v_pk_mul_f32 v[182:183], v[156:157], v[150:151] op_sel_hi:[1,0]
    v_pk_fma_f32 v[166:167], v[164:165], v[146:147], v[180:181] op_sel:[1,1,0] op_sel_hi:[0,1,1] neg_lo:[1,0,0]
    v_pk_fma_f32 v[172:173], v[156:157], v[150:151], v[182:183] op_sel:[1,1,0] op_sel_hi:[0,1,1] neg_lo:[1,0,0]
    v_pk_mul_f32 v[180:181], v[166:167], v[146:147] op_sel_hi:[1,0]
    v_pk_mul_f32 v[182:183], v[158:159], v[150:151] op_sel_hi:[1,0]
    v_pk_fma_f32 v[168:169], v[166:167], v[146:147], v[180:181] op_sel:[1,1,0] op_sel_hi:[0,1,1] neg_lo:[1,0,0]
    v_pk_fma_f32 v[174:175], v[158:159], v[150:151], v[182:183] op_sel:[1,1,0] op_sel_hi:[0,1,1] neg_lo:[1,0,0]
    v_cvt_pk_bf16_f32 v184, v156, v157
    v_cvt_pk_bf16_f32 v185, v158, v159
    ds_write2_b32 v241, v184, v185 offset0:0 offset1:68
    v_cvt_pk_bf16_f32 v186, v160, v161
    v_cvt_pk_bf16_f32 v187, v162, v163
    ds_write2_b32 v241, v186, v187 offset0:136 offset1:204
    v_cvt_pk_bf16_f32 v184, v172, v173
    v_cvt_pk_bf16_f32 v185, v174, v175
    ds_write2_b32 v243, v184, v185 offset0:0 offset1:68
    v_pk_mul_f32 v[180:181], v[168:169], v[146:147] op_sel_hi:[1,0]
    v_pk_mul_f32 v[182:183], v[160:161], v[150:151] op_sel_hi:[1,0]
    v_pk_fma_f32 v[170:171], v[168:169], v[146:147], v[180:181] op_sel:[1,1,0] op_sel_hi:[0,1,1] neg_lo:[1,0,0]
    v_pk_fma_f32 v[176:177], v[160:161], v[150:151], v[182:183] op_sel:[1,1,0] op_sel_hi:[0,1,1] neg_lo:[1,0,0]
    v_cvt_pk_bf16_f32 v186, v164, v165
    v_cvt_pk_bf16_f32 v187, v166, v167
    ds_write2_b32 v242, v186, v187 offset0:0 offset1:68
    v_cvt_pk_bf16_f32 v184, v168, v169
    v_cvt_pk_bf16_f32 v185, v170, v171
    ds_write2_b32 v242, v184, v185 offset0:136 offset1:204
    v_pk_mul_f32 v[180:181], v[162:163], v[150:151] op_sel_hi:[1,0]
    v_pk_mul_f32 v[182:183], v[164:165], v[150:151] op_sel_hi:[1,0]
    v_pk_fma_f32 v[178:179], v[162:163], v[150:151], v[180:181] op_sel:[1,1,0] op_sel_hi:[0,1,1] neg_lo:[1,0,0]
    v_pk_fma_f32 v[172:173], v[164:165], v[150:151], v[182:183] op_sel:[1,1,0] op_sel_hi:[0,1,1] neg_lo:[1,0,0]
    v_cvt_pk_bf16_f32 v186, v176, v177
    v_cvt_pk_bf16_f32 v187, v178, v179
    ds_write2_b32 v243, v186, v187 offset0:136 offset1:204
    v_pk_mul_f32 v[180:181], v[166:167], v[150:151] op_sel_hi:[1,0]
    v_pk_mul_f32 v[182:183], v[168:169], v[150:151] op_sel_hi:[1,0]
    v_pk_fma_f32 v[174:175], v[166:167], v[150:151], v[180:181] op_sel:[1,1,0] op_sel_hi:[0,1,1] neg_lo:[1,0,0]
    v_pk_fma_f32 v[176:177], v[168:169], v[150:151], v[182:183] op_sel:[1,1,0] op_sel_hi:[0,1,1] neg_lo:[1,0,0]
    v_cvt_pk_bf16_f32 v184, v172, v173
    v_cvt_pk_bf16_f32 v185, v174, v175
    ds_write2_b32 v244, v184, v185 offset0:0 offset1:68
    v_pk_mul_f32 v[180:181], v[170:171], v[150:151] op_sel_hi:[1,0]
    v_pk_mul_f32 v[182:183], v[156:157], v[152:153] op_sel_hi:[1,0]
    v_pk_fma_f32 v[178:179], v[170:171], v[150:151], v[180:181] op_sel:[1,1,0] op_sel_hi:[0,1,1] neg_lo:[1,0,0]
    v_pk_fma_f32 v[172:173], v[156:157], v[152:153], v[182:183] op_sel:[1,1,0] op_sel_hi:[0,1,1] neg_lo:[1,0,0]
    v_cvt_pk_bf16_f32 v186, v176, v177
    v_cvt_pk_bf16_f32 v187, v178, v179
    ds_write2_b32 v244, v186, v187 offset0:136 offset1:204
    ds_read_b128 v[204:207], v233 offset:4352
    ds_read_b128 v[208:211], v233 offset:4416
    ds_read_b128 v[212:215], v233 offset:4480
    ds_read_b128 v[216:219], v233 offset:4544
    v_pk_mul_f32 v[180:181], v[160:161], v[152:153] op_sel_hi:[1,0]
    v_pk_mul_f32 v[182:183], v[164:165], v[152:153] op_sel_hi:[1,0]
    v_pk_fma_f32 v[174:175], v[160:161], v[152:153], v[180:181] op_sel:[1,1,0] op_sel_hi:[0,1,1] neg_lo:[1,0,0]
    v_pk_fma_f32 v[176:177], v[164:165], v[152:153], v[182:183] op_sel:[1,1,0] op_sel_hi:[0,1,1] neg_lo:[1,0,0]
    v_cvt_pk_bf16_f32 v184, v172, v173
    v_cvt_pk_bf16_f32 v185, v174, v175
    ds_write2_b32 v241, v184, v185 offset0:0 offset1:68
    v_pk_mul_f32 v[180:181], v[168:169], v[152:153] op_sel_hi:[1,0]
    v_pk_mul_f32 v[182:183], v[156:157], v[154:155] op_sel_hi:[1,0]
    v_pk_fma_f32 v[178:179], v[168:169], v[152:153], v[180:181] op_sel:[1,1,0] op_sel_hi:[0,1,1] neg_lo:[1,0,0]
    v_pk_fma_f32 v[172:173], v[156:157], v[154:155], v[182:183] op_sel:[1,1,0] op_sel_hi:[0,1,1] neg_lo:[1,0,0]
    v_cvt_pk_bf16_f32 v186, v176, v177
    v_cvt_pk_bf16_f32 v187, v178, v179
    ds_write2_b32 v241, v186, v187 offset0:136 offset1:204
    s_waitcnt lgkmcnt(0)
    s_cmp_eq_u32 s25, 0
    s_cbranch_scc1 aux_notr_39
    s_mov_b32 s17, s26
    buffer_load_dwordx4 v[8:11], v2, s[8:11], s17 offen offset:0
    buffer_load_dwordx4 v[12:15], v2, s[8:11], s17 offen offset:1152
    buffer_load_dwordx4 v[16:19], v2, s[8:11], s17 offen offset:2304
    buffer_load_dwordx4 v[20:23], v2, s[8:11], s17 offen offset:3456
    s_add_u32 s17, s17, 4608
    buffer_load_dwordx4 v[24:27], v2, s[8:11], s17 offen offset:0
    buffer_load_dwordx4 v[28:31], v2, s[8:11], s17 offen offset:1152
    buffer_load_dwordx4 v[32:35], v2, s[8:11], s17 offen offset:2304
    buffer_load_dwordx4 v[36:39], v2, s[8:11], s17 offen offset:3456
aux_notr_39:
    v_mfma_f32_16x16x32_bf16 v[220:223], v[204:207], v[188:191], 0
    v_mfma_f32_16x16x32_bf16 v[220:223], v[208:211], v[192:195], v[220:223]
    v_mfma_f32_16x16x32_bf16 v[220:223], v[212:215], v[196:199], v[220:223]
    v_mfma_f32_16x16x32_bf16 v[220:223], v[216:219], v[200:203], v[220:223]
    v_pk_mul_f32 v[180:181], v[160:161], v[154:155] op_sel_hi:[1,0]
    v_pk_mul_f32 v[182:183], v[164:165], v[154:155] op_sel_hi:[1,0]
    v_pk_fma_f32 v[174:175], v[160:161], v[154:155], v[180:181] op_sel:[1,1,0] op_sel_hi:[0,1,1] neg_lo:[1,0,0]
    v_pk_fma_f32 v[176:177], v[164:165], v[154:155], v[182:183] op_sel:[1,1,0] op_sel_hi:[0,1,1] neg_lo:[1,0,0]
    v_cvt_pk_bf16_f32 v184, v172, v173
    v_cvt_pk_bf16_f32 v185, v174, v175
    ds_write2_b32 v242, v184, v185 offset0:0 offset1:68
    v_pk_mul_f32 v[180:181], v[168:169], v[154:155] op_sel_hi:[1,0]
    v_pk_mul_f32 v[182:183], v[154:155], v[150:151] op_sel_hi:[1,0]
    v_pk_fma_f32 v[178:179], v[168:169], v[154:155], v[180:181] op_sel:[1,1,0] op_sel_hi:[0,1,1] neg_lo:[1,0,0]
    v_pk_fma_f32 v[152:153], v[154:155], v[150:151], v[182:183] op_sel:[1,1,0] op_sel_hi:[0,1,1] neg_lo:[1,0,0]
    v_cvt_pk_bf16_f32 v186, v176, v177
    v_cvt_pk_bf16_f32 v187, v178, v179
    ds_write2_b32 v242, v186, v187 offset0:136 offset1:204
    v_pk_mul_f32 v[180:181], v[156:157], v[152:153] op_sel_hi:[1,0]
    v_pk_mul_f32 v[182:183], v[164:165], v[152:153] op_sel_hi:[1,0]
    v_pk_fma_f32 v[172:173], v[156:157], v[152:153], v[180:181] op_sel:[1,1,0] op_sel_hi:[0,1,1] neg_lo:[1,0,0]
    v_pk_fma_f32 v[174:175], v[164:165], v[152:153], v[182:183] op_sel:[1,1,0] op_sel_hi:[0,1,1] neg_lo:[1,0,0]
    v_pk_mul_f32 v[180:181], v[152:153], v[150:151] op_sel_hi:[1,0]
    v_pk_fma_f32 v[154:155], v[152:153], v[150:151], v[180:181] op_sel:[1,1,0] op_sel_hi:[0,1,1] neg_lo:[1,0,0]
    v_cvt_pk_bf16_f32 v184, v172, v173
    v_cvt_pk_bf16_f32 v185, v174, v175
    ds_write2_b32 v243, v184, v185 offset0:0 offset1:68
    v_pk_mul_f32 v[180:181], v[156:157], v[154:155] op_sel_hi:[1,0]
    v_pk_mul_f32 v[182:183], v[164:165], v[154:155] op_sel_hi:[1,0]
    v_pk_fma_f32 v[172:173], v[156:157], v[154:155], v[180:181] op_sel:[1,1,0] op_sel_hi:[0,1,1] neg_lo:[1,0,0]
    v_pk_fma_f32 v[174:175], v[164:165], v[154:155], v[182:183] op_sel:[1,1,0] op_sel_hi:[0,1,1] neg_lo:[1,0,0]
    v_pk_mul_f32 v[180:181], v[154:155], v[150:151] op_sel_hi:[1,0]
    v_pk_fma_f32 v[152:153], v[154:155], v[150:151], v[180:181] op_sel:[1,1,0] op_sel_hi:[0,1,1] neg_lo:[1,0,0]
    v_cvt_pk_bf16_f32 v186, v172, v173
    v_cvt_pk_bf16_f32 v187, v174, v175
    ds_write2_b32 v243, v186, v187 offset0:136 offset1:204
    v_pk_mul_f32 v[180:181], v[156:157], v[152:153] op_sel_hi:[1,0]
    v_pk_mul_f32 v[182:183], v[164:165], v[152:153] op_sel_hi:[1,0]
    v_pk_fma_f32 v[172:173], v[156:157], v[152:153], v[180:181] op_sel:[1,1,0] op_sel_hi:[0,1,1] neg_lo:[1,0,0]
    v_pk_fma_f32 v[174:175], v[164:165], v[152:153], v[182:183] op_sel:[1,1,0] op_sel_hi:[0,1,1] neg_lo:[1,0,0]
    v_pk_mul_f32 v[180:181], v[152:153], v[150:151] op_sel_hi:[1,0]
    v_pk_fma_f32 v[154:155], v[152:153], v[150:151], v[180:181] op_sel:[1,1,0] op_sel_hi:[0,1,1] neg_lo:[1,0,0]
    v_cvt_pk_bf16_f32 v184, v172, v173
    v_cvt_pk_bf16_f32 v185, v174, v175
    ds_write2_b32 v244, v184, v185 offset0:0 offset1:68
    v_pk_mul_f32 v[180:181], v[156:157], v[154:155] op_sel_hi:[1,0]
    v_pk_mul_f32 v[182:183], v[164:165], v[154:155] op_sel_hi:[1,0]
    v_pk_fma_f32 v[172:173], v[156:157], v[154:155], v[180:181] op_sel:[1,1,0] op_sel_hi:[0,1,1] neg_lo:[1,0,0]
    v_pk_fma_f32 v[174:175], v[164:165], v[154:155], v[182:183] op_sel:[1,1,0] op_sel_hi:[0,1,1] neg_lo:[1,0,0]
    v_pk_mul_f32 v[180:181], v[154:155], v[150:151] op_sel_hi:[1,0]
    v_pk_fma_f32 v[152:153], v[154:155], v[150:151], v[180:181] op_sel:[1,1,0] op_sel_hi:[0,1,1] neg_lo:[1,0,0]
    v_cvt_pk_bf16_f32 v186, v172, v173
    v_cvt_pk_bf16_f32 v187, v174, v175
    ds_write2_b32 v244, v186, v187 offset0:136 offset1:204
    ds_read_b128 v[204:207], v233 offset:4352
    ds_read_b128 v[208:211], v233 offset:4416
    ds_read_b128 v[212:215], v233 offset:4480
    ds_read_b128 v[216:219], v233 offset:4544
    v_pk_mul_f32 v[180:181], v[156:157], v[152:153] op_sel_hi:[1,0]
    v_pk_mul_f32 v[182:183], v[152:153], v[150:151] op_sel_hi:[1,0]
    v_pk_fma_f32 v[172:173], v[156:157], v[152:153], v[180:181] op_sel:[1,1,0] op_sel_hi:[0,1,1] neg_lo:[1,0,0]
    v_pk_fma_f32 v[154:155], v[152:153], v[150:151], v[182:183] op_sel:[1,1,0] op_sel_hi:[0,1,1] neg_lo:[1,0,0]
    v_pk_mul_f32 v[180:181], v[156:157], v[154:155] op_sel_hi:[1,0]
    v_pk_mul_f32 v[182:183], v[154:155], v[150:151] op_sel_hi:[1,0]
    v_pk_fma_f32 v[174:175], v[156:157], v[154:155], v[180:181] op_sel:[1,1,0] op_sel_hi:[0,1,1] neg_lo:[1,0,0]
    v_pk_fma_f32 v[152:153], v[154:155], v[150:151], v[182:183] op_sel:[1,1,0] op_sel_hi:[0,1,1] neg_lo:[1,0,0]
    v_cvt_pk_bf16_f32 v184, v172, v173
    v_cvt_pk_bf16_f32 v185, v174, v175
    ds_write2_b32 v241, v184, v185 offset0:0 offset1:68
    s_waitcnt lgkmcnt(0)
    v_mfma_f32_16x16x32_bf16 v[224:227], v[204:207], v[188:191], 0
    v_mfma_f32_16x16x32_bf16 v[224:227], v[208:211], v[192:195], v[224:227]
    v_mfma_f32_16x16x32_bf16 v[224:227], v[212:215], v[196:199], v[224:227]
    v_mfma_f32_16x16x32_bf16 v[224:227], v[216:219], v[200:203], v[224:227]
    v_pk_mul_f32 v[180:181], v[156:157], v[152:153] op_sel_hi:[1,0]
    v_pk_mul_f32 v[182:183], v[152:153], v[150:151] op_sel_hi:[1,0]
    v_pk_fma_f32 v[172:173], v[156:157], v[152:153], v[180:181] op_sel:[1,1,0] op_sel_hi:[0,1,1] neg_lo:[1,0,0]
    v_pk_fma_f32 v[154:155], v[152:153], v[150:151], v[182:183] op_sel:[1,1,0] op_sel_hi:[0,1,1] neg_lo:[1,0,0]
    v_pk_mul_f32 v[180:181], v[156:157], v[154:155] op_sel_hi:[1,0]
    v_pk_mul_f32 v[182:183], v[154:155], v[150:151] op_sel_hi:[1,0]
    v_pk_fma_f32 v[174:175], v[156:157], v[154:155], v[180:181] op_sel:[1,1,0] op_sel_hi:[0,1,1] neg_lo:[1,0,0]
    v_pk_fma_f32 v[152:153], v[154:155], v[150:151], v[182:183] op_sel:[1,1,0] op_sel_hi:[0,1,1] neg_lo:[1,0,0]
    v_cvt_pk_bf16_f32 v186, v172, v173
    v_cvt_pk_bf16_f32 v187, v174, v175
    ds_write2_b32 v241, v186, v187 offset0:136 offset1:204
    v_pk_mul_f32 v[180:181], v[156:157], v[152:153] op_sel_hi:[1,0]
    v_pk_mul_f32 v[182:183], v[152:153], v[150:151] op_sel_hi:[1,0]
    v_pk_fma_f32 v[172:173], v[156:157], v[152:153], v[180:181] op_sel:[1,1,0] op_sel_hi:[0,1,1] neg_lo:[1,0,0]
    v_pk_fma_f32 v[154:155], v[152:153], v[150:151], v[182:183] op_sel:[1,1,0] op_sel_hi:[0,1,1] neg_lo:[1,0,0]
    v_pk_mul_f32 v[180:181], v[156:157], v[154:155] op_sel_hi:[1,0]
    v_pk_mul_f32 v[182:183], v[154:155], v[150:151] op_sel_hi:[1,0]
    v_pk_fma_f32 v[174:175], v[156:157], v[154:155], v[180:181] op_sel:[1,1,0] op_sel_hi:[0,1,1] neg_lo:[1,0,0]
    v_pk_fma_f32 v[152:153], v[154:155], v[150:151], v[182:183] op_sel:[1,1,0] op_sel_hi:[0,1,1] neg_lo:[1,0,0]
    v_cvt_pk_bf16_f32 v184, v172, v173
    v_cvt_pk_bf16_f32 v185, v174, v175
    ds_write2_b32 v242, v184, v185 offset0:0 offset1:68
    v_pk_mul_f32 v[180:181], v[156:157], v[152:153] op_sel_hi:[1,0]
    v_pk_mul_f32 v[182:183], v[152:153], v[150:151] op_sel_hi:[1,0]
    v_pk_fma_f32 v[172:173], v[156:157], v[152:153], v[180:181] op_sel:[1,1,0] op_sel_hi:[0,1,1] neg_lo:[1,0,0]
    v_pk_fma_f32 v[154:155], v[152:153], v[150:151], v[182:183] op_sel:[1,1,0] op_sel_hi:[0,1,1] neg_lo:[1,0,0]
    v_pk_mul_f32 v[180:181], v[156:157], v[154:155] op_sel_hi:[1,0]
    v_pk_mul_f32 v[182:183], v[154:155], v[150:151] op_sel_hi:[1,0]
    v_pk_fma_f32 v[174:175], v[156:157], v[154:155], v[180:181] op_sel:[1,1,0] op_sel_hi:[0,1,1] neg_lo:[1,0,0]
    v_pk_fma_f32 v[152:153], v[154:155], v[150:151], v[182:183] op_sel:[1,1,0] op_sel_hi:[0,1,1] neg_lo:[1,0,0]
    v_cvt_pk_bf16_f32 v186, v172, v173
    v_cvt_pk_bf16_f32 v187, v174, v175
    ds_write2_b32 v242, v186, v187 offset0:136 offset1:204
    v_pk_mul_f32 v[180:181], v[156:157], v[152:153] op_sel_hi:[1,0]
    v_pk_fma_f32 v[172:173], v[156:157], v[152:153], v[180:181] op_sel:[1,1,0] op_sel_hi:[0,1,1] neg_lo:[1,0,0]
    v_cvt_pk_bf16_f32 v184, v172, v173
    ds_write_b32 v232, v184 offset:6528
    ds_read_b128 v[204:207], v233 offset:4352
    ds_read_b128 v[208:211], v233 offset:4416
    ds_read_b128 v[212:215], v233 offset:4480
    ds_read_b128 v[216:219], v233 offset:4544
    s_waitcnt lgkmcnt(0)
    v_mfma_f32_16x16x32_bf16 v[228:231], v[204:207], v[188:191], 0
    v_mfma_f32_16x16x32_bf16 v[228:231], v[208:211], v[192:195], v[228:231]
    v_mfma_f32_16x16x32_bf16 v[228:231], v[212:215], v[196:199], v[228:231]
    v_mfma_f32_16x16x32_bf16 v[228:231], v[216:219], v[200:203], v[228:231]
    v_lshlrev_b32 v236, 4, v1
    v_add_u32 v236, s78, v236
    s_cmp_eq_u32 s77, 0
    s_cbranch_scc1 kg_t1_40
    ds_write_b128 v236, v[220:223] offset:0
    ds_write_b128 v236, v[224:227] offset:1024
    s_nop 1
    ds_write_b128 v236, v[228:231] offset:2048
kg_t1_40:
    s_branch aux_j_41
aux_mv_38:
    s_lshl_b32 s23, s2, 1
    s_add_u32 s23, s23, s16
    s_sub_u32 s23, s23, 6
    s_add_u32 s27, s23, 0
    s_min_u32 s27, s27, 647
    s_mul_i32 s17, s27, 10923
    s_lshr_b32 s17, s17, 16
    s_mul_i32 s18, s17, 6
    s_sub_u32 s18, s27, s18
    s_mul_i32 s19, s17, 3641
    s_lshr_b32 s19, s19, 16
    s_mul_i32 s20, s19, 18
    s_sub_u32 s17, s17, s20
    s_mul_i32 s19, s19, 6
    s_add_u32 s18, s18, s19
    s_lshl_b32 s18, s18, 5
    v_and_b32 v8, 15, v1
    v_lshrrev_b32 v9, 4, v1
    v_lshrrev_b32 v10, 1, v9
    v_mul_u32_u24 v10, 18, v10
    v_and_b32 v12, 1, v9
    v_lshl_add_u32 v10, v12, 3, v10
    v_mul_u32_u24 v9, 72, v9
    s_cmp_ge_u32 s17, 16
    s_cselect_b64 vcc, -1, 0
    v_cndmask_b32 v10, v10, v9, vcc
    v_mul_u32_u24 v10, 1152, v10
    v_lshl_add_u32 v10, v8, 1, v10
    s_mul_i32 s19, s17, 41472
    s_sub_u32 s20, s17, 16
    s_mul_i32 s20, s20, 331776
    s_add_u32 s20, s20, 18432
    s_cmp_ge_u32 s17, 16
    s_cselect_b32 s17, s20, s19
    s_mov_b32 s19, 1152
    s_cselect_b32 s19, 19584, s19
    s_add_u32 s17, s17, s18
    buffer_load_ushort v12, v10, s[12:15], s17 offen
    s_add_u32 s17, s17, 1152
    buffer_load_ushort v13, v10, s[12:15], s17 offen
    s_add_u32 s17, s17, s19
    buffer_load_ushort v14, v10, s[12:15], s17 offen
    s_add_u32 s17, s17, 1152
    buffer_load_ushort v15, v10, s[12:15], s17 offen
    s_add_u32 s17, s17, s19
    buffer_load_ushort v16, v10, s[12:15], s17 offen
    s_add_u32 s17, s17, 1152
    buffer_load_ushort v17, v10, s[12:15], s17 offen
    s_add_u32 s17, s17, s19
    buffer_load_ushort v18, v10, s[12:15], s17 offen
    s_add_u32 s17, s17, 1152
    buffer_load_ushort v19, v10, s[12:15], s17 offen
    s_add_u32 s28, s23, 128
    s_min_u32 s28, s28, 647
    s_mul_i32 s17, s28, 10923
    s_lshr_b32 s17, s17, 16
    s_mul_i32 s18, s17, 6
    s_sub_u32 s18, s28, s18
    s_mul_i32 s19, s17, 3641
    s_lshr_b32 s19, s19, 16
    s_mul_i32 s20, s19, 18
    s_sub_u32 s17, s17, s20
    s_mul_i32 s19, s19, 6
    s_add_u32 s18, s18, s19
    s_lshl_b32 s18, s18, 5
    v_and_b32 v24, 15, v1
    v_lshrrev_b32 v25, 4, v1
    v_lshrrev_b32 v26, 1, v25
    v_mul_u32_u24 v26, 18, v26
    v_and_b32 v28, 1, v25
    v_lshl_add_u32 v26, v28, 3, v26
    v_mul_u32_u24 v25, 72, v25
    s_cmp_ge_u32 s17, 16
    s_cselect_b64 vcc, -1, 0
    v_cndmask_b32 v26, v26, v25, vcc
    v_mul_u32_u24 v26, 1152, v26
    v_lshl_add_u32 v26, v24, 1, v26
    s_mul_i32 s19, s17, 41472
    s_sub_u32 s20, s17, 16
    s_mul_i32 s20, s20, 331776
    s_add_u32 s20, s20, 18432
    s_cmp_ge_u32 s17, 16
    s_cselect_b32 s17, s20, s19
    s_mov_b32 s19, 1152
    s_cselect_b32 s19, 19584, s19
    s_add_u32 s17, s17, s18
    buffer_load_ushort v28, v26, s[12:15], s17 offen
    s_add_u32 s17, s17, 1152
    buffer_load_ushort v29, v26, s[12:15], s17 offen
    s_add_u32 s17, s17, s19
    buffer_load_ushort v30, v26, s[12:15], s17 offen
    s_add_u32 s17, s17, 1152
    buffer_load_ushort v31, v26, s[12:15], s17 offen
    s_add_u32 s17, s17, s19
    buffer_load_ushort v32, v26, s[12:15], s17 offen
    s_add_u32 s17, s17, 1152
    buffer_load_ushort v33, v26, s[12:15], s17 offen
    s_add_u32 s17, s17, s19
    buffer_load_ushort v34, v26, s[12:15], s17 offen
    s_add_u32 s17, s17, 1152
    buffer_load_ushort v35, v26, s[12:15], s17 offen
    s_add_u32 s29, s23, 256
    s_min_u32 s29, s29, 647
    s_mul_i32 s17, s29, 10923
    s_lshr_b32 s17, s17, 16
    s_mul_i32 s18, s17, 6
    s_sub_u32 s18, s29, s18
    s_mul_i32 s19, s17, 3641
    s_lshr_b32 s19, s19, 16
    s_mul_i32 s20, s19, 18
    s_sub_u32 s17, s17, s20
    s_mul_i32 s19, s19, 6
    s_add_u32 s18, s18, s19
    s_lshl_b32 s18, s18, 5
    v_and_b32 v40, 15, v1
    v_lshrrev_b32 v41, 4, v1
    v_lshrrev_b32 v42, 1, v41
    v_mul_u32_u24 v42, 18, v42
    v_and_b32 v44, 1, v41
    v_lshl_add_u32 v42, v44, 3, v42
    v_mul_u32_u24 v41, 72, v41
    s_cmp_ge_u32 s17, 16
    s_cselect_b64 vcc, -1, 0
    v_cndmask_b32 v42, v42, v41, vcc
    v_mul_u32_u24 v42, 1152, v42
    v_lshl_add_u32 v42, v40, 1, v42
    s_mul_i32 s19, s17, 41472
    s_sub_u32 s20, s17, 16
    s_mul_i32 s20, s20, 331776
    s_add_u32 s20, s20, 18432
    s_cmp_ge_u32 s17, 16
    s_cselect_b32 s17, s20, s19
    s_mov_b32 s19, 1152
    s_cselect_b32 s19, 19584, s19
    s_add_u32 s17, s17, s18
    buffer_load_ushort v44, v42, s[12:15], s17 offen
    s_add_u32 s17, s17, 1152
    buffer_load_ushort v45, v42, s[12:15], s17 offen
    s_add_u32 s17, s17, s19
    buffer_load_ushort v46, v42, s[12:15], s17 offen
    s_add_u32 s17, s17, 1152
    buffer_load_ushort v47, v42, s[12:15], s17 offen
    s_add_u32 s17, s17, s19
    buffer_load_ushort v48, v42, s[12:15], s17 offen
    s_add_u32 s17, s17, 1152
    buffer_load_ushort v49, v42, s[12:15], s17 offen
    s_add_u32 s17, s17, s19
    buffer_load_ushort v50, v42, s[12:15], s17 offen
    s_add_u32 s17, s17, 1152
    buffer_load_ushort v51, v42, s[12:15], s17 offen
    s_waitcnt vmcnt(0)
    v_lshlrev_b32 v8, 4, v1
    s_lshl_b32 s17, s27, 10
    s_add_u32 s17, s17, 23068672
    v_lshl_or_b32 v20, v13, 16, v12
    v_lshl_or_b32 v21, v15, 16, v14
    v_lshl_or_b32 v22, v17, 16, v16
    v_lshl_or_b32 v23, v19, 16, v18
    buffer_store_dwordx4 v[20:23], v8, s[4:7], s17 offen sc1
    v_lshlrev_b32 v24, 4, v1
    s_lshl_b32 s17, s28, 10
    s_add_u32 s17, s17, 23068672
    v_lshl_or_b32 v36, v29, 16, v28
    v_lshl_or_b32 v37, v31, 16, v30
    v_lshl_or_b32 v38, v33, 16, v32
    v_lshl_or_b32 v39, v35, 16, v34
    buffer_store_dwordx4 v[36:39], v24, s[4:7], s17 offen sc1
    v_lshlrev_b32 v40, 4, v1
    s_lshl_b32 s17, s29, 10
    s_add_u32 s17, s17, 23068672
    v_lshl_or_b32 v52, v45, 16, v44
    v_lshl_or_b32 v53, v47, 16, v46
    v_lshl_or_b32 v54, v49, 16, v48
    v_lshl_or_b32 v55, v51, 16, v50
    buffer_store_dwordx4 v[52:55], v40, s[4:7], s17 offen sc1
    s_add_u32 s27, s23, 384
    s_min_u32 s27, s27, 647
    s_mul_i32 s17, s27, 10923
    s_lshr_b32 s17, s17, 16
    s_mul_i32 s18, s17, 6
    s_sub_u32 s18, s27, s18
    s_mul_i32 s19, s17, 3641
    s_lshr_b32 s19, s19, 16
    s_mul_i32 s20, s19, 18
    s_sub_u32 s17, s17, s20
    s_mul_i32 s19, s19, 6
    s_add_u32 s18, s18, s19
    s_lshl_b32 s18, s18, 5
    v_and_b32 v8, 15, v1
    v_lshrrev_b32 v9, 4, v1
    v_lshrrev_b32 v10, 1, v9
    v_mul_u32_u24 v10, 18, v10
    v_and_b32 v12, 1, v9
    v_lshl_add_u32 v10, v12, 3, v10
    v_mul_u32_u24 v9, 72, v9
    s_cmp_ge_u32 s17, 16
    s_cselect_b64 vcc, -1, 0
    v_cndmask_b32 v10, v10, v9, vcc
    v_mul_u32_u24 v10, 1152, v10
    v_lshl_add_u32 v10, v8, 1, v10
    s_mul_i32 s19, s17, 41472
    s_sub_u32 s20, s17, 16
    s_mul_i32 s20, s20, 331776
    s_add_u32 s20, s20, 18432
    s_cmp_ge_u32 s17, 16
    s_cselect_b32 s17, s20, s19
    s_mov_b32 s19, 1152
    s_cselect_b32 s19, 19584, s19
    s_add_u32 s17, s17, s18
    buffer_load_ushort v12, v10, s[12:15], s17 offen
    s_add_u32 s17, s17, 1152
    buffer_load_ushort v13, v10, s[12:15], s17 offen
    s_add_u32 s17, s17, s19
    buffer_load_ushort v14, v10, s[12:15], s17 offen
    s_add_u32 s17, s17, 1152
    buffer_load_ushort v15, v10, s[12:15], s17 offen
    s_add_u32 s17, s17, s19
    buffer_load_ushort v16, v10, s[12:15], s17 offen
    s_add_u32 s17, s17, 1152
    buffer_load_ushort v17, v10, s[12:15], s17 offen
    s_add_u32 s17, s17, s19
    buffer_load_ushort v18, v10, s[12:15], s17 offen
    s_add_u32 s17, s17, 1152
    buffer_load_ushort v19, v10, s[12:15], s17 offen
    s_add_u32 s28, s23, 512
    s_min_u32 s28, s28, 647
    s_mul_i32 s17, s28, 10923
    s_lshr_b32 s17, s17, 16
    s_mul_i32 s18, s17, 6
    s_sub_u32 s18, s28, s18
    s_mul_i32 s19, s17, 3641
    s_lshr_b32 s19, s19, 16
    s_mul_i32 s20, s19, 18
    s_sub_u32 s17, s17, s20
    s_mul_i32 s19, s19, 6
    s_add_u32 s18, s18, s19
    s_lshl_b32 s18, s18, 5
    v_and_b32 v24, 15, v1
    v_lshrrev_b32 v25, 4, v1
    v_lshrrev_b32 v26, 1, v25
    v_mul_u32_u24 v26, 18, v26
    v_and_b32 v28, 1, v25
    v_lshl_add_u32 v26, v28, 3, v26
    v_mul_u32_u24 v25, 72, v25
    s_cmp_ge_u32 s17, 16
    s_cselect_b64 vcc, -1, 0
    v_cndmask_b32 v26, v26, v25, vcc
    v_mul_u32_u24 v26, 1152, v26
    v_lshl_add_u32 v26, v24, 1, v26
    s_mul_i32 s19, s17, 41472
    s_sub_u32 s20, s17, 16
    s_mul_i32 s20, s20, 331776
    s_add_u32 s20, s20, 18432
    s_cmp_ge_u32 s17, 16
    s_cselect_b32 s17, s20, s19
    s_mov_b32 s19, 1152
    s_cselect_b32 s19, 19584, s19
    s_add_u32 s17, s17, s18
    buffer_load_ushort v28, v26, s[12:15], s17 offen
    s_add_u32 s17, s17, 1152
    buffer_load_ushort v29, v26, s[12:15], s17 offen
    s_add_u32 s17, s17, s19
    buffer_load_ushort v30, v26, s[12:15], s17 offen
    s_add_u32 s17, s17, 1152
    buffer_load_ushort v31, v26, s[12:15], s17 offen
    s_add_u32 s17, s17, s19
    buffer_load_ushort v32, v26, s[12:15], s17 offen
    s_add_u32 s17, s17, 1152
    buffer_load_ushort v33, v26, s[12:15], s17 offen
    s_add_u32 s17, s17, s19
    buffer_load_ushort v34, v26, s[12:15], s17 offen
    s_add_u32 s17, s17, 1152
    buffer_load_ushort v35, v26, s[12:15], s17 offen
    s_add_u32 s29, s23, 640
    s_min_u32 s29, s29, 647
    s_mul_i32 s17, s29, 10923
    s_lshr_b32 s17, s17, 16
    s_mul_i32 s18, s17, 6
    s_sub_u32 s18, s29, s18
    s_mul_i32 s19, s17, 3641
    s_lshr_b32 s19, s19, 16
    s_mul_i32 s20, s19, 18
    s_sub_u32 s17, s17, s20
    s_mul_i32 s19, s19, 6
    s_add_u32 s18, s18, s19
    s_lshl_b32 s18, s18, 5
    v_and_b32 v40, 15, v1
    v_lshrrev_b32 v41, 4, v1
    v_lshrrev_b32 v42, 1, v41
    v_mul_u32_u24 v42, 18, v42
    v_and_b32 v44, 1, v41
    v_lshl_add_u32 v42, v44, 3, v42
    v_mul_u32_u24 v41, 72, v41
    s_cmp_ge_u32 s17, 16
    s_cselect_b64 vcc, -1, 0
    v_cndmask_b32 v42, v42, v41, vcc
    v_mul_u32_u24 v42, 1152, v42
    v_lshl_add_u32 v42, v40, 1, v42
    s_mul_i32 s19, s17, 41472
    s_sub_u32 s20, s17, 16
    s_mul_i32 s20, s20, 331776
    s_add_u32 s20, s20, 18432
    s_cmp_ge_u32 s17, 16
    s_cselect_b32 s17, s20, s19
    s_mov_b32 s19, 1152
    s_cselect_b32 s19, 19584, s19
    s_add_u32 s17, s17, s18
    buffer_load_ushort v44, v42, s[12:15], s17 offen
    s_add_u32 s17, s17, 1152
    buffer_load_ushort v45, v42, s[12:15], s17 offen
    s_add_u32 s17, s17, s19
    buffer_load_ushort v46, v42, s[12:15], s17 offen
    s_add_u32 s17, s17, 1152
    buffer_load_ushort v47, v42, s[12:15], s17 offen
    s_add_u32 s17, s17, s19
    buffer_load_ushort v48, v42, s[12:15], s17 offen
    s_add_u32 s17, s17, 1152
    buffer_load_ushort v49, v42, s[12:15], s17 offen
    s_add_u32 s17, s17, s19
    buffer_load_ushort v50, v42, s[12:15], s17 offen
    s_add_u32 s17, s17, 1152
    buffer_load_ushort v51, v42, s[12:15], s17 offen
    s_waitcnt vmcnt(0)
    v_lshlrev_b32 v8, 4, v1
    s_lshl_b32 s17, s27, 10
    s_add_u32 s17, s17, 23068672
    v_lshl_or_b32 v20, v13, 16, v12
    v_lshl_or_b32 v21, v15, 16, v14
    v_lshl_or_b32 v22, v17, 16, v16
    v_lshl_or_b32 v23, v19, 16, v18
    buffer_store_dwordx4 v[20:23], v8, s[4:7], s17 offen sc1
    v_lshlrev_b32 v24, 4, v1
    s_lshl_b32 s17, s28, 10
    s_add_u32 s17, s17, 23068672
    v_lshl_or_b32 v36, v29, 16, v28
    v_lshl_or_b32 v37, v31, 16, v30
    v_lshl_or_b32 v38, v33, 16, v32
    v_lshl_or_b32 v39, v35, 16, v34
    buffer_store_dwordx4 v[36:39], v24, s[4:7], s17 offen sc1
    v_lshlrev_b32 v40, 4, v1
    s_lshl_b32 s17, s29, 10
    s_add_u32 s17, s17, 23068672
    v_lshl_or_b32 v52, v45, 16, v44
    v_lshl_or_b32 v53, v47, 16, v46
    v_lshl_or_b32 v54, v49, 16, v48
    v_lshl_or_b32 v55, v51, 16, v50
    buffer_store_dwordx4 v[52:55], v40, s[4:7], s17 offen sc1
aux_j_41:
    s_waitcnt lgkmcnt(0)
    s_barrier
    s_cmp_ge_u32 s16, 6
    s_cbranch_scc1 aux_nok2_42
    s_cmp_eq_u32 s77, 1
    s_cbranch_scc1 kg_t2_43
    ds_read_b128 v[204:207], v236 offset:8704
    ds_read_b128 v[208:211], v236 offset:9728
    ds_read_b128 v[212:215], v236 offset:10752
    v_and_b32 v188, 15, v1
    v_lshrrev_b32 v189, 4, v1
    v_lshrrev_b32 v190, 1, v189
    v_lshlrev_b32 v190, 7, v190
    v_and_b32 v191, 1, v189
    v_lshl_add_u32 v190, v191, 2, v190
    v_lshl_add_u32 v146, v188, 3, v190
    v_lshlrev_b32 v190, 6, v189
    v_lshl_add_u32 v191, v188, 1, v190
    v_add_u32 v149, v190, v188
    v_lshl_add_u32 v190, v188, 2, v190
    v_cmp_gt_u32 vcc, 2, v189
    s_nop 1
    v_cndmask_b32 v147, v191, v190, vcc
    v_add_u32 v147, 256, v147
    v_add_u32 v149, 512, v149
    v_mov_b32 v190, 64
    v_mov_b32 v191, 4
    v_cndmask_b32 v148, v190, v191, vcc
    v_lshlrev_b32 v146, 1, v146
    v_add_u32 v146, s79, v146
    v_lshlrev_b32 v147, 1, v147
    v_add_u32 v147, s79, v147
    v_lshlrev_b32 v149, 1, v149
    v_add_u32 v149, s79, v149
    v_add_u32 v148, v148, v147
    s_waitcnt lgkmcnt(0)
    v_add_f32 v220, v220, v204
    v_add_f32 v221, v221, v205
    v_add_f32 v222, v222, v206
    v_add_f32 v223, v223, v207
    v_add_f32 v224, v224, v208
    v_add_f32 v225, v225, v209
    v_add_f32 v226, v226, v210
    v_add_f32 v227, v227, v211
    v_add_f32 v228, v228, v212
    v_add_f32 v229, v229, v213
    v_add_f32 v230, v230, v214
    v_add_f32 v231, v231, v215
    v_cvt_pk_bf16_f32 v220, v220, v221
    v_cvt_pk_bf16_f32 v221, v222, v223
    v_cvt_pk_bf16_f32 v224, v224, v225
    v_cvt_pk_bf16_f32 v225, v226, v227
    v_cvt_pk_bf16_f32 v228, v228, v229
    v_cvt_pk_bf16_f32 v229, v230, v231
    ds_write_b16 v146, v220
    ds_write_b16_d16_hi v146, v220 offset:2
    ds_write_b16 v146, v221 offset:4
    ds_write_b16_d16_hi v146, v221 offset:6
    ds_write_b16 v147, v224
    ds_write_b16_d16_hi v147, v224 offset:2
    ds_write_b16 v148, v225
    ds_write_b16_d16_hi v148, v225 offset:2
    s_mov_b32 exec_hi, 0xffff
    ds_write_b16 v149, v228
    s_mov_b32 exec_hi, 0
    ds_write_b16_d16_hi v149, v228 offset:32
    ds_write_b16 v149, v229 offset:64
    ds_write_b16_d16_hi v149, v229 offset:96
    s_mov_b64 exec, -1
kg_t2_43:
aux_nok2_42:
    s_cmp_eq_u32 s25, 0
    s_cbranch_scc1 aux_notr2_44
    s_waitcnt vmcnt(0)
    s_mov_b32 s19, 0x05040100
    s_mov_b32 s20, 0x07060302
    v_perm_b32 v40, v12, v8, s19
    v_perm_b32 v41, v20, v16, s19
    v_perm_b32 v42, v28, v24, s19
    v_perm_b32 v43, v36, v32, s19
    v_perm_b32 v44, v12, v8, s20
    v_perm_b32 v45, v20, v16, s20
    v_perm_b32 v46, v28, v24, s20
    v_perm_b32 v47, v36, v32, s20
    v_perm_b32 v48, v13, v9, s19
    v_perm_b32 v49, v21, v17, s19
    v_perm_b32 v50, v29, v25, s19
    v_perm_b32 v51, v37, v33, s19
    v_perm_b32 v52, v13, v9, s20
    v_perm_b32 v53, v21, v17, s20
    v_perm_b32 v54, v29, v25, s20
    v_perm_b32 v55, v37, v33, s20
    v_perm_b32 v56, v14, v10, s19
    v_perm_b32 v57, v22, v18, s19
    v_perm_b32 v58, v30, v26, s19
    v_perm_b32 v59, v38, v34, s19
    v_perm_b32 v60, v14, v10, s20
    v_perm_b32 v61, v22, v18, s20
    v_perm_b32 v62, v30, v26, s20
    v_perm_b32 v63, v38, v34, s20
    v_perm_b32 v64, v15, v11, s19
    v_perm_b32 v65, v23, v19, s19
    v_perm_b32 v66, v31, v27, s19
    v_perm_b32 v67, v39, v35, s19
    v_perm_b32 v68, v15, v11, s20
    v_perm_b32 v69, v23, v19, s20
    v_perm_b32 v70, v31, v27, s20
    v_perm_b32 v71, v39, v35, s20
    buffer_store_dwordx4 v[40:43], v3, s[4:7], s24 offen sc1
    s_add_u32 s24, s24, 4096
    buffer_store_dwordx4 v[44:47], v3, s[4:7], s24 offen sc1
    s_add_u32 s24, s24, 4096
    buffer_store_dwordx4 v[48:51], v3, s[4:7], s24 offen sc1
    s_add_u32 s24, s24, 4096
    buffer_store_dwordx4 v[52:55], v3, s[4:7], s24 offen sc1
    s_add_u32 s24, s24, 4096
    buffer_store_dwordx4 v[56:59], v3, s[4:7], s24 offen sc1
    s_add_u32 s24, s24, 4096
    buffer_store_dwordx4 v[60:63], v3, s[4:7], s24 offen sc1
    s_add_u32 s24, s24, 4096
    buffer_store_dwordx4 v[64:67], v3, s[4:7], s24 offen sc1
    s_add_u32 s24, s24, 4096
    buffer_store_dwordx4 v[68:71], v3, s[4:7], s24 offen sc1
aux_notr2_44:
    s_waitcnt lgkmcnt(0)
    s_barrier
    s_cmp_ge_u32 s16, 6
    s_cbranch_scc1 aux_nok3_45
    s_cmp_eq_u32 s77, 0
    s_cbranch_scc1 kg_t3_46
    v_lshlrev_b32 v234, 4, v1
    v_add_u32 v235, s79, v234
    ds_read_b128 v[204:207], v235
    ds_read_b128 v[208:211], v235 offset:1024
    s_mul_i32 s80, s76, 1344
    s_add_u32 s80, s80, 11534336
    s_waitcnt lgkmcnt(0)
    buffer_store_dwordx4 v[204:207], v234, s[4:7], s80 offen sc1
    s_mov_b64 exec, 0xfffff
    buffer_store_dwordx4 v[208:211], v234, s[4:7], s80 offen offset:1024 sc1
    s_mov_b64 exec, -1
kg_t3_46:
aux_nok3_45:
    s_endpgm
k1_done:
k1_exit:
    s_endpgm
.section .rodata,"a"
.p2align 6
.amdhsa_kernel k1_kernel
  .amdhsa_next_free_vgpr 256
  .amdhsa_next_free_sgpr 102
  .amdhsa_accum_offset 256
  .amdhsa_group_segment_fixed_size 0
  .amdhsa_kernarg_size 104
  .amdhsa_user_sgpr_count 2
  .amdhsa_user_sgpr_kernarg_segment_ptr 1
  .amdhsa_system_sgpr_workgroup_id_x 1
.end_amdhsa_kernel
.text
.globl k2_kernel
.p2align 8
.type k2_kernel,@function
k2_kernel:
    s_cmp_ge_u32 s2, 400
    s_cbranch_scc1 k2_exit
    s_cmp_ge_u32 s2, 256
    s_cbranch_scc1 k2_role1
k2_role0:
    s_load_dwordx2 s[4:5], s[0:1], 96
    v_lshrrev_b32 v6, 6, v0
    v_and_b32 v1, 63, v0
    v_readfirstlane_b32 s16, v6
    s_and_b32 s19, s2, 31
    s_lshr_b32 s20, s2, 5
    v_lshlrev_b32 v5, 4, v1
    s_lshr_b32 s17, s16, 2
    s_and_b32 s18, s16, 3
    s_lshl_b32 s21, s17, 5
    s_add_u32 s21, s21, s18
    s_mul_i32 s21, s21, 2368
    s_mul_i32 s28, s19, 151552
    s_add_u32 s25, s21, s28
    s_mul_i32 s26, s16, 3072
    s_add_u32 s27, s26, 24576
    s_lshl_b32 s21, s19, 6
    s_lshl_b32 s22, s20, 3
    s_add_u32 s21, s21, s22
    s_lshl_b32 s22, s18, 1
    s_add_u32 s21, s21, s22
    s_mul_i32 s21, s21, 1152
    s_add_u32 s21, s21, 5242880
    s_add_u32 s22, s21, 1152
    v_and_b32 v6, 31, v1
    v_lshlrev_b32 v6, 2, v6
    s_waitcnt lgkmcnt(0)
    s_mov_b32 s6, 24117248
    s_mov_b32 s7, 0x20000
    s_mov_b32 m0, s26
    s_add_u32 s23, s25, 0
    buffer_load_dwordx4 v5, s[4:7], s23 offen lds
    buffer_load_dwordx4 v5, s[4:7], s23 offen offset:1024 lds
    s_mov_b64 exec, 0xfffff
    buffer_load_dwordx4 v5, s[4:7], s23 offen offset:2048 lds
    s_mov_b64 exec, -1
    s_add_u32 s25, s25, 9472
    buffer_load_dwordx4 v[88:91], v5, s[4:7], s21 offen
    buffer_load_dword v96, v6, s[4:7], s21 offen offset:1024
    buffer_load_dwordx4 v[92:95], v5, s[4:7], s22 offen
    buffer_load_dword v98, v6, s[4:7], s22 offen offset:1024
    s_mul_i32 s21, s17, 12288
    v_add_u32 v2, s21, v5
    v_and_b32 v6, 31, v1
    v_lshlrev_b32 v4, 2, v6
    v_add_u32 v4, s21, v4
    v_min_u32 v6, 18, v6
    v_lshrrev_b32 v7, 5, v1
    v_mul_u32_u24 v7, 19, v7
    v_add_u32 v6, v6, v7
    v_lshlrev_b32 v6, 4, v6
    v_add_u32 v3, s21, v6
    v_mov_b32 v105, 0x3f803f80
    v_mov_b32 v40, 0
    v_mov_b32 v41, 0
    v_mov_b32 v42, 0
    v_mov_b32 v43, 0
    v_mov_b32 v44, 0
    v_mov_b32 v45, 0
    v_mov_b32 v46, 0
    v_mov_b32 v47, 0
    v_mov_b32 v48, 0
    v_mov_b32 v49, 0
    v_mov_b32 v50, 0
    v_mov_b32 v51, 0
    v_mov_b32 v52, 0
    v_mov_b32 v53, 0
    v_mov_b32 v54, 0
    v_mov_b32 v55, 0
    v_mov_b32 v56, 0
    v_mov_b32 v57, 0
    v_mov_b32 v58, 0
    v_mov_b32 v59, 0
    v_mov_b32 v60, 0
    v_mov_b32 v61, 0
    v_mov_b32 v62, 0
    v_mov_b32 v63, 0
    v_mov_b32 v64, 0
    v_mov_b32 v65, 0
    v_mov_b32 v66, 0
    v_mov_b32 v67, 0
    v_mov_b32 v68, 0
    v_mov_b32 v69, 0
    v_mov_b32 v70, 0
    v_mov_b32 v71, 0
    v_mov_b32 v80, 0
    v_mov_b32 v81, 0
    v_mov_b32 v82, 0
    v_mov_b32 v83, 0
    v_mov_b32 v84, 0
    v_mov_b32 v85, 0
    v_mov_b32 v86, 0
    v_mov_b32 v87, 0
    v_mov_b32 v114, 0
    v_mov_b32 v118, 0
    v_mov_b32 v115, 0
    v_mov_b32 v119, 0
    v_mov_b32 v116, 0
    v_mov_b32 v120, 0
    v_mov_b32 v117, 0
    v_mov_b32 v121, 0
    s_mov_b32 s24, 0
    v_cmp_gt_u32 vcc, 32, v1
    s_waitcnt vmcnt(0)
    s_nop 0
    v_cndmask_b32 v96, 0, v96, vcc
    v_mov_b32 v97, 0
    v_cndmask_b32 v98, 0, v98, vcc
    v_mov_b32 v99, 0
    s_barrier
    s_mov_b32 m0, s27
    s_add_u32 s23, s25, 0
    buffer_load_dwordx4 v5, s[4:7], s23 offen lds
    buffer_load_dwordx4 v5, s[4:7], s23 offen offset:1024 lds
    buffer_load_dwordx4 v5, s[4:7], s23 offen offset:2048 lds
    s_add_u32 s25, s25, 9472
    s_lshr_b32 s21, s2, 3
    s_mul_i32 s21, s21, 3
    s_add_u32 s21, s21, s16
    s_cmp_ge_u32 s16, 3
    s_cbranch_scc1 attn_pf_10001
    s_cmp_ge_u32 s21, 81
    s_cbranch_scc1 attn_pf_10001
    s_lshl_b32 s21, s21, 13
    s_add_u32 s21, s21, 23068672
    v_lshlrev_b32 v6, 7, v1
    buffer_load_dword v7, v6, s[4:7], s21 offen
attn_pf_10001:
    ds_read_b128 v[100:103], v2 offset:0
    ds_read_b32 v104, v4 offset:1024
    ds_read_b128 v[106:109], v3 offset:1152
    ds_read_b128 v[110:113], v3 offset:1760
    s_waitcnt lgkmcnt(2)
    v_mfma_f32_32x32x16_bf16 v[8:23], v[100:103], v[88:91], 0
    v_mfma_f32_32x32x8_bf16 v[8:23], v[104:105], v[96:97], v[8:23]
    s_nop 11
.p2align 6
attn_loop_10002:
    v_mfma_f32_32x32x16_bf16 v[24:39], v[100:103], v[92:95], 0
    v_exp_f32 v8, v8
    v_exp_f32 v9, v9
    v_exp_f32 v10, v10
    v_exp_f32 v11, v11
    v_cvt_pk_bf16_f32 v72, v8, v9
    v_cvt_pk_bf16_f32 v73, v10, v11
    v_mfma_f32_32x32x8_bf16 v[24:39], v[104:105], v[98:99], v[24:39]
    ds_read_b128 v[100:103], v2 offset:3072
    ds_read_b32 v104, v4 offset:4096
    v_exp_f32 v12, v12
    v_exp_f32 v13, v13
    v_exp_f32 v14, v14
    v_exp_f32 v15, v15
    v_cvt_pk_bf16_f32 v74, v12, v13
    v_cvt_pk_bf16_f32 v75, v14, v15
    v_mfma_f32_32x32x16_bf16 v[56:71], v[114:117], v[80:83], v[56:71]
    v_exp_f32 v16, v16
    v_exp_f32 v17, v17
    v_exp_f32 v18, v18
    v_exp_f32 v19, v19
    v_cvt_pk_bf16_f32 v76, v16, v17
    v_cvt_pk_bf16_f32 v77, v18, v19
    v_mfma_f32_32x32x16_bf16 v[56:71], v[118:121], v[84:87], v[56:71]
    ds_read_b128 v[114:117], v3 offset:4224
    ds_read_b128 v[118:121], v3 offset:4832
    v_exp_f32 v20, v20
    v_exp_f32 v21, v21
    v_exp_f32 v22, v22
    v_exp_f32 v23, v23
    v_cvt_pk_bf16_f32 v78, v20, v21
    v_cvt_pk_bf16_f32 v79, v22, v23
    v_exp_f32 v24, v24
    s_waitcnt lgkmcnt(2)
    v_mfma_f32_32x32x16_bf16 v[8:23], v[100:103], v[88:91], 0
    v_exp_f32 v25, v25
    v_exp_f32 v26, v26
    v_exp_f32_e64 v27, v27
    v_cvt_pk_bf16_f32 v80, v24, v25
    v_cvt_pk_bf16_f32 v81, v26, v27
    v_mfma_f32_32x32x8_bf16 v[8:23], v[104:105], v[96:97], v[8:23]
    v_exp_f32 v28, v28
    v_exp_f32 v29, v29
    v_exp_f32 v30, v30
    v_exp_f32 v31, v31
    v_cvt_pk_bf16_f32 v82, v28, v29
    v_cvt_pk_bf16_f32 v83, v30, v31
    v_mfma_f32_32x32x16_bf16 v[40:55], v[106:109], v[72:75], v[40:55]
    v_exp_f32 v32, v32
    v_exp_f32 v33, v33
    v_exp_f32 v34, v34
    v_exp_f32 v35, v35
    v_cvt_pk_bf16_f32 v84, v32, v33
    v_cvt_pk_bf16_f32 v85, v34, v35
    v_mfma_f32_32x32x16_bf16 v[40:55], v[110:113], v[76:79], v[40:55]
    v_exp_f32 v36, v36
    v_exp_f32 v37, v37
    v_exp_f32 v38, v38
    v_exp_f32 v39, v39
    v_cvt_pk_bf16_f32 v86, v36, v37
    v_cvt_pk_bf16_f32 v87, v38, v39
    v_mfma_f32_32x32x16_bf16 v[24:39], v[100:103], v[92:95], 0
    v_exp_f32 v8, v8
    v_exp_f32 v9, v9
    v_exp_f32 v10, v10
    v_exp_f32 v11, v11
    v_cvt_pk_bf16_f32 v72, v8, v9
    v_cvt_pk_bf16_f32 v73, v10, v11
    v_mfma_f32_32x32x8_bf16 v[24:39], v[104:105], v[98:99], v[24:39]
    ds_read_b128 v[100:103], v2 offset:6144
    ds_read_b32 v104, v4 offset:7168
    v_exp_f32 v12, v12
    v_exp_f32 v13, v13
    v_exp_f32 v14, v14
    v_exp_f32 v15, v15
    v_cvt_pk_bf16_f32 v74, v12, v13
    v_cvt_pk_bf16_f32 v75, v14, v15
    v_mfma_f32_32x32x16_bf16 v[56:71], v[106:109], v[80:83], v[56:71]
    v_exp_f32 v16, v16
    v_exp_f32 v17, v17
    v_exp_f32 v18, v18
    v_exp_f32 v19, v19
    v_cvt_pk_bf16_f32 v76, v16, v17
    v_cvt_pk_bf16_f32 v77, v18, v19
    v_mfma_f32_32x32x16_bf16 v[56:71], v[110:113], v[84:87], v[56:71]
    ds_read_b128 v[106:109], v3 offset:7296
    ds_read_b128 v[110:113], v3 offset:7904
    v_exp_f32 v20, v20
    v_exp_f32 v21, v21
    v_exp_f32 v22, v22
    v_exp_f32 v23, v23
    v_cvt_pk_bf16_f32 v78, v20, v21
    v_cvt_pk_bf16_f32 v79, v22, v23
    v_exp_f32 v24, v24
    s_waitcnt lgkmcnt(2)
    v_mfma_f32_32x32x16_bf16 v[8:23], v[100:103], v[88:91], 0
    v_exp_f32 v25, v25
    v_exp_f32 v26, v26
    v_exp_f32_e64 v27, v27
    v_cvt_pk_bf16_f32 v80, v24, v25
    v_cvt_pk_bf16_f32 v81, v26, v27
    v_mfma_f32_32x32x8_bf16 v[8:23], v[104:105], v[96:97], v[8:23]
    v_exp_f32 v28, v28
    v_exp_f32 v29, v29
    v_exp_f32 v30, v30
    v_exp_f32 v31, v31
    v_cvt_pk_bf16_f32 v82, v28, v29
    v_cvt_pk_bf16_f32 v83, v30, v31
    v_mfma_f32_32x32x16_bf16 v[40:55], v[114:117], v[72:75], v[40:55]
    v_exp_f32 v32, v32
    v_exp_f32 v33, v33
    v_exp_f32 v34, v34
    v_exp_f32 v35, v35
    v_cvt_pk_bf16_f32 v84, v32, v33
    v_cvt_pk_bf16_f32 v85, v34, v35
    v_mfma_f32_32x32x16_bf16 v[40:55], v[118:121], v[76:79], v[40:55]
    v_exp_f32 v36, v36
    v_exp_f32 v37, v37
    v_exp_f32 v38, v38
    v_exp_f32 v39, v39
    v_cvt_pk_bf16_f32 v86, v36, v37
    v_cvt_pk_bf16_f32 v87, v38, v39
    v_mfma_f32_32x32x16_bf16 v[24:39], v[100:103], v[92:95], 0
    v_exp_f32 v8, v8
    v_exp_f32 v9, v9
    v_exp_f32 v10, v10
    v_exp_f32 v11, v11
    v_cvt_pk_bf16_f32 v72, v8, v9
    v_cvt_pk_bf16_f32 v73, v10, v11
    v_mfma_f32_32x32x8_bf16 v[24:39], v[104:105], v[98:99], v[24:39]
    ds_read_b128 v[100:103], v2 offset:9216
    ds_read_b32 v104, v4 offset:10240
    v_exp_f32 v12, v12
    v_exp_f32 v13, v13
    v_exp_f32 v14, v14
    v_exp_f32 v15, v15
    v_cvt_pk_bf16_f32 v74, v12, v13
    v_cvt_pk_bf16_f32 v75, v14, v15
    v_mfma_f32_32x32x16_bf16 v[56:71], v[114:117], v[80:83], v[56:71]
    v_exp_f32 v16, v16
    v_exp_f32 v17, v17
    v_exp_f32 v18, v18
    v_exp_f32 v19, v19
    v_cvt_pk_bf16_f32 v76, v16, v17
    v_cvt_pk_bf16_f32 v77, v18, v19
    v_mfma_f32_32x32x16_bf16 v[56:71], v[118:121], v[84:87], v[56:71]
    ds_read_b128 v[114:117], v3 offset:10368
    ds_read_b128 v[118:121], v3 offset:10976
    v_exp_f32 v20, v20
    v_exp_f32 v21, v21
    v_exp_f32 v22, v22
    v_exp_f32 v23, v23
    v_cvt_pk_bf16_f32 v78, v20, v21
    v_cvt_pk_bf16_f32 v79, v22, v23
    v_exp_f32 v24, v24
    s_waitcnt lgkmcnt(2)
    v_mfma_f32_32x32x16_bf16 v[8:23], v[100:103], v[88:91], 0
    v_exp_f32 v25, v25
    v_exp_f32 v26, v26
    v_exp_f32_e64 v27, v27
    v_cvt_pk_bf16_f32 v80, v24, v25
    v_cvt_pk_bf16_f32 v81, v26, v27
    v_mfma_f32_32x32x8_bf16 v[8:23], v[104:105], v[96:97], v[8:23]
    v_exp_f32 v28, v28
    v_exp_f32 v29, v29
    v_exp_f32 v30, v30
    v_exp_f32 v31, v31
    v_cvt_pk_bf16_f32 v82, v28, v29
    v_cvt_pk_bf16_f32 v83, v30, v31
    v_mfma_f32_32x32x16_bf16 v[40:55], v[106:109], v[72:75], v[40:55]
    v_exp_f32 v32, v32
    v_exp_f32 v33, v33
    v_exp_f32 v34, v34
    v_exp_f32 v35, v35
    v_cvt_pk_bf16_f32 v84, v32, v33
    v_cvt_pk_bf16_f32 v85, v34, v35
    v_mfma_f32_32x32x16_bf16 v[40:55], v[110:113], v[76:79], v[40:55]
    v_exp_f32 v36, v36
    v_exp_f32 v37, v37
    v_exp_f32 v38, v38
    v_exp_f32 v39, v39
    v_cvt_pk_bf16_f32 v86, v36, v37
    v_cvt_pk_bf16_f32 v87, v38, v39
    v_mfma_f32_32x32x16_bf16 v[24:39], v[100:103], v[92:95], 0
    v_exp_f32 v8, v8
    v_exp_f32 v9, v9
    v_exp_f32 v10, v10
    v_exp_f32 v11, v11
    v_cvt_pk_bf16_f32 v72, v8, v9
    v_cvt_pk_bf16_f32 v73, v10, v11
    v_exp_f32_e64 v12, v12
    s_waitcnt vmcnt(0) lgkmcnt(0)
    s_barrier
    v_mfma_f32_32x32x8_bf16 v[24:39], v[104:105], v[98:99], v[24:39]
    ds_read_b128 v[100:103], v2 offset:24576
    ds_read_b32 v104, v4 offset:25600
    v_exp_f32 v13, v13
    v_exp_f32 v14, v14
    v_exp_f32_e64 v15, v15
    v_cvt_pk_bf16_f32 v74, v12, v13
    v_cvt_pk_bf16_f32 v75, v14, v15
    v_mfma_f32_32x32x16_bf16 v[56:71], v[106:109], v[80:83], v[56:71]
    s_cmp_ge_u32 s24, 3
    s_cbranch_scc1 attn_nodma_10003
    s_mov_b32 m0, s26
    s_add_u32 s23, s25, 0
    buffer_load_dwordx4 v5, s[4:7], s23 offen lds
    buffer_load_dwordx4 v5, s[4:7], s23 offen offset:1024 lds
    buffer_load_dwordx4 v5, s[4:7], s23 offen offset:2048 lds
    s_add_u32 s25, s25, 9472
attn_nodma_10003:
    v_exp_f32 v16, v16
    v_exp_f32 v17, v17
    v_exp_f32 v18, v18
    v_exp_f32 v19, v19
    v_cvt_pk_bf16_f32 v76, v16, v17
    v_cvt_pk_bf16_f32 v77, v18, v19
    v_mfma_f32_32x32x16_bf16 v[56:71], v[110:113], v[84:87], v[56:71]
    ds_read_b128 v[106:109], v3 offset:25728
    ds_read_b128 v[110:113], v3 offset:26336
    v_exp_f32 v20, v20
    v_exp_f32 v21, v21
    v_exp_f32 v22, v22
    v_exp_f32 v23, v23
    v_cvt_pk_bf16_f32 v78, v20, v21
    v_cvt_pk_bf16_f32 v79, v22, v23
    v_exp_f32 v24, v24
    s_waitcnt lgkmcnt(2)
    v_mfma_f32_32x32x16_bf16 v[8:23], v[100:103], v[88:91], 0
    v_exp_f32 v25, v25
    v_exp_f32 v26, v26
    v_exp_f32_e64 v27, v27
    v_cvt_pk_bf16_f32 v80, v24, v25
    v_cvt_pk_bf16_f32 v81, v26, v27
    v_mfma_f32_32x32x8_bf16 v[8:23], v[104:105], v[96:97], v[8:23]
    v_exp_f32 v28, v28
    v_exp_f32 v29, v29
    v_exp_f32 v30, v30
    v_exp_f32 v31, v31
    v_cvt_pk_bf16_f32 v82, v28, v29
    v_cvt_pk_bf16_f32 v83, v30, v31
    v_mfma_f32_32x32x16_bf16 v[40:55], v[114:117], v[72:75], v[40:55]
    v_exp_f32 v32, v32
    v_exp_f32 v33, v33
    v_exp_f32 v34, v34
    v_exp_f32 v35, v35
    v_cvt_pk_bf16_f32 v84, v32, v33
    v_cvt_pk_bf16_f32 v85, v34, v35
    v_mfma_f32_32x32x16_bf16 v[40:55], v[118:121], v[76:79], v[40:55]
    v_exp_f32 v36, v36
    v_exp_f32 v37, v37
    v_exp_f32 v38, v38
    v_exp_f32 v39, v39
    v_cvt_pk_bf16_f32 v86, v36, v37
    v_cvt_pk_bf16_f32 v87, v38, v39
    v_mfma_f32_32x32x16_bf16 v[24:39], v[100:103], v[92:95], 0
    v_exp_f32 v8, v8
    v_exp_f32 v9, v9
    v_exp_f32 v10, v10
    v_exp_f32 v11, v11
    v_cvt_pk_bf16_f32 v72, v8, v9
    v_cvt_pk_bf16_f32 v73, v10, v11
    v_mfma_f32_32x32x8_bf16 v[24:39], v[104:105], v[98:99], v[24:39]
    ds_read_b128 v[100:103], v2 offset:27648
    ds_read_b32 v104, v4 offset:28672
    v_exp_f32 v12, v12
    v_exp_f32 v13, v13
    v_exp_f32 v14, v14
    v_exp_f32 v15, v15
    v_cvt_pk_bf16_f32 v74, v12, v13
    v_cvt_pk_bf16_f32 v75, v14, v15
    v_mfma_f32_32x32x16_bf16 v[56:71], v[114:117], v[80:83], v[56:71]
    v_exp_f32 v16, v16
    v_exp_f32 v17, v17
    v_exp_f32 v18, v18
    v_exp_f32 v19, v19
    v_cvt_pk_bf16_f32 v76, v16, v17
    v_cvt_pk_bf16_f32 v77, v18, v19
    v_mfma_f32_32x32x16_bf16 v[56:71], v[118:121], v[84:87], v[56:71]
    ds_read_b128 v[114:117], v3 offset:28800
    ds_read_b128 v[118:121], v3 offset:29408
    v_exp_f32 v20, v20
    v_exp_f32 v21, v21
    v_exp_f32 v22, v22
    v_exp_f32 v23, v23
    v_cvt_pk_bf16_f32 v78, v20, v21
    v_cvt_pk_bf16_f32 v79, v22, v23
    v_exp_f32 v24, v24
    s_waitcnt lgkmcnt(2)
    v_mfma_f32_32x32x16_bf16 v[8:23], v[100:103], v[88:91], 0
    v_exp_f32 v25, v25
    v_exp_f32 v26, v26
    v_exp_f32_e64 v27, v27
    v_cvt_pk_bf16_f32 v80, v24, v25
    v_cvt_pk_bf16_f32 v81, v26, v27
    v_mfma_f32_32x32x8_bf16 v[8:23], v[104:105], v[96:97], v[8:23]
    v_exp_f32 v28, v28
    v_exp_f32 v29, v29
    v_exp_f32 v30, v30
    v_exp_f32 v31, v31
    v_cvt_pk_bf16_f32 v82, v28, v29
    v_cvt_pk_bf16_f32 v83, v30, v31
    v_mfma_f32_32x32x16_bf16 v[40:55], v[106:109], v[72:75], v[40:55]
    v_exp_f32 v32, v32
    v_exp_f32 v33, v33
    v_exp_f32 v34, v34
    v_exp_f32 v35, v35
    v_cvt_pk_bf16_f32 v84, v32, v33
    v_cvt_pk_bf16_f32 v85, v34, v35
    v_mfma_f32_32x32x16_bf16 v[40:55], v[110:113], v[76:79], v[40:55]
    v_exp_f32 v36, v36
    v_exp_f32 v37, v37
    v_exp_f32 v38, v38
    v_exp_f32 v39, v39
    v_cvt_pk_bf16_f32 v86, v36, v37
    v_cvt_pk_bf16_f32 v87, v38, v39
    v_mfma_f32_32x32x16_bf16 v[24:39], v[100:103], v[92:95], 0
    v_exp_f32 v8, v8
    v_exp_f32 v9, v9
    v_exp_f32 v10, v10
    v_exp_f32 v11, v11
    v_cvt_pk_bf16_f32 v72, v8, v9
    v_cvt_pk_bf16_f32 v73, v10, v11
    v_mfma_f32_32x32x8_bf16 v[24:39], v[104:105], v[98:99], v[24:39]
    ds_read_b128 v[100:103], v2 offset:30720
    ds_read_b32 v104, v4 offset:31744
    v_exp_f32 v12, v12
    v_exp_f32 v13, v13
    v_exp_f32 v14, v14
    v_exp_f32 v15, v15
    v_cvt_pk_bf16_f32 v74, v12, v13
    v_cvt_pk_bf16_f32 v75, v14, v15
    v_mfma_f32_32x32x16_bf16 v[56:71], v[106:109], v[80:83], v[56:71]
    v_exp_f32 v16, v16
    v_exp_f32 v17, v17
    v_exp_f32 v18, v18
    v_exp_f32 v19, v19
    v_cvt_pk_bf16_f32 v76, v16, v17
    v_cvt_pk_bf16_f32 v77, v18, v19
    v_mfma_f32_32x32x16_bf16 v[56:71], v[110:113], v[84:87], v[56:71]
    ds_read_b128 v[106:109], v3 offset:31872
    ds_read_b128 v[110:113], v3 offset:32480
    v_exp_f32 v20, v20
    v_exp_f32 v21, v21
    v_exp_f32 v22, v22
    v_exp_f32 v23, v23
    v_cvt_pk_bf16_f32 v78, v20, v21
    v_cvt_pk_bf16_f32 v79, v22, v23
    v_exp_f32 v24, v24
    s_waitcnt lgkmcnt(2)
    v_mfma_f32_32x32x16_bf16 v[8:23], v[100:103], v[88:91], 0
    v_exp_f32 v25, v25
    v_exp_f32 v26, v26
    v_exp_f32_e64 v27, v27
    v_cvt_pk_bf16_f32 v80, v24, v25
    v_cvt_pk_bf16_f32 v81, v26, v27
    v_mfma_f32_32x32x8_bf16 v[8:23], v[104:105], v[96:97], v[8:23]
    v_exp_f32 v28, v28
    v_exp_f32 v29, v29
    v_exp_f32 v30, v30
    v_exp_f32 v31, v31
    v_cvt_pk_bf16_f32 v82, v28, v29
    v_cvt_pk_bf16_f32 v83, v30, v31
    v_mfma_f32_32x32x16_bf16 v[40:55], v[114:117], v[72:75], v[40:55]
    v_exp_f32 v32, v32
    v_exp_f32 v33, v33
    v_exp_f32 v34, v34
    v_exp_f32 v35, v35
    v_cvt_pk_bf16_f32 v84, v32, v33
    v_cvt_pk_bf16_f32 v85, v34, v35
    v_mfma_f32_32x32x16_bf16 v[40:55], v[118:121], v[76:79], v[40:55]
    v_exp_f32 v36, v36
    v_exp_f32 v37, v37
    v_exp_f32 v38, v38
    v_exp_f32 v39, v39
    v_cvt_pk_bf16_f32 v86, v36, v37
    v_cvt_pk_bf16_f32 v87, v38, v39
    v_mfma_f32_32x32x16_bf16 v[24:39], v[100:103], v[92:95], 0
    v_exp_f32 v8, v8
    v_exp_f32 v9, v9
    v_exp_f32 v10, v10
    v_exp_f32 v11, v11
    v_cvt_pk_bf16_f32 v72, v8, v9
    v_cvt_pk_bf16_f32 v73, v10, v11
    v_mfma_f32_32x32x8_bf16 v[24:39], v[104:105], v[98:99], v[24:39]
    ds_read_b128 v[100:103], v2 offset:33792
    ds_read_b32 v104, v4 offset:34816
    v_exp_f32 v12, v12
    v_exp_f32 v13, v13
    v_exp_f32 v14, v14
    v_exp_f32 v15, v15
    v_cvt_pk_bf16_f32 v74, v12, v13
    v_cvt_pk_bf16_f32 v75, v14, v15
    v_mfma_f32_32x32x16_bf16 v[56:71], v[114:117], v[80:83], v[56:71]
    v_exp_f32 v16, v16
    v_exp_f32 v17, v17
    v_exp_f32 v18, v18
    v_exp_f32 v19, v19
    v_cvt_pk_bf16_f32 v76, v16, v17
    v_cvt_pk_bf16_f32 v77, v18, v19
    v_mfma_f32_32x32x16_bf16 v[56:71], v[118:121], v[84:87], v[56:71]
    ds_read_b128 v[114:117], v3 offset:34944
    ds_read_b128 v[118:121], v3 offset:35552
    v_exp_f32 v20, v20
    v_exp_f32 v21, v21
    v_exp_f32 v22, v22
    v_exp_f32 v23, v23
    v_cvt_pk_bf16_f32 v78, v20, v21
    v_cvt_pk_bf16_f32 v79, v22, v23
    v_exp_f32 v24, v24
    s_waitcnt lgkmcnt(2)
    v_mfma_f32_32x32x16_bf16 v[8:23], v[100:103], v[88:91], 0
    v_exp_f32 v25, v25
    v_exp_f32 v26, v26
    v_exp_f32_e64 v27, v27
    v_cvt_pk_bf16_f32 v80, v24, v25
    v_cvt_pk_bf16_f32 v81, v26, v27
    v_mfma_f32_32x32x8_bf16 v[8:23], v[104:105], v[96:97], v[8:23]
    v_exp_f32 v28, v28
    v_exp_f32 v29, v29
    v_exp_f32 v30, v30
    v_exp_f32 v31, v31
    v_cvt_pk_bf16_f32 v82, v28, v29
    v_cvt_pk_bf16_f32 v83, v30, v31
    v_mfma_f32_32x32x16_bf16 v[40:55], v[106:109], v[72:75], v[40:55]
    v_exp_f32 v32, v32
    v_exp_f32 v33, v33
    v_exp_f32 v34, v34
    v_exp_f32 v35, v35
    v_cvt_pk_bf16_f32 v84, v32, v33
    v_cvt_pk_bf16_f32 v85, v34, v35
    v_mfma_f32_32x32x16_bf16 v[40:55], v[110:113], v[76:79], v[40:55]
    v_exp_f32 v36, v36
    v_exp_f32 v37, v37
    v_exp_f32 v38, v38
    v_exp_f32 v39, v39
    v_cvt_pk_bf16_f32 v86, v36, v37
    v_cvt_pk_bf16_f32 v87, v38, v39
    v_mfma_f32_32x32x16_bf16 v[24:39], v[100:103], v[92:95], 0
    v_exp_f32 v8, v8
    v_exp_f32 v9, v9
    v_exp_f32 v10, v10
    v_exp_f32 v11, v11
    v_cvt_pk_bf16_f32 v72, v8, v9
    v_cvt_pk_bf16_f32 v73, v10, v11
    v_exp_f32_e64 v12, v12
    s_waitcnt vmcnt(0) lgkmcnt(0)
    s_barrier
    v_mfma_f32_32x32x8_bf16 v[24:39], v[104:105], v[98:99], v[24:39]
    ds_read_b128 v[100:103], v2 offset:0
    ds_read_b32 v104, v4 offset:1024
    v_exp_f32 v13, v13
    v_exp_f32 v14, v14
    v_exp_f32_e64 v15, v15
    v_cvt_pk_bf16_f32 v74, v12, v13
    v_cvt_pk_bf16_f32 v75, v14, v15
    v_mfma_f32_32x32x16_bf16 v[56:71], v[106:109], v[80:83], v[56:71]
    s_cmp_ge_u32 s24, 3
    s_cbranch_scc1 attn_nodma_10004
    s_mov_b32 m0, s27
    s_add_u32 s23, s25, 0
    buffer_load_dwordx4 v5, s[4:7], s23 offen lds
    buffer_load_dwordx4 v5, s[4:7], s23 offen offset:1024 lds
    buffer_load_dwordx4 v5, s[4:7], s23 offen offset:2048 lds
    s_add_u32 s25, s25, 9472
attn_nodma_10004:
    v_exp_f32 v16, v16
    v_exp_f32 v17, v17
    v_exp_f32 v18, v18
    v_exp_f32 v19, v19
    v_cvt_pk_bf16_f32 v76, v16, v17
    v_cvt_pk_bf16_f32 v77, v18, v19
    v_mfma_f32_32x32x16_bf16 v[56:71], v[110:113], v[84:87], v[56:71]
    ds_read_b128 v[106:109], v3 offset:1152
    ds_read_b128 v[110:113], v3 offset:1760
    v_exp_f32 v20, v20
    v_exp_f32 v21, v21
    v_exp_f32 v22, v22
    v_exp_f32 v23, v23
    v_cvt_pk_bf16_f32 v78, v20, v21
    v_cvt_pk_bf16_f32 v79, v22, v23
    v_exp_f32 v24, v24
    s_waitcnt lgkmcnt(2)
    v_mfma_f32_32x32x16_bf16 v[8:23], v[100:103], v[88:91], 0
    v_exp_f32 v25, v25
    v_exp_f32 v26, v26
    v_exp_f32_e64 v27, v27
    v_cvt_pk_bf16_f32 v80, v24, v25
    v_cvt_pk_bf16_f32 v81, v26, v27
    v_mfma_f32_32x32x8_bf16 v[8:23], v[104:105], v[96:97], v[8:23]
    v_exp_f32 v28, v28
    v_exp_f32 v29, v29
    v_exp_f32 v30, v30
    v_exp_f32 v31, v31
    v_cvt_pk_bf16_f32 v82, v28, v29
    v_cvt_pk_bf16_f32 v83, v30, v31
    v_mfma_f32_32x32x16_bf16 v[40:55], v[114:117], v[72:75], v[40:55]
    v_exp_f32 v32, v32
    v_exp_f32 v33, v33
    v_exp_f32 v34, v34
    v_exp_f32 v35, v35
    v_cvt_pk_bf16_f32 v84, v32, v33
    v_cvt_pk_bf16_f32 v85, v34, v35
    v_mfma_f32_32x32x16_bf16 v[40:55], v[118:121], v[76:79], v[40:55]
    v_exp_f32 v36, v36
    v_exp_f32 v37, v37
    v_exp_f32 v38, v38
    v_exp_f32 v39, v39
    v_cvt_pk_bf16_f32 v86, v36, v37
    v_cvt_pk_bf16_f32 v87, v38, v39
    s_add_u32 s24, s24, 1
    s_cmp_lt_u32 s24, 4
    s_cbranch_scc1 attn_loop_10002
    v_mfma_f32_32x32x16_bf16 v[56:71], v[114:117], v[80:83], v[56:71]
    v_mfma_f32_32x32x16_bf16 v[56:71], v[118:121], v[84:87], v[56:71]
    s_mul_i32 s21, s18, 6144
    s_add_u32 s21, s21, 49152
    v_add_u32 v6, s21, v5
    s_cmp_eq_u32 s17, 1
    s_cbranch_scc1 attn_h1_10005
    s_nop 6
    ds_write_b128 v6, v[56:59] offset:3072
    ds_write_b128 v6, v[60:63] offset:4096
    ds_write_b128 v6, v[64:67] offset:5120
    s_branch attn_join_10006
attn_h1_10005:
    ds_write_b128 v6, v[40:43] offset:0
    ds_write_b128 v6, v[44:47] offset:1024
    ds_write_b128 v6, v[48:51] offset:2048
    s_nop 3
    v_mov_b32 v40, v56
    v_mov_b32 v41, v57
    v_mov_b32 v42, v58
    v_mov_b32 v43, v59
    v_mov_b32 v44, v60
    v_mov_b32 v45, v61
    v_mov_b32 v46, v62
    v_mov_b32 v47, v63
    v_mov_b32 v48, v64
    v_mov_b32 v49, v65
    v_mov_b32 v50, v66
    v_mov_b32 v51, v67
    v_mov_b32 v88, v92
    v_mov_b32 v89, v93
    v_mov_b32 v90, v94
    v_mov_b32 v91, v95
    v_mov_b32 v96, v98
    v_add_u32 v6, 3072, v6
attn_join_10006:
    s_waitcnt lgkmcnt(0)
    s_barrier
    ds_read_b128 v[8:11], v6 offset:0
    ds_read_b128 v[12:15], v6 offset:1024
    ds_read_b128 v[16:19], v6 offset:2048
    s_lshl_b32 s21, s20, 8
    s_lshl_b32 s22, s18, 6
    s_add_u32 s21, s21, s22
    s_lshl_b32 s22, s17, 5
    s_add_u32 s21, s21, s22
    s_lshl_b32 s22, s19, 11
    s_add_u32 s22, s21, s22
    s_lshl_b32 s22, s22, 5
    s_add_u32 s22, s22, 8388608
    s_lshr_b32 s23, s19, 3
    s_add_u32 s23, s23, 32
    s_lshl_b32 s23, s23, 11
    s_add_u32 s21, s21, s23
    s_lshl_b32 s21, s21, 5
    s_and_b32 s23, s19, 7
    s_lshl_b32 s23, s23, 2
    s_add_u32 s21, s21, s23
    s_add_u32 s21, s21, 8388608
    s_waitcnt lgkmcnt(0)
    v_add_f32 v40, v40, v8
    v_add_f32 v41, v41, v9
    v_add_f32 v42, v42, v10
    v_add_f32 v43, v43, v11
    v_add_f32 v44, v44, v12
    v_add_f32 v45, v45, v13
    v_add_f32 v46, v46, v14
    v_add_f32 v47, v47, v15
    v_add_f32 v48, v48, v16
    v_add_f32 v49, v49, v17
    v_add_f32 v50, v50, v18
    v_add_f32 v51, v51, v19
    v_mul_f32 v24, 0, v40
    v_fma_f32 v24, v41, 0, v24
    v_fma_f32 v24, v42, 0, v24
    v_fma_f32 v24, v43, 0, v24
    v_fma_f32 v24, v44, 0, v24
    v_fma_f32 v24, v45, 0, v24
    v_fma_f32 v24, v46, 0, v24
    v_fma_f32 v24, v47, 0, v24
    v_fma_f32 v24, v48, 0, v24
    v_fma_f32 v24, v49, 0, v24
    v_add_f32 v24, v24, v50
    s_mov_b32 s23, 0x2b800000
    v_cmp_le_f32 vcc, s23, v24
    s_mov_b32 s23, 0x53800000
    v_cmp_ge_f32 s[34:35], s23, v24
    s_nop 0
    s_and_b64 vcc, vcc, s[34:35]
    s_cmp_eq_u64 vcc, -1
    s_cbranch_scc0 attn_fallback_10008
attn_store_10007:
    s_nop 7
    v_rcp_f32 v6, v50
    s_nop 0
    v_mul_f32 v40, v40, v6
    v_mul_f32 v41, v41, v6
    v_mul_f32 v42, v42, v6
    v_mul_f32 v43, v43, v6
    v_mul_f32 v44, v44, v6
    v_mul_f32 v45, v45, v6
    v_mul_f32 v46, v46, v6
    v_mul_f32 v47, v47, v6
    v_mul_f32 v48, v48, v6
    v_mul_f32 v49, v49, v6
    v_cvt_pk_bf16_f32 v72, v40, v41
    v_cvt_pk_bf16_f32 v73, v42, v43
    v_cvt_pk_bf16_f32 v74, v44, v45
    v_cvt_pk_bf16_f32 v75, v46, v47
    v_cvt_pk_bf16_f32 v80, v48, v49
    v_and_b32 v6, 31, v1
    v_lshrrev_b32 v7, 5, v1
    v_permlane32_swap_b32 v72, v74
    v_permlane32_swap_b32 v73, v75
    v_lshlrev_b32 v8, 5, v6
    v_lshl_add_u32 v8, v7, 4, v8
    v_lshlrev_b32 v6, 5, v6
    buffer_store_dwordx4 v[72:75], v8, s[4:7], s22 offen sc1
    s_mov_b32 exec_lo, -1
    s_mov_b32 exec_hi, 0x0
    buffer_store_dword v80, v6, s[4:7], s21 offen sc1
    s_mov_b64 exec, -1
    s_endpgm
attn_fallback_10008:
    v_and_b32 v7, 31, v1
    v_lshlrev_b32 v4, 2, v7
    s_mul_i32 s23, s17, 12288
    v_subrev_u32 v3, s23, v3
    v_mov_b32 v25, 0xff7fffff
    v_mov_b32 v97, 0
    s_mov_b32 s24, s28
    s_add_u32 s25, s28, 151552
attn_fb_10009:
    buffer_load_dwordx4 v[100:103], v5, s[4:7], s24 offen
    buffer_load_dword v104, v4, s[4:7], s24 offen offset:1024
    s_waitcnt vmcnt(0)
    v_mfma_f32_32x32x16_bf16 v[8:23], v[100:103], v[88:91], 0
    v_mfma_f32_32x32x8_bf16 v[8:23], v[104:105], v[96:97], v[8:23]
    s_nop 11
    v_max3_f32 v25, v8, v9, v25
    v_max3_f32 v25, v10, v11, v25
    v_max3_f32 v25, v12, v13, v25
    v_max3_f32 v25, v14, v15, v25
    v_max3_f32 v25, v16, v17, v25
    v_max3_f32 v25, v18, v19, v25
    v_max3_f32 v25, v20, v21, v25
    v_max3_f32 v25, v22, v23, v25
    s_add_u32 s24, s24, 2368
    s_cmp_lt_u32 s24, s25
    s_cbranch_scc1 attn_fb_10009
    v_mov_b32 v6, v25
    s_nop 1
    v_permlane32_swap_b32 v6, v25
    v_max_f32 v25, v6, v25
    v_cmp_gt_u32 vcc, 32, v1
    v_cvt_pk_bf16_f32 v6, -v25, -v25
    v_lshlrev_b32 v7, 16, v6
    v_sub_f32 v7, -v25, v7
    v_cvt_pk_bf16_f32 v7, v7, v7
    v_and_b32 v6, 0xffff, v6
    v_lshl_or_b32 v6, v7, 16, v6
    v_cndmask_b32 v97, 0, v6, vcc
    v_mov_b32 v40, 0
    v_mov_b32 v41, 0
    v_mov_b32 v42, 0
    v_mov_b32 v43, 0
    v_mov_b32 v44, 0
    v_mov_b32 v45, 0
    v_mov_b32 v46, 0
    v_mov_b32 v47, 0
    v_mov_b32 v48, 0
    v_mov_b32 v49, 0
    v_mov_b32 v50, 0
    v_mov_b32 v51, 0
    v_mov_b32 v52, 0
    v_mov_b32 v53, 0
    v_mov_b32 v54, 0
    v_mov_b32 v55, 0
    s_mov_b32 s24, s28
    s_add_u32 s25, s28, 151552
attn_fb_10010:
    buffer_load_dwordx4 v[100:103], v5, s[4:7], s24 offen
    buffer_load_dword v104, v4, s[4:7], s24 offen offset:1024
    buffer_load_dwordx4 v[106:109], v3, s[4:7], s24 offen offset:1152
    buffer_load_dwordx4 v[110:113], v3, s[4:7], s24 offen offset:1760
    s_waitcnt vmcnt(0)
    v_mfma_f32_32x32x16_bf16 v[8:23], v[100:103], v[88:91], 0
    v_mfma_f32_32x32x8_bf16 v[8:23], v[104:105], v[96:97], v[8:23]
    s_nop 11
    v_exp_f32 v8, v8
    v_exp_f32 v9, v9
    v_exp_f32 v10, v10
    v_exp_f32 v11, v11
    v_cvt_pk_bf16_f32 v72, v8, v9
    v_cvt_pk_bf16_f32 v73, v10, v11
    v_exp_f32 v12, v12
    v_exp_f32 v13, v13
    v_exp_f32 v14, v14
    v_exp_f32 v15, v15
    v_cvt_pk_bf16_f32 v74, v12, v13
    v_cvt_pk_bf16_f32 v75, v14, v15
    v_exp_f32 v16, v16
    v_exp_f32 v17, v17
    v_exp_f32 v18, v18
    v_exp_f32 v19, v19
    v_cvt_pk_bf16_f32 v76, v16, v17
    v_cvt_pk_bf16_f32 v77, v18, v19
    v_exp_f32 v20, v20
    v_exp_f32 v21, v21
    v_exp_f32 v22, v22
    v_exp_f32 v23, v23
    v_cvt_pk_bf16_f32 v78, v20, v21
    v_cvt_pk_bf16_f32 v79, v22, v23
    v_mfma_f32_32x32x16_bf16 v[40:55], v[106:109], v[72:75], v[40:55]
    s_nop 0
    v_mfma_f32_32x32x16_bf16 v[40:55], v[110:113], v[76:79], v[40:55]
    s_add_u32 s24, s24, 2368
    s_cmp_lt_u32 s24, s25
    s_cbranch_scc1 attn_fb_10010
    s_branch attn_store_10007
k2_role1:
    s_sub_u32 s2, s2, 256
    v_lshrrev_b32 v2, 6, v0
    v_and_b32 v1, 63, v0
    v_readfirstlane_b32 s16, v2
    s_nop 0
    s_cmp_ge_u32 s16, 4
    s_cbranch_scc1 k2_done
    s_load_dwordx2 s[4:5], s[0:1], 96
    s_load_dwordx2 s[8:9], s[0:1], 48
    s_lshl_b32 s17, s2, 2
    s_add_u32 s17, s17, s16
    s_mul_i32 s21, s16, 14272
    s_add_u32 s22, s21, 12928
    v_lshlrev_b32 v14, 4, v1
    s_mul_i32 s18, s17, 1344
    s_add_u32 s18, s18, 11534336
    s_lshl_b32 s19, s17, 12
    s_add_u32 s19, s19, 16777216
    s_waitcnt lgkmcnt(0)
    s_mov_b32 s6, 24117248
    s_mov_b32 s7, 0x20000
    s_mov_b32 m0, s22
    s_add_u32 s20, s21, 8832
    buffer_load_dwordx4 v14, s[4:7], s18 offen lds
    s_mov_b64 exec, 0xfffff
    buffer_load_dwordx4 v14, s[4:7], s18 offen offset:1024 lds
    s_mov_b64 exec, -1
    s_mov_b32 m0, s20
    s_nop 0
    buffer_load_dwordx4 v14, s[4:7], s19 offen offset:0 lds
    buffer_load_dwordx4 v14, s[4:7], s19 offen offset:1024 lds
    buffer_load_dwordx4 v14, s[4:7], s19 offen offset:2048 lds
    buffer_load_dwordx4 v14, s[4:7], s19 offen offset:3072 lds
    s_lshl_b32 s18, s17, 1
    v_mov_b32 v15, s18
    global_load_ushort v15, v15, s[8:9]
    v_and_b32 v2, 15, v1
    v_lshrrev_b32 v3, 4, v1
    v_lshrrev_b32 v4, 1, v3
    v_lshl_add_u32 v5, v4, 4, v2
    v_sub_u32 v6, v2, v4
    v_and_b32 v13, 1, v3
    v_lshlrev_b32 v7, 3, v13
    v_sub_u32 v5, v7, v5
    v_add_u32 v5, 2047, v5
    v_and_b32 v5, 0xfffffffe, v5
    v_lshlrev_b32 v5, 1, v5
    v_lshlrev_b32 v6, 5, v6
    v_lshl_add_u32 v6, v13, 4, v6
    s_add_u32 s18, s21, 8384
    v_add_u32 v13, s18, v6
    v_and_b32 v2, 1, v2
    v_xor_b32 v2, 1, v2
    v_mul_u32_u24 v2, 4160, v2
    v_add_u32 v5, v5, v2
    s_sub_u32 s18, s21, 448
    v_add_u32 v5, s18, v5
    v_subrev_u32 v6, 512, v5
    v_subrev_u32 v7, 1024, v5
    v_subrev_u32 v8, 1536, v5
    v_subrev_u32 v9, 2048, v5
    v_subrev_u32 v10, 2560, v5
    v_subrev_u32 v11, 3072, v5
    v_subrev_u32 v12, 3584, v5
    s_waitcnt vmcnt(5)
    v_lshlrev_b32 v2, 4, v1
    v_add_u32 v2, s21, v2
    s_mov_b32 s40, 0x1000100
    s_mov_b32 s41, 0x3020302
    s_mov_b32 s42, 0x5040100
    s_mov_b32 s43, 0x1000302
    s_mov_b32 s46, 0x7060100
    v_sub_u32 v3, 255, v1
    v_lshlrev_b32 v4, 1, v3
    v_add_u32 v4, s22, v4
    ds_read_u16 v64, v4 offset:768
    ds_read_u16 v65, v4 offset:770
    v_sub_u32 v3, 191, v1
    v_lshlrev_b32 v4, 1, v3
    v_add_u32 v4, s22, v4
    ds_read_u16 v66, v4 offset:768
    ds_read_u16 v67, v4 offset:770
    v_sub_u32 v3, 127, v1
    v_lshlrev_b32 v4, 2, v3
    v_add_u32 v4, s22, v4
    ds_read_u16 v68, v4 offset:512
    ds_read_u16 v70, v4 offset:514
    ds_read_u16 v69, v4 offset:516
    v_sub_u32 v3, 63, v1
    v_lshlrev_b32 v72, 3, v3
    v_add_u32 v72, 256, v72
    v_lshlrev_b32 v73, 4, v3
    v_add_u32 v72, s22, v72
    v_add_u32 v73, s22, v73
    ds_read_u16 v32, v72 offset:0
    ds_read_u16 v33, v72 offset:2
    ds_read_u16 v34, v72 offset:4
    ds_read_u16 v35, v72 offset:6
    ds_read_u16 v36, v72 offset:8
    ds_read_u16 v55, v73 offset:0
    ds_read_u16 v54, v73 offset:2
    ds_read_u16 v53, v73 offset:4
    ds_read_u16 v52, v73 offset:6
    ds_read_u16 v51, v73 offset:8
    ds_read_u16 v50, v73 offset:10
    ds_read_u16 v49, v73 offset:12
    ds_read_u16 v48, v73 offset:14
    v_subrev_u32 v73, 2, v73
    ds_read_u16 v56, v73
    v_and_b32 v3, 1, v1
    v_cmp_eq_u32 vcc, 1, v3
    s_waitcnt lgkmcnt(0)
    v_lshl_or_b32 v64, v65, 16, v64
    v_perm_b32 v16, v64, v64, s41
    v_perm_b32 v18, v64, v64, s40
    v_mov_b32 v19, v18
    v_cndmask_b32 v65, v16, v18, vcc
    v_perm_b32 v17, v65, v16, s42
    v_mov_b32 v20, v16
    v_perm_b32 v21, v18, v65, s42
    v_mov_b32 v22, v18
    v_mov_b32 v23, v18
    ds_write_b128 v2, v[16:19] offset:0
    ds_write_b128 v2, v[20:23] offset:4160
    v_lshl_or_b32 v66, v67, 16, v66
    v_perm_b32 v40, v66, v66, s41
    v_perm_b32 v42, v66, v66, s40
    v_mov_b32 v43, v42
    v_cndmask_b32 v67, v40, v42, vcc
    v_perm_b32 v41, v67, v40, s42
    v_mov_b32 v44, v40
    v_perm_b32 v45, v42, v67, s42
    v_mov_b32 v46, v42
    v_mov_b32 v47, v42
    ds_write_b128 v2, v[40:43] offset:1024
    ds_write_b128 v2, v[44:47] offset:5184
    v_lshl_or_b32 v68, v70, 16, v68
    v_perm_b32 v24, v69, v69, s40
    v_perm_b32 v25, v68, v68, s41
    v_perm_b32 v26, v68, v68, s43
    v_perm_b32 v27, v68, v68, s40
    v_perm_b32 v76, v68, v69, s46
    v_mov_b32 v77, v25
    v_mov_b32 v78, v27
    v_mov_b32 v79, v27
    ds_write_b128 v2, v[24:27] offset:2048
    ds_write_b128 v2, v[76:79] offset:6208
    v_cmp_gt_u32 vcc, 32, v1
    s_nop 1
    v_cndmask_b32 v48, v48, v36, vcc
    v_cndmask_b32 v49, v49, v35, vcc
    v_cndmask_b32 v50, v50, v34, vcc
    v_cndmask_b32 v51, v51, v34, vcc
    v_cndmask_b32 v52, v52, v34, vcc
    v_cndmask_b32 v53, v53, v33, vcc
    v_cndmask_b32 v54, v54, v32, vcc
    v_cndmask_b32 v55, v55, v32, vcc
    v_cmp_gt_u32 vcc, 31, v1
    s_nop 1
    v_cndmask_b32 v56, v56, v32, vcc
    v_cmp_eq_u32 vcc, 63, v1
    v_mov_b32 v72, 0
    s_nop 0
    v_cndmask_b32 v56, v56, v72, vcc
    v_lshl_or_b32 v60, v49, 16, v48
    v_lshl_or_b32 v61, v51, 16, v50
    v_lshl_or_b32 v62, v53, 16, v52
    v_lshl_or_b32 v63, v55, 16, v54
    v_alignbit_b32 v64, v61, v60, 16
    v_alignbit_b32 v65, v62, v61, 16
    v_alignbit_b32 v66, v63, v62, 16
    v_alignbit_b32 v67, v56, v63, 16
    ds_write_b128 v2, v[60:63] offset:3072
    ds_write_b128 v2, v[64:67] offset:7232
    v_mov_b32 v68, 0
    v_mov_b32 v69, 0
    v_mov_b32 v70, 0
    v_mov_b32 v71, 0
    s_mov_b64 exec, 0xf
    ds_write_b128 v2, v[68:71] offset:4096
    ds_write_b128 v2, v[68:71] offset:8256
    s_mov_b32 exec_lo, -1
    s_mov_b32 exec_hi, 0x0
    ds_write_b128 v2, v[68:71] offset:8320
    s_mov_b64 exec, -1
    s_waitcnt vmcnt(0) lgkmcnt(0)
    ds_read2_b32 v[48:49], v5 offset0:112 offset1:113
    ds_read2_b32 v[50:51], v5 offset0:114 offset1:115
    ds_read_b128 v[108:111], v13 offset:4032
    ds_read2_b32 v[52:53], v6 offset0:112 offset1:113
    ds_read2_b32 v[54:55], v6 offset0:114 offset1:115
    ds_read_b128 v[104:107], v13 offset:3520
    ds_read2_b32 v[56:57], v7 offset0:112 offset1:113
    ds_read2_b32 v[58:59], v7 offset0:114 offset1:115
    ds_read_b128 v[100:103], v13 offset:3008
    ds_read2_b32 v[60:61], v8 offset0:112 offset1:113
    ds_read2_b32 v[62:63], v8 offset0:114 offset1:115
    ds_read_b128 v[96:99], v13 offset:2496
    ds_read2_b32 v[64:65], v9 offset0:112 offset1:113
    ds_read2_b32 v[66:67], v9 offset0:114 offset1:115
    ds_read_b128 v[92:95], v13 offset:1984
    ds_read2_b32 v[68:69], v10 offset0:112 offset1:113
    ds_read2_b32 v[70:71], v10 offset0:114 offset1:115
    ds_read_b128 v[88:91], v13 offset:1472
    ds_read2_b32 v[72:73], v11 offset0:112 offset1:113
    ds_read2_b32 v[74:75], v11 offset0:114 offset1:115
    ds_read_b128 v[84:87], v13 offset:960
    ds_read2_b32 v[76:77], v12 offset0:112 offset1:113
    ds_read2_b32 v[78:79], v12 offset0:114 offset1:115
    ds_read_b128 v[80:83], v13 offset:448
    s_waitcnt lgkmcnt(0)
    v_mfma_f32_16x16x32_bf16 v[44:47], v[48:51], v[108:111], 0
    v_mfma_f32_16x16x32_bf16 v[40:43], v[48:51], v[104:107], 0
    v_mfma_f32_16x16x32_bf16 v[36:39], v[48:51], v[100:103], 0
    v_mfma_f32_16x16x32_bf16 v[32:35], v[48:51], v[96:99], 0
    v_mfma_f32_16x16x32_bf16 v[28:31], v[48:51], v[92:95], 0
    v_mfma_f32_16x16x32_bf16 v[24:27], v[48:51], v[88:91], 0
    v_mfma_f32_16x16x32_bf16 v[20:23], v[48:51], v[84:87], 0
    v_mfma_f32_16x16x32_bf16 v[16:19], v[48:51], v[80:83], 0
    ds_read2_b32 v[48:49], v5 offset0:96 offset1:97
    ds_read2_b32 v[50:51], v5 offset0:98 offset1:99
    ds_read_b128 v[108:111], v13 offset:3968
    v_mfma_f32_16x16x32_bf16 v[44:47], v[52:55], v[104:107], v[44:47]
    v_mfma_f32_16x16x32_bf16 v[40:43], v[52:55], v[100:103], v[40:43]
    v_mfma_f32_16x16x32_bf16 v[36:39], v[52:55], v[96:99], v[36:39]
    v_mfma_f32_16x16x32_bf16 v[32:35], v[52:55], v[92:95], v[32:35]
    v_mfma_f32_16x16x32_bf16 v[28:31], v[52:55], v[88:91], v[28:31]
    v_mfma_f32_16x16x32_bf16 v[24:27], v[52:55], v[84:87], v[24:27]
    v_mfma_f32_16x16x32_bf16 v[20:23], v[52:55], v[80:83], v[20:23]
    ds_read2_b32 v[52:53], v6 offset0:96 offset1:97
    ds_read2_b32 v[54:55], v6 offset0:98 offset1:99
    ds_read_b128 v[104:107], v13 offset:3456
    v_mfma_f32_16x16x32_bf16 v[44:47], v[56:59], v[100:103], v[44:47]
    v_mfma_f32_16x16x32_bf16 v[40:43], v[56:59], v[96:99], v[40:43]
    v_mfma_f32_16x16x32_bf16 v[36:39], v[56:59], v[92:95], v[36:39]
    v_mfma_f32_16x16x32_bf16 v[32:35], v[56:59], v[88:91], v[32:35]
    v_mfma_f32_16x16x32_bf16 v[28:31], v[56:59], v[84:87], v[28:31]
    v_mfma_f32_16x16x32_bf16 v[24:27], v[56:59], v[80:83], v[24:27]
    ds_read2_b32 v[56:57], v7 offset0:96 offset1:97
    ds_read2_b32 v[58:59], v7 offset0:98 offset1:99
    ds_read_b128 v[100:103], v13 offset:2944
    v_mfma_f32_16x16x32_bf16 v[44:47], v[60:63], v[96:99], v[44:47]
    v_mfma_f32_16x16x32_bf16 v[40:43], v[60:63], v[92:95], v[40:43]
    v_mfma_f32_16x16x32_bf16 v[36:39], v[60:63], v[88:91], v[36:39]
    v_mfma_f32_16x16x32_bf16 v[32:35], v[60:63], v[84:87], v[32:35]
    v_mfma_f32_16x16x32_bf16 v[28:31], v[60:63], v[80:83], v[28:31]
    ds_read2_b32 v[60:61], v8 offset0:96 offset1:97
    ds_read2_b32 v[62:63], v8 offset0:98 offset1:99
    ds_read_b128 v[96:99], v13 offset:2432
    v_mfma_f32_16x16x32_bf16 v[44:47], v[64:67], v[92:95], v[44:47]
    v_mfma_f32_16x16x32_bf16 v[40:43], v[64:67], v[88:91], v[40:43]
    v_mfma_f32_16x16x32_bf16 v[36:39], v[64:67], v[84:87], v[36:39]
    v_mfma_f32_16x16x32_bf16 v[32:35], v[64:67], v[80:83], v[32:35]
    ds_read2_b32 v[64:65], v9 offset0:96 offset1:97
    ds_read2_b32 v[66:67], v9 offset0:98 offset1:99
    ds_read_b128 v[92:95], v13 offset:1920
    v_mfma_f32_16x16x32_bf16 v[44:47], v[68:71], v[88:91], v[44:47]
    v_mfma_f32_16x16x32_bf16 v[40:43], v[68:71], v[84:87], v[40:43]
    v_mfma_f32_16x16x32_bf16 v[36:39], v[68:71], v[80:83], v[36:39]
    ds_read2_b32 v[68:69], v10 offset0:96 offset1:97
    ds_read2_b32 v[70:71], v10 offset0:98 offset1:99
    ds_read_b128 v[88:91], v13 offset:1408
    v_mfma_f32_16x16x32_bf16 v[44:47], v[72:75], v[84:87], v[44:47]
    v_mfma_f32_16x16x32_bf16 v[40:43], v[72:75], v[80:83], v[40:43]
    ds_read2_b32 v[72:73], v11 offset0:96 offset1:97
    ds_read2_b32 v[74:75], v11 offset0:98 offset1:99
    ds_read_b128 v[84:87], v13 offset:896
    v_mfma_f32_16x16x32_bf16 v[44:47], v[76:79], v[80:83], v[44:47]
    ds_read2_b32 v[76:77], v12 offset0:96 offset1:97
    ds_read2_b32 v[78:79], v12 offset0:98 offset1:99
    ds_read_b128 v[80:83], v13 offset:384
    s_waitcnt lgkmcnt(3)
    v_mfma_f32_16x16x32_bf16 v[44:47], v[48:51], v[108:111], v[44:47]
    v_mfma_f32_16x16x32_bf16 v[40:43], v[48:51], v[104:107], v[40:43]
    v_mfma_f32_16x16x32_bf16 v[36:39], v[48:51], v[100:103], v[36:39]
    v_mfma_f32_16x16x32_bf16 v[32:35], v[48:51], v[96:99], v[32:35]
    v_mfma_f32_16x16x32_bf16 v[28:31], v[48:51], v[92:95], v[28:31]
    v_mfma_f32_16x16x32_bf16 v[24:27], v[48:51], v[88:91], v[24:27]
    v_mfma_f32_16x16x32_bf16 v[20:23], v[48:51], v[84:87], v[20:23]
    s_waitcnt lgkmcnt(0)
    v_mfma_f32_16x16x32_bf16 v[16:19], v[48:51], v[80:83], v[16:19]
    ds_read2_b32 v[48:49], v5 offset0:80 offset1:81
    ds_read2_b32 v[50:51], v5 offset0:82 offset1:83
    ds_read_b128 v[108:111], v13 offset:3904
    v_mfma_f32_16x16x32_bf16 v[44:47], v[52:55], v[104:107], v[44:47]
    v_mfma_f32_16x16x32_bf16 v[40:43], v[52:55], v[100:103], v[40:43]
    v_mfma_f32_16x16x32_bf16 v[36:39], v[52:55], v[96:99], v[36:39]
    v_mfma_f32_16x16x32_bf16 v[32:35], v[52:55], v[92:95], v[32:35]
    v_mfma_f32_16x16x32_bf16 v[28:31], v[52:55], v[88:91], v[28:31]
    v_mfma_f32_16x16x32_bf16 v[24:27], v[52:55], v[84:87], v[24:27]
    v_mfma_f32_16x16x32_bf16 v[20:23], v[52:55], v[80:83], v[20:23]
    ds_read2_b32 v[52:53], v6 offset0:80 offset1:81
    ds_read2_b32 v[54:55], v6 offset0:82 offset1:83
    ds_read_b128 v[104:107], v13 offset:3392
    v_mfma_f32_16x16x32_bf16 v[44:47], v[56:59], v[100:103], v[44:47]
    v_mfma_f32_16x16x32_bf16 v[40:43], v[56:59], v[96:99], v[40:43]
    v_mfma_f32_16x16x32_bf16 v[36:39], v[56:59], v[92:95], v[36:39]
    v_mfma_f32_16x16x32_bf16 v[32:35], v[56:59], v[88:91], v[32:35]
    v_mfma_f32_16x16x32_bf16 v[28:31], v[56:59], v[84:87], v[28:31]
    v_mfma_f32_16x16x32_bf16 v[24:27], v[56:59], v[80:83], v[24:27]
    ds_read2_b32 v[56:57], v7 offset0:80 offset1:81
    ds_read2_b32 v[58:59], v7 offset0:82 offset1:83
    ds_read_b128 v[100:103], v13 offset:2880
    v_mfma_f32_16x16x32_bf16 v[44:47], v[60:63], v[96:99], v[44:47]
    v_mfma_f32_16x16x32_bf16 v[40:43], v[60:63], v[92:95], v[40:43]
    v_mfma_f32_16x16x32_bf16 v[36:39], v[60:63], v[88:91], v[36:39]
    v_mfma_f32_16x16x32_bf16 v[32:35], v[60:63], v[84:87], v[32:35]
    v_mfma_f32_16x16x32_bf16 v[28:31], v[60:63], v[80:83], v[28:31]
    ds_read2_b32 v[60:61], v8 offset0:80 offset1:81
    ds_read2_b32 v[62:63], v8 offset0:82 offset1:83
    ds_read_b128 v[96:99], v13 offset:2368
    v_mfma_f32_16x16x32_bf16 v[44:47], v[64:67], v[92:95], v[44:47]
    v_mfma_f32_16x16x32_bf16 v[40:43], v[64:67], v[88:91], v[40:43]
    v_mfma_f32_16x16x32_bf16 v[36:39], v[64:67], v[84:87], v[36:39]
    v_mfma_f32_16x16x32_bf16 v[32:35], v[64:67], v[80:83], v[32:35]
    ds_read2_b32 v[64:65], v9 offset0:80 offset1:81
    ds_read2_b32 v[66:67], v9 offset0:82 offset1:83
    ds_read_b128 v[92:95], v13 offset:1856
    v_mfma_f32_16x16x32_bf16 v[44:47], v[68:71], v[88:91], v[44:47]
    v_mfma_f32_16x16x32_bf16 v[40:43], v[68:71], v[84:87], v[40:43]
    v_mfma_f32_16x16x32_bf16 v[36:39], v[68:71], v[80:83], v[36:39]
    ds_read2_b32 v[68:69], v10 offset0:80 offset1:81
    ds_read2_b32 v[70:71], v10 offset0:82 offset1:83
    ds_read_b128 v[88:91], v13 offset:1344
    v_mfma_f32_16x16x32_bf16 v[44:47], v[72:75], v[84:87], v[44:47]
    v_mfma_f32_16x16x32_bf16 v[40:43], v[72:75], v[80:83], v[40:43]
    ds_read2_b32 v[72:73], v11 offset0:80 offset1:81
    ds_read2_b32 v[74:75], v11 offset0:82 offset1:83
    ds_read_b128 v[84:87], v13 offset:832
    v_mfma_f32_16x16x32_bf16 v[44:47], v[76:79], v[80:83], v[44:47]
    ds_read2_b32 v[76:77], v12 offset0:80 offset1:81
    ds_read2_b32 v[78:79], v12 offset0:82 offset1:83
    ds_read_b128 v[80:83], v13 offset:320
    s_waitcnt lgkmcnt(3)
    v_mfma_f32_16x16x32_bf16 v[44:47], v[48:51], v[108:111], v[44:47]
    v_mfma_f32_16x16x32_bf16 v[40:43], v[48:51], v[104:107], v[40:43]
    v_mfma_f32_16x16x32_bf16 v[36:39], v[48:51], v[100:103], v[36:39]
    v_mfma_f32_16x16x32_bf16 v[32:35], v[48:51], v[96:99], v[32:35]
    v_mfma_f32_16x16x32_bf16 v[28:31], v[48:51], v[92:95], v[28:31]
    v_mfma_f32_16x16x32_bf16 v[24:27], v[48:51], v[88:91], v[24:27]
    v_mfma_f32_16x16x32_bf16 v[20:23], v[48:51], v[84:87], v[20:23]
    s_waitcnt lgkmcnt(0)
    v_mfma_f32_16x16x32_bf16 v[16:19], v[48:51], v[80:83], v[16:19]
    ds_read2_b32 v[48:49], v5 offset0:64 offset1:65
    ds_read2_b32 v[50:51], v5 offset0:66 offset1:67
    ds_read_b128 v[108:111], v13 offset:3840
    v_mfma_f32_16x16x32_bf16 v[44:47], v[52:55], v[104:107], v[44:47]
    v_mfma_f32_16x16x32_bf16 v[40:43], v[52:55], v[100:103], v[40:43]
    v_mfma_f32_16x16x32_bf16 v[36:39], v[52:55], v[96:99], v[36:39]
    v_mfma_f32_16x16x32_bf16 v[32:35], v[52:55], v[92:95], v[32:35]
    v_mfma_f32_16x16x32_bf16 v[28:31], v[52:55], v[88:91], v[28:31]
    v_mfma_f32_16x16x32_bf16 v[24:27], v[52:55], v[84:87], v[24:27]
    v_mfma_f32_16x16x32_bf16 v[20:23], v[52:55], v[80:83], v[20:23]
    ds_read2_b32 v[52:53], v6 offset0:64 offset1:65
    ds_read2_b32 v[54:55], v6 offset0:66 offset1:67
    ds_read_b128 v[104:107], v13 offset:3328
    v_mfma_f32_16x16x32_bf16 v[44:47], v[56:59], v[100:103], v[44:47]
    v_mfma_f32_16x16x32_bf16 v[40:43], v[56:59], v[96:99], v[40:43]
    v_mfma_f32_16x16x32_bf16 v[36:39], v[56:59], v[92:95], v[36:39]
    v_mfma_f32_16x16x32_bf16 v[32:35], v[56:59], v[88:91], v[32:35]
    v_mfma_f32_16x16x32_bf16 v[28:31], v[56:59], v[84:87], v[28:31]
    v_mfma_f32_16x16x32_bf16 v[24:27], v[56:59], v[80:83], v[24:27]
    ds_read2_b32 v[56:57], v7 offset0:64 offset1:65
    ds_read2_b32 v[58:59], v7 offset0:66 offset1:67
    ds_read_b128 v[100:103], v13 offset:2816
    v_mfma_f32_16x16x32_bf16 v[44:47], v[60:63], v[96:99], v[44:47]
    v_mfma_f32_16x16x32_bf16 v[40:43], v[60:63], v[92:95], v[40:43]
    v_mfma_f32_16x16x32_bf16 v[36:39], v[60:63], v[88:91], v[36:39]
    v_mfma_f32_16x16x32_bf16 v[32:35], v[60:63], v[84:87], v[32:35]
    v_mfma_f32_16x16x32_bf16 v[28:31], v[60:63], v[80:83], v[28:31]
    ds_read2_b32 v[60:61], v8 offset0:64 offset1:65
    ds_read2_b32 v[62:63], v8 offset0:66 offset1:67
    ds_read_b128 v[96:99], v13 offset:2304
    v_mfma_f32_16x16x32_bf16 v[44:47], v[64:67], v[92:95], v[44:47]
    v_mfma_f32_16x16x32_bf16 v[40:43], v[64:67], v[88:91], v[40:43]
    v_mfma_f32_16x16x32_bf16 v[36:39], v[64:67], v[84:87], v[36:39]
    v_mfma_f32_16x16x32_bf16 v[32:35], v[64:67], v[80:83], v[32:35]
    ds_read2_b32 v[64:65], v9 offset0:64 offset1:65
    ds_read2_b32 v[66:67], v9 offset0:66 offset1:67
    ds_read_b128 v[92:95], v13 offset:1792
    v_mfma_f32_16x16x32_bf16 v[44:47], v[68:71], v[88:91], v[44:47]
    v_mfma_f32_16x16x32_bf16 v[40:43], v[68:71], v[84:87], v[40:43]
    v_mfma_f32_16x16x32_bf16 v[36:39], v[68:71], v[80:83], v[36:39]
    ds_read2_b32 v[68:69], v10 offset0:64 offset1:65
    ds_read2_b32 v[70:71], v10 offset0:66 offset1:67
    ds_read_b128 v[88:91], v13 offset:1280
    v_mfma_f32_16x16x32_bf16 v[44:47], v[72:75], v[84:87], v[44:47]
    v_mfma_f32_16x16x32_bf16 v[40:43], v[72:75], v[80:83], v[40:43]
    ds_read2_b32 v[72:73], v11 offset0:64 offset1:65
    ds_read2_b32 v[74:75], v11 offset0:66 offset1:67
    ds_read_b128 v[84:87], v13 offset:768
    v_mfma_f32_16x16x32_bf16 v[44:47], v[76:79], v[80:83], v[44:47]
    ds_read2_b32 v[76:77], v12 offset0:64 offset1:65
    ds_read2_b32 v[78:79], v12 offset0:66 offset1:67
    ds_read_b128 v[80:83], v13 offset:256
    s_waitcnt lgkmcnt(3)
    v_mfma_f32_16x16x32_bf16 v[44:47], v[48:51], v[108:111], v[44:47]
    v_mfma_f32_16x16x32_bf16 v[40:43], v[48:51], v[104:107], v[40:43]
    v_mfma_f32_16x16x32_bf16 v[36:39], v[48:51], v[100:103], v[36:39]
    v_mfma_f32_16x16x32_bf16 v[32:35], v[48:51], v[96:99], v[32:35]
    v_mfma_f32_16x16x32_bf16 v[28:31], v[48:51], v[92:95], v[28:31]
    v_mfma_f32_16x16x32_bf16 v[24:27], v[48:51], v[88:91], v[24:27]
    v_mfma_f32_16x16x32_bf16 v[20:23], v[48:51], v[84:87], v[20:23]
    s_waitcnt lgkmcnt(0)
    v_mfma_f32_16x16x32_bf16 v[16:19], v[48:51], v[80:83], v[16:19]
    ds_read2_b32 v[48:49], v5 offset0:48 offset1:49
    ds_read2_b32 v[50:51], v5 offset0:50 offset1:51
    ds_read_b128 v[108:111], v13 offset:3776
    v_mfma_f32_16x16x32_bf16 v[44:47], v[52:55], v[104:107], v[44:47]
    v_mfma_f32_16x16x32_bf16 v[40:43], v[52:55], v[100:103], v[40:43]
    v_mfma_f32_16x16x32_bf16 v[36:39], v[52:55], v[96:99], v[36:39]
    v_mfma_f32_16x16x32_bf16 v[32:35], v[52:55], v[92:95], v[32:35]
    v_mfma_f32_16x16x32_bf16 v[28:31], v[52:55], v[88:91], v[28:31]
    v_mfma_f32_16x16x32_bf16 v[24:27], v[52:55], v[84:87], v[24:27]
    v_mfma_f32_16x16x32_bf16 v[20:23], v[52:55], v[80:83], v[20:23]
    ds_read2_b32 v[52:53], v6 offset0:48 offset1:49
    ds_read2_b32 v[54:55], v6 offset0:50 offset1:51
    ds_read_b128 v[104:107], v13 offset:3264
    v_mfma_f32_16x16x32_bf16 v[44:47], v[56:59], v[100:103], v[44:47]
    v_mfma_f32_16x16x32_bf16 v[40:43], v[56:59], v[96:99], v[40:43]
    v_mfma_f32_16x16x32_bf16 v[36:39], v[56:59], v[92:95], v[36:39]
    v_mfma_f32_16x16x32_bf16 v[32:35], v[56:59], v[88:91], v[32:35]
    v_mfma_f32_16x16x32_bf16 v[28:31], v[56:59], v[84:87], v[28:31]
    v_mfma_f32_16x16x32_bf16 v[24:27], v[56:59], v[80:83], v[24:27]
    ds_read2_b32 v[56:57], v7 offset0:48 offset1:49
    ds_read2_b32 v[58:59], v7 offset0:50 offset1:51
    ds_read_b128 v[100:103], v13 offset:2752
    v_mfma_f32_16x16x32_bf16 v[44:47], v[60:63], v[96:99], v[44:47]
    v_mfma_f32_16x16x32_bf16 v[40:43], v[60:63], v[92:95], v[40:43]
    v_mfma_f32_16x16x32_bf16 v[36:39], v[60:63], v[88:91], v[36:39]
    v_mfma_f32_16x16x32_bf16 v[32:35], v[60:63], v[84:87], v[32:35]
    v_mfma_f32_16x16x32_bf16 v[28:31], v[60:63], v[80:83], v[28:31]
    ds_read2_b32 v[60:61], v8 offset0:48 offset1:49
    ds_read2_b32 v[62:63], v8 offset0:50 offset1:51
    ds_read_b128 v[96:99], v13 offset:2240
    v_mfma_f32_16x16x32_bf16 v[44:47], v[64:67], v[92:95], v[44:47]
    v_mfma_f32_16x16x32_bf16 v[40:43], v[64:67], v[88:91], v[40:43]
    v_mfma_f32_16x16x32_bf16 v[36:39], v[64:67], v[84:87], v[36:39]
    v_mfma_f32_16x16x32_bf16 v[32:35], v[64:67], v[80:83], v[32:35]
    ds_read2_b32 v[64:65], v9 offset0:48 offset1:49
    ds_read2_b32 v[66:67], v9 offset0:50 offset1:51
    ds_read_b128 v[92:95], v13 offset:1728
    v_mfma_f32_16x16x32_bf16 v[44:47], v[68:71], v[88:91], v[44:47]
    v_mfma_f32_16x16x32_bf16 v[40:43], v[68:71], v[84:87], v[40:43]
    v_mfma_f32_16x16x32_bf16 v[36:39], v[68:71], v[80:83], v[36:39]
    ds_read2_b32 v[68:69], v10 offset0:48 offset1:49
    ds_read2_b32 v[70:71], v10 offset0:50 offset1:51
    ds_read_b128 v[88:91], v13 offset:1216
    v_mfma_f32_16x16x32_bf16 v[44:47], v[72:75], v[84:87], v[44:47]
    v_mfma_f32_16x16x32_bf16 v[40:43], v[72:75], v[80:83], v[40:43]
    ds_read2_b32 v[72:73], v11 offset0:48 offset1:49
    ds_read2_b32 v[74:75], v11 offset0:50 offset1:51
    ds_read_b128 v[84:87], v13 offset:704
    v_mfma_f32_16x16x32_bf16 v[44:47], v[76:79], v[80:83], v[44:47]
    ds_read2_b32 v[76:77], v12 offset0:48 offset1:49
    ds_read2_b32 v[78:79], v12 offset0:50 offset1:51
    ds_read_b128 v[80:83], v13 offset:192
    s_waitcnt lgkmcnt(3)
    v_mfma_f32_16x16x32_bf16 v[44:47], v[48:51], v[108:111], v[44:47]
    v_mfma_f32_16x16x32_bf16 v[40:43], v[48:51], v[104:107], v[40:43]
    v_mfma_f32_16x16x32_bf16 v[36:39], v[48:51], v[100:103], v[36:39]
    v_mfma_f32_16x16x32_bf16 v[32:35], v[48:51], v[96:99], v[32:35]
    v_mfma_f32_16x16x32_bf16 v[28:31], v[48:51], v[92:95], v[28:31]
    v_mfma_f32_16x16x32_bf16 v[24:27], v[48:51], v[88:91], v[24:27]
    v_mfma_f32_16x16x32_bf16 v[20:23], v[48:51], v[84:87], v[20:23]
    s_waitcnt lgkmcnt(0)
    v_mfma_f32_16x16x32_bf16 v[16:19], v[48:51], v[80:83], v[16:19]
    ds_read2_b32 v[48:49], v5 offset0:32 offset1:33
    ds_read2_b32 v[50:51], v5 offset0:34 offset1:35
    ds_read_b128 v[108:111], v13 offset:3712
    v_mfma_f32_16x16x32_bf16 v[44:47], v[52:55], v[104:107], v[44:47]
    v_mfma_f32_16x16x32_bf16 v[40:43], v[52:55], v[100:103], v[40:43]
    v_mfma_f32_16x16x32_bf16 v[36:39], v[52:55], v[96:99], v[36:39]
    v_mfma_f32_16x16x32_bf16 v[32:35], v[52:55], v[92:95], v[32:35]
    v_mfma_f32_16x16x32_bf16 v[28:31], v[52:55], v[88:91], v[28:31]
    v_mfma_f32_16x16x32_bf16 v[24:27], v[52:55], v[84:87], v[24:27]
    v_mfma_f32_16x16x32_bf16 v[20:23], v[52:55], v[80:83], v[20:23]
    ds_read2_b32 v[52:53], v6 offset0:32 offset1:33
    ds_read2_b32 v[54:55], v6 offset0:34 offset1:35
    ds_read_b128 v[104:107], v13 offset:3200
    v_mfma_f32_16x16x32_bf16 v[44:47], v[56:59], v[100:103], v[44:47]
    v_mfma_f32_16x16x32_bf16 v[40:43], v[56:59], v[96:99], v[40:43]
    v_mfma_f32_16x16x32_bf16 v[36:39], v[56:59], v[92:95], v[36:39]
    v_mfma_f32_16x16x32_bf16 v[32:35], v[56:59], v[88:91], v[32:35]
    v_mfma_f32_16x16x32_bf16 v[28:31], v[56:59], v[84:87], v[28:31]
    v_mfma_f32_16x16x32_bf16 v[24:27], v[56:59], v[80:83], v[24:27]
    ds_read2_b32 v[56:57], v7 offset0:32 offset1:33
    ds_read2_b32 v[58:59], v7 offset0:34 offset1:35
    ds_read_b128 v[100:103], v13 offset:2688
    v_mfma_f32_16x16x32_bf16 v[44:47], v[60:63], v[96:99], v[44:47]
    v_mfma_f32_16x16x32_bf16 v[40:43], v[60:63], v[92:95], v[40:43]
    v_mfma_f32_16x16x32_bf16 v[36:39], v[60:63], v[88:91], v[36:39]
    v_mfma_f32_16x16x32_bf16 v[32:35], v[60:63], v[84:87], v[32:35]
    v_mfma_f32_16x16x32_bf16 v[28:31], v[60:63], v[80:83], v[28:31]
    ds_read2_b32 v[60:61], v8 offset0:32 offset1:33
    ds_read2_b32 v[62:63], v8 offset0:34 offset1:35
    ds_read_b128 v[96:99], v13 offset:2176
    v_mfma_f32_16x16x32_bf16 v[44:47], v[64:67], v[92:95], v[44:47]
    v_mfma_f32_16x16x32_bf16 v[40:43], v[64:67], v[88:91], v[40:43]
    v_mfma_f32_16x16x32_bf16 v[36:39], v[64:67], v[84:87], v[36:39]
    v_mfma_f32_16x16x32_bf16 v[32:35], v[64:67], v[80:83], v[32:35]
    ds_read2_b32 v[64:65], v9 offset0:32 offset1:33
    ds_read2_b32 v[66:67], v9 offset0:34 offset1:35
    ds_read_b128 v[92:95], v13 offset:1664
    v_mfma_f32_16x16x32_bf16 v[44:47], v[68:71], v[88:91], v[44:47]
    v_mfma_f32_16x16x32_bf16 v[40:43], v[68:71], v[84:87], v[40:43]
    v_mfma_f32_16x16x32_bf16 v[36:39], v[68:71], v[80:83], v[36:39]
    ds_read2_b32 v[68:69], v10 offset0:32 offset1:33
    ds_read2_b32 v[70:71], v10 offset0:34 offset1:35
    ds_read_b128 v[88:91], v13 offset:1152
    v_mfma_f32_16x16x32_bf16 v[44:47], v[72:75], v[84:87], v[44:47]
    v_mfma_f32_16x16x32_bf16 v[40:43], v[72:75], v[80:83], v[40:43]
    ds_read2_b32 v[72:73], v11 offset0:32 offset1:33
    ds_read2_b32 v[74:75], v11 offset0:34 offset1:35
    ds_read_b128 v[84:87], v13 offset:640
    v_mfma_f32_16x16x32_bf16 v[44:47], v[76:79], v[80:83], v[44:47]
    ds_read2_b32 v[76:77], v12 offset0:32 offset1:33
    ds_read2_b32 v[78:79], v12 offset0:34 offset1:35
    ds_read_b128 v[80:83], v13 offset:128
    s_waitcnt lgkmcnt(3)
    v_mfma_f32_16x16x32_bf16 v[44:47], v[48:51], v[108:111], v[44:47]
    v_mfma_f32_16x16x32_bf16 v[40:43], v[48:51], v[104:107], v[40:43]
    v_mfma_f32_16x16x32_bf16 v[36:39], v[48:51], v[100:103], v[36:39]
    v_mfma_f32_16x16x32_bf16 v[32:35], v[48:51], v[96:99], v[32:35]
    v_mfma_f32_16x16x32_bf16 v[28:31], v[48:51], v[92:95], v[28:31]
    v_mfma_f32_16x16x32_bf16 v[24:27], v[48:51], v[88:91], v[24:27]
    v_mfma_f32_16x16x32_bf16 v[20:23], v[48:51], v[84:87], v[20:23]
    s_waitcnt lgkmcnt(0)
    v_mfma_f32_16x16x32_bf16 v[16:19], v[48:51], v[80:83], v[16:19]
    ds_read2_b32 v[48:49], v5 offset0:16 offset1:17
    ds_read2_b32 v[50:51], v5 offset0:18 offset1:19
    ds_read_b128 v[108:111], v13 offset:3648
    v_mfma_f32_16x16x32_bf16 v[44:47], v[52:55], v[104:107], v[44:47]
    v_mfma_f32_16x16x32_bf16 v[40:43], v[52:55], v[100:103], v[40:43]
    v_mfma_f32_16x16x32_bf16 v[36:39], v[52:55], v[96:99], v[36:39]
    v_mfma_f32_16x16x32_bf16 v[32:35], v[52:55], v[92:95], v[32:35]
    v_mfma_f32_16x16x32_bf16 v[28:31], v[52:55], v[88:91], v[28:31]
    v_mfma_f32_16x16x32_bf16 v[24:27], v[52:55], v[84:87], v[24:27]
    v_mfma_f32_16x16x32_bf16 v[20:23], v[52:55], v[80:83], v[20:23]
    ds_read2_b32 v[52:53], v6 offset0:16 offset1:17
    ds_read2_b32 v[54:55], v6 offset0:18 offset1:19
    ds_read_b128 v[104:107], v13 offset:3136
    v_mfma_f32_16x16x32_bf16 v[44:47], v[56:59], v[100:103], v[44:47]
    v_mfma_f32_16x16x32_bf16 v[40:43], v[56:59], v[96:99], v[40:43]
    v_mfma_f32_16x16x32_bf16 v[36:39], v[56:59], v[92:95], v[36:39]
    v_mfma_f32_16x16x32_bf16 v[32:35], v[56:59], v[88:91], v[32:35]
    v_mfma_f32_16x16x32_bf16 v[28:31], v[56:59], v[84:87], v[28:31]
    v_mfma_f32_16x16x32_bf16 v[24:27], v[56:59], v[80:83], v[24:27]
    ds_read2_b32 v[56:57], v7 offset0:16 offset1:17
    ds_read2_b32 v[58:59], v7 offset0:18 offset1:19
    ds_read_b128 v[100:103], v13 offset:2624
    v_mfma_f32_16x16x32_bf16 v[44:47], v[60:63], v[96:99], v[44:47]
    v_mfma_f32_16x16x32_bf16 v[40:43], v[60:63], v[92:95], v[40:43]
    v_mfma_f32_16x16x32_bf16 v[36:39], v[60:63], v[88:91], v[36:39]
    v_mfma_f32_16x16x32_bf16 v[32:35], v[60:63], v[84:87], v[32:35]
    v_mfma_f32_16x16x32_bf16 v[28:31], v[60:63], v[80:83], v[28:31]
    ds_read2_b32 v[60:61], v8 offset0:16 offset1:17
    ds_read2_b32 v[62:63], v8 offset0:18 offset1:19
    ds_read_b128 v[96:99], v13 offset:2112
    v_mfma_f32_16x16x32_bf16 v[44:47], v[64:67], v[92:95], v[44:47]
    v_mfma_f32_16x16x32_bf16 v[40:43], v[64:67], v[88:91], v[40:43]
    v_mfma_f32_16x16x32_bf16 v[36:39], v[64:67], v[84:87], v[36:39]
    v_mfma_f32_16x16x32_bf16 v[32:35], v[64:67], v[80:83], v[32:35]
    ds_read2_b32 v[64:65], v9 offset0:16 offset1:17
    ds_read2_b32 v[66:67], v9 offset0:18 offset1:19
    ds_read_b128 v[92:95], v13 offset:1600
    v_mfma_f32_16x16x32_bf16 v[44:47], v[68:71], v[88:91], v[44:47]
    v_mfma_f32_16x16x32_bf16 v[40:43], v[68:71], v[84:87], v[40:43]
    v_mfma_f32_16x16x32_bf16 v[36:39], v[68:71], v[80:83], v[36:39]
    ds_read2_b32 v[68:69], v10 offset0:16 offset1:17
    ds_read2_b32 v[70:71], v10 offset0:18 offset1:19
    ds_read_b128 v[88:91], v13 offset:1088
    v_mfma_f32_16x16x32_bf16 v[44:47], v[72:75], v[84:87], v[44:47]
    v_mfma_f32_16x16x32_bf16 v[40:43], v[72:75], v[80:83], v[40:43]
    ds_read2_b32 v[72:73], v11 offset0:16 offset1:17
    ds_read2_b32 v[74:75], v11 offset0:18 offset1:19
    ds_read_b128 v[84:87], v13 offset:576
    v_mfma_f32_16x16x32_bf16 v[44:47], v[76:79], v[80:83], v[44:47]
    ds_read2_b32 v[76:77], v12 offset0:16 offset1:17
    ds_read2_b32 v[78:79], v12 offset0:18 offset1:19
    ds_read_b128 v[80:83], v13 offset:64
    s_waitcnt lgkmcnt(3)
    v_mfma_f32_16x16x32_bf16 v[44:47], v[48:51], v[108:111], v[44:47]
    v_mfma_f32_16x16x32_bf16 v[40:43], v[48:51], v[104:107], v[40:43]
    v_mfma_f32_16x16x32_bf16 v[36:39], v[48:51], v[100:103], v[36:39]
    v_mfma_f32_16x16x32_bf16 v[32:35], v[48:51], v[96:99], v[32:35]
    v_mfma_f32_16x16x32_bf16 v[28:31], v[48:51], v[92:95], v[28:31]
    v_mfma_f32_16x16x32_bf16 v[24:27], v[48:51], v[88:91], v[24:27]
    v_mfma_f32_16x16x32_bf16 v[20:23], v[48:51], v[84:87], v[20:23]
    s_waitcnt lgkmcnt(0)
    v_mfma_f32_16x16x32_bf16 v[16:19], v[48:51], v[80:83], v[16:19]
    ds_read2_b32 v[48:49], v5 offset0:0 offset1:1
    ds_read2_b32 v[50:51], v5 offset0:2 offset1:3
    ds_read_b128 v[108:111], v13 offset:3584
    v_mfma_f32_16x16x32_bf16 v[44:47], v[52:55], v[104:107], v[44:47]
    v_mfma_f32_16x16x32_bf16 v[40:43], v[52:55], v[100:103], v[40:43]
    v_mfma_f32_16x16x32_bf16 v[36:39], v[52:55], v[96:99], v[36:39]
    v_mfma_f32_16x16x32_bf16 v[32:35], v[52:55], v[92:95], v[32:35]
    v_mfma_f32_16x16x32_bf16 v[28:31], v[52:55], v[88:91], v[28:31]
    v_mfma_f32_16x16x32_bf16 v[24:27], v[52:55], v[84:87], v[24:27]
    v_mfma_f32_16x16x32_bf16 v[20:23], v[52:55], v[80:83], v[20:23]
    ds_read2_b32 v[52:53], v6 offset0:0 offset1:1
    ds_read2_b32 v[54:55], v6 offset0:2 offset1:3
    ds_read_b128 v[104:107], v13 offset:3072
    v_mfma_f32_16x16x32_bf16 v[44:47], v[56:59], v[100:103], v[44:47]
    v_mfma_f32_16x16x32_bf16 v[40:43], v[56:59], v[96:99], v[40:43]
    v_mfma_f32_16x16x32_bf16 v[36:39], v[56:59], v[92:95], v[36:39]
    v_mfma_f32_16x16x32_bf16 v[32:35], v[56:59], v[88:91], v[32:35]
    v_mfma_f32_16x16x32_bf16 v[28:31], v[56:59], v[84:87], v[28:31]
    v_mfma_f32_16x16x32_bf16 v[24:27], v[56:59], v[80:83], v[24:27]
    ds_read2_b32 v[56:57], v7 offset0:0 offset1:1
    ds_read2_b32 v[58:59], v7 offset0:2 offset1:3
    ds_read_b128 v[100:103], v13 offset:2560
    v_mfma_f32_16x16x32_bf16 v[44:47], v[60:63], v[96:99], v[44:47]
    v_mfma_f32_16x16x32_bf16 v[40:43], v[60:63], v[92:95], v[40:43]
    v_mfma_f32_16x16x32_bf16 v[36:39], v[60:63], v[88:91], v[36:39]
    v_mfma_f32_16x16x32_bf16 v[32:35], v[60:63], v[84:87], v[32:35]
    v_mfma_f32_16x16x32_bf16 v[28:31], v[60:63], v[80:83], v[28:31]
    ds_read2_b32 v[60:61], v8 offset0:0 offset1:1
    ds_read2_b32 v[62:63], v8 offset0:2 offset1:3
    ds_read_b128 v[96:99], v13 offset:2048
    v_mfma_f32_16x16x32_bf16 v[44:47], v[64:67], v[92:95], v[44:47]
    v_mfma_f32_16x16x32_bf16 v[40:43], v[64:67], v[88:91], v[40:43]
    v_mfma_f32_16x16x32_bf16 v[36:39], v[64:67], v[84:87], v[36:39]
    v_mfma_f32_16x16x32_bf16 v[32:35], v[64:67], v[80:83], v[32:35]
    ds_read2_b32 v[64:65], v9 offset0:0 offset1:1
    ds_read2_b32 v[66:67], v9 offset0:2 offset1:3
    ds_read_b128 v[92:95], v13 offset:1536
    v_mfma_f32_16x16x32_bf16 v[44:47], v[68:71], v[88:91], v[44:47]
    v_mfma_f32_16x16x32_bf16 v[40:43], v[68:71], v[84:87], v[40:43]
    v_mfma_f32_16x16x32_bf16 v[36:39], v[68:71], v[80:83], v[36:39]
    ds_read2_b32 v[68:69], v10 offset0:0 offset1:1
    ds_read2_b32 v[70:71], v10 offset0:2 offset1:3
    ds_read_b128 v[88:91], v13 offset:1024
    v_mfma_f32_16x16x32_bf16 v[44:47], v[72:75], v[84:87], v[44:47]
    v_mfma_f32_16x16x32_bf16 v[40:43], v[72:75], v[80:83], v[40:43]
    ds_read2_b32 v[72:73], v11 offset0:0 offset1:1
    ds_read2_b32 v[74:75], v11 offset0:2 offset1:3
    ds_read_b128 v[84:87], v13 offset:512
    v_mfma_f32_16x16x32_bf16 v[44:47], v[76:79], v[80:83], v[44:47]
    ds_read2_b32 v[76:77], v12 offset0:0 offset1:1
    ds_read2_b32 v[78:79], v12 offset0:2 offset1:3
    ds_read_b128 v[80:83], v13 offset:0
    s_waitcnt lgkmcnt(3)
    v_mfma_f32_16x16x32_bf16 v[44:47], v[48:51], v[108:111], v[44:47]
    v_mfma_f32_16x16x32_bf16 v[40:43], v[48:51], v[104:107], v[40:43]
    v_mfma_f32_16x16x32_bf16 v[36:39], v[48:51], v[100:103], v[36:39]
    v_mfma_f32_16x16x32_bf16 v[32:35], v[48:51], v[96:99], v[32:35]
    v_mfma_f32_16x16x32_bf16 v[28:31], v[48:51], v[92:95], v[28:31]
    v_mfma_f32_16x16x32_bf16 v[24:27], v[48:51], v[88:91], v[24:27]
    v_mfma_f32_16x16x32_bf16 v[20:23], v[48:51], v[84:87], v[20:23]
    s_waitcnt lgkmcnt(0)
    v_mfma_f32_16x16x32_bf16 v[16:19], v[48:51], v[80:83], v[16:19]
    v_mfma_f32_16x16x32_bf16 v[44:47], v[52:55], v[104:107], v[44:47]
    v_mfma_f32_16x16x32_bf16 v[40:43], v[52:55], v[100:103], v[40:43]
    v_mfma_f32_16x16x32_bf16 v[36:39], v[52:55], v[96:99], v[36:39]
    v_mfma_f32_16x16x32_bf16 v[32:35], v[52:55], v[92:95], v[32:35]
    v_mfma_f32_16x16x32_bf16 v[28:31], v[52:55], v[88:91], v[28:31]
    v_mfma_f32_16x16x32_bf16 v[24:27], v[52:55], v[84:87], v[24:27]
    v_mfma_f32_16x16x32_bf16 v[20:23], v[52:55], v[80:83], v[20:23]
    v_mfma_f32_16x16x32_bf16 v[44:47], v[56:59], v[100:103], v[44:47]
    v_mfma_f32_16x16x32_bf16 v[40:43], v[56:59], v[96:99], v[40:43]
    v_mfma_f32_16x16x32_bf16 v[36:39], v[56:59], v[92:95], v[36:39]
    v_mfma_f32_16x16x32_bf16 v[32:35], v[56:59], v[88:91], v[32:35]
    v_mfma_f32_16x16x32_bf16 v[28:31], v[56:59], v[84:87], v[28:31]
    v_mfma_f32_16x16x32_bf16 v[24:27], v[56:59], v[80:83], v[24:27]
    v_mfma_f32_16x16x32_bf16 v[44:47], v[60:63], v[96:99], v[44:47]
    v_mfma_f32_16x16x32_bf16 v[40:43], v[60:63], v[92:95], v[40:43]
    v_mfma_f32_16x16x32_bf16 v[36:39], v[60:63], v[88:91], v[36:39]
    v_mfma_f32_16x16x32_bf16 v[32:35], v[60:63], v[84:87], v[32:35]
    v_mfma_f32_16x16x32_bf16 v[28:31], v[60:63], v[80:83], v[28:31]
    v_mfma_f32_16x16x32_bf16 v[44:47], v[64:67], v[92:95], v[44:47]
    v_mfma_f32_16x16x32_bf16 v[40:43], v[64:67], v[88:91], v[40:43]
    v_mfma_f32_16x16x32_bf16 v[36:39], v[64:67], v[84:87], v[36:39]
    v_mfma_f32_16x16x32_bf16 v[32:35], v[64:67], v[80:83], v[32:35]
    v_mfma_f32_16x16x32_bf16 v[44:47], v[68:71], v[88:91], v[44:47]
    v_mfma_f32_16x16x32_bf16 v[40:43], v[68:71], v[84:87], v[40:43]
    v_mfma_f32_16x16x32_bf16 v[36:39], v[68:71], v[80:83], v[36:39]
    v_mfma_f32_16x16x32_bf16 v[44:47], v[72:75], v[84:87], v[44:47]
    v_mfma_f32_16x16x32_bf16 v[40:43], v[72:75], v[80:83], v[40:43]
    v_mfma_f32_16x16x32_bf16 v[44:47], v[76:79], v[80:83], v[44:47]
    v_and_b32 v3, 15, v1
    v_lshrrev_b32 v4, 4, v1
    v_lshlrev_b32 v3, 5, v3
    v_lshl_add_u32 v3, v4, 3, v3
    s_add_u32 s19, s21, 8832
    v_add_u32 v4, s19, v3
    s_lshl_b32 s18, s17, 12
    s_add_u32 s18, s18, 19922944
    ds_read_b64 v[80:81], v4 offset:0
    ds_read_b64 v[82:83], v4 offset:512
    ds_read_b64 v[84:85], v4 offset:1024
    ds_read_b64 v[86:87], v4 offset:1536
    ds_read_b64 v[88:89], v4 offset:2048
    ds_read_b64 v[90:91], v4 offset:2560
    ds_read_b64 v[92:93], v4 offset:3072
    ds_read_b64 v[94:95], v4 offset:3584
    v_lshlrev_b32 v48, 16, v15
    v_mov_b32 v49, v48
    s_waitcnt lgkmcnt(0)
    v_lshlrev_b32 v52, 16, v80
    v_and_b32 v53, 0xffff0000, v80
    v_lshlrev_b32 v54, 16, v81
    v_and_b32 v55, 0xffff0000, v81
    v_pk_fma_f32 v[16:17], v[52:53], v[48:49], v[16:17]
    v_pk_fma_f32 v[18:19], v[54:55], v[48:49], v[18:19]
    v_cvt_pk_bf16_f32 v16, v16, v17
    v_cvt_pk_bf16_f32 v17, v18, v19
    buffer_store_dwordx2 v[16:17], v3, s[4:7], s18 offen offset:0 sc1
    v_lshlrev_b32 v56, 16, v82
    v_and_b32 v57, 0xffff0000, v82
    v_lshlrev_b32 v58, 16, v83
    v_and_b32 v59, 0xffff0000, v83
    v_pk_fma_f32 v[20:21], v[56:57], v[48:49], v[20:21]
    v_pk_fma_f32 v[22:23], v[58:59], v[48:49], v[22:23]
    v_cvt_pk_bf16_f32 v20, v20, v21
    v_cvt_pk_bf16_f32 v21, v22, v23
    buffer_store_dwordx2 v[20:21], v3, s[4:7], s18 offen offset:512 sc1
    v_lshlrev_b32 v52, 16, v84
    v_and_b32 v53, 0xffff0000, v84
    v_lshlrev_b32 v54, 16, v85
    v_and_b32 v55, 0xffff0000, v85
    v_pk_fma_f32 v[24:25], v[52:53], v[48:49], v[24:25]
    v_pk_fma_f32 v[26:27], v[54:55], v[48:49], v[26:27]
    v_cvt_pk_bf16_f32 v24, v24, v25
    v_cvt_pk_bf16_f32 v25, v26, v27
    buffer_store_dwordx2 v[24:25], v3, s[4:7], s18 offen offset:1024 sc1
    v_lshlrev_b32 v56, 16, v86
    v_and_b32 v57, 0xffff0000, v86
    v_lshlrev_b32 v58, 16, v87
    v_and_b32 v59, 0xffff0000, v87
    v_pk_fma_f32 v[28:29], v[56:57], v[48:49], v[28:29]
    v_pk_fma_f32 v[30:31], v[58:59], v[48:49], v[30:31]
    v_cvt_pk_bf16_f32 v28, v28, v29
    v_cvt_pk_bf16_f32 v29, v30, v31
    buffer_store_dwordx2 v[28:29], v3, s[4:7], s18 offen offset:1536 sc1
    v_lshlrev_b32 v52, 16, v88
    v_and_b32 v53, 0xffff0000, v88
    v_lshlrev_b32 v54, 16, v89
    v_and_b32 v55, 0xffff0000, v89
    v_pk_fma_f32 v[32:33], v[52:53], v[48:49], v[32:33]
    v_pk_fma_f32 v[34:35], v[54:55], v[48:49], v[34:35]
    v_cvt_pk_bf16_f32 v32, v32, v33
    v_cvt_pk_bf16_f32 v33, v34, v35
    buffer_store_dwordx2 v[32:33], v3, s[4:7], s18 offen offset:2048 sc1
    v_lshlrev_b32 v56, 16, v90
    v_and_b32 v57, 0xffff0000, v90
    v_lshlrev_b32 v58, 16, v91
    v_and_b32 v59, 0xffff0000, v91
    v_pk_fma_f32 v[36:37], v[56:57], v[48:49], v[36:37]
    v_pk_fma_f32 v[38:39], v[58:59], v[48:49], v[38:39]
    v_cvt_pk_bf16_f32 v36, v36, v37
    v_cvt_pk_bf16_f32 v37, v38, v39
    buffer_store_dwordx2 v[36:37], v3, s[4:7], s18 offen offset:2560 sc1
    v_lshlrev_b32 v52, 16, v92
    v_and_b32 v53, 0xffff0000, v92
    v_lshlrev_b32 v54, 16, v93
    v_and_b32 v55, 0xffff0000, v93
    v_pk_fma_f32 v[40:41], v[52:53], v[48:49], v[40:41]
    v_pk_fma_f32 v[42:43], v[54:55], v[48:49], v[42:43]
    v_cvt_pk_bf16_f32 v40, v40, v41
    v_cvt_pk_bf16_f32 v41, v42, v43
    buffer_store_dwordx2 v[40:41], v3, s[4:7], s18 offen offset:3072 sc1
    v_lshlrev_b32 v56, 16, v94
    v_and_b32 v57, 0xffff0000, v94
    v_lshlrev_b32 v58, 16, v95
    v_and_b32 v59, 0xffff0000, v95
    v_pk_fma_f32 v[44:45], v[56:57], v[48:49], v[44:45]
    v_pk_fma_f32 v[46:47], v[58:59], v[48:49], v[46:47]
    v_cvt_pk_bf16_f32 v44, v44, v45
    v_cvt_pk_bf16_f32 v45, v46, v47
    buffer_store_dwordx2 v[44:45], v3, s[4:7], s18 offen offset:3584 sc1
    s_endpgm
k2_done:
k2_exit:
    s_endpgm
.section .rodata,"a"
.p2align 6
.amdhsa_kernel k2_kernel
  .amdhsa_next_free_vgpr 128
  .amdhsa_next_free_sgpr 102
  .amdhsa_accum_offset 128
  .amdhsa_group_segment_fixed_size 0
  .amdhsa_kernarg_size 104
  .amdhsa_user_sgpr_count 2
  .amdhsa_user_sgpr_kernarg_segment_ptr 1
  .amdhsa_system_sgpr_workgroup_id_x 1
.end_amdhsa_kernel
.text
.globl k3_kernel
.p2align 8
.type k3_kernel,@function
k3_kernel:
    s_cmp_ge_u32 s2, 256
    s_cbranch_scc1 k3_exit
    s_cmp_ge_u32 s2, 192
    s_cbranch_scc1 k3_role1
k3_role0:
    s_load_dwordx2 s[4:5], s[0:1], 96
    s_load_dwordx2 s[8:9], s[0:1], 80
    v_lshrrev_b32 v10, 6, v0
    v_and_b32 v1, 63, v0
    v_readfirstlane_b32 s16, v10
    v_lshlrev_b32 v4, 4, v1
    s_and_b32 s21, s2, 7
    s_lshr_b32 s22, s2, 3
    s_lshl_b32 s19, s21, 2
    s_and_b32 s23, s22, 3
    s_add_u32 s19, s19, s23
    s_lshr_b32 s20, s22, 2
    s_cmp_lt_u32 s16, 4
    s_cbranch_scc1 op_cmp_20001
    s_sub_u32 s33, s16, 4
    s_add_u32 s30, s20, s23
    s_cmp_ge_u32 s30, 6
    s_cselect_b32 s31, 6, 0
    s_sub_u32 s30, s30, s31
    s_lshl_b32 s24, s19, 11
    s_add_u32 s24, s24, 8388608
    s_mul_i32 s25, s20, 110592
    s_add_u32 s25, s25, 23068672
    s_lshr_b32 s31, s33, 1
    s_lshl_b32 s31, s31, 16
    s_and_b32 s32, s33, 1
    s_lshl_b32 s32, s32, 10
    s_add_u32 s24, s24, s31
    s_add_u32 s24, s24, s32
    s_lshl_b32 s28, s33, 10
    s_add_u32 s26, s25, s28
    s_add_u32 s27, s25, s32
    s_add_u32 s27, s27, 4096
    s_add_u32 s29, s32, 8192
    s_lshr_b32 s31, s33, 1
    s_mul_i32 s21, s31, 12288
    s_add_u32 s27, s27, s21
    s_mul_i32 s21, s31, 20480
    s_add_u32 s29, s29, s21
    s_mul_i32 s21, s30, 3
    s_lshl_b32 s31, s21, 17
    s_add_u32 s24, s24, s31
    s_mul_i32 s31, s21, 6144
    s_add_u32 s26, s26, s31
    s_add_u32 s27, s27, s31
    s_lshr_b32 s22, s33, 1
    s_cmp_eq_u32 s22, 0
    s_cselect_b32 s22, 6144, 0
    s_cselect_b32 s23, 10240, 0
    s_waitcnt lgkmcnt(0)
    s_mov_b32 s6, 24117248
    s_mov_b32 s7, 0x20000
    s_add_u32 m0, s28, 0
    s_add_u32 s31, s24, 0
    buffer_load_dwordx4 v4, s[4:7], s31 offen lds
    s_add_u32 m0, s28, 4096
    s_add_u32 s31, s26, 0
    buffer_load_dwordx4 v4, s[4:7], s31 offen lds
    s_add_u32 m0, s28, 10240
    s_add_u32 s31, s24, 131072
    buffer_load_dwordx4 v4, s[4:7], s31 offen lds
    s_add_u32 m0, s28, 14336
    s_add_u32 s31, s26, 6144
    buffer_load_dwordx4 v4, s[4:7], s31 offen lds
    s_add_u32 m0, s28, 20480
    s_add_u32 s31, s24, 262144
    buffer_load_dwordx4 v4, s[4:7], s31 offen lds
    s_add_u32 m0, s28, 24576
    s_add_u32 s31, s26, 12288
    buffer_load_dwordx4 v4, s[4:7], s31 offen lds
    s_add_u32 m0, s29, 0
    s_add_u32 s31, s27, s22
    buffer_load_dwordx4 v4, s[4:7], s27 offen lds
    s_add_u32 m0, m0, s23
    s_add_u32 s30, s30, 1
    buffer_load_dwordx4 v4, s[4:7], s31 offen lds
    s_cmp_eq_u32 s30, 6
    s_cselect_b32 s30, 0, s30
    s_cselect_b32 s31, 2359296, 0
    s_cselect_b32 s32, 110592, 0
    s_add_u32 s24, s24, 393216
    s_add_u32 s26, s26, 18432
    s_add_u32 s27, s27, 18432
    s_sub_u32 s24, s24, s31
    s_sub_u32 s26, s26, s32
    s_sub_u32 s27, s27, s32
    s_add_u32 m0, s28, 30720
    s_add_u32 s31, s24, 0
    buffer_load_dwordx4 v4, s[4:7], s31 offen lds
    s_add_u32 m0, s28, 34816
    s_add_u32 s31, s26, 0
    buffer_load_dwordx4 v4, s[4:7], s31 offen lds
    s_add_u32 m0, s28, 40960
    s_add_u32 s31, s24, 131072
    buffer_load_dwordx4 v4, s[4:7], s31 offen lds
    s_add_u32 m0, s28, 45056
    s_add_u32 s31, s26, 6144
    buffer_load_dwordx4 v4, s[4:7], s31 offen lds
    s_add_u32 m0, s28, 51200
    s_add_u32 s31, s24, 262144
    buffer_load_dwordx4 v4, s[4:7], s31 offen lds
    s_add_u32 m0, s28, 55296
    s_add_u32 s31, s26, 12288
    buffer_load_dwordx4 v4, s[4:7], s31 offen lds
    s_add_u32 m0, s29, 30720
    s_add_u32 s31, s27, s22
    buffer_load_dwordx4 v4, s[4:7], s27 offen lds
    s_add_u32 m0, m0, s23
    s_add_u32 s30, s30, 1
    buffer_load_dwordx4 v4, s[4:7], s31 offen lds
    s_cmp_eq_u32 s30, 6
    s_cselect_b32 s30, 0, s30
    s_cselect_b32 s31, 2359296, 0
    s_cselect_b32 s32, 110592, 0
    s_add_u32 s24, s24, 393216
    s_add_u32 s26, s26, 18432
    s_add_u32 s27, s27, 18432
    s_sub_u32 s24, s24, s31
    s_sub_u32 s26, s26, s32
    s_sub_u32 s27, s27, s32
    s_waitcnt vmcnt(8)
    s_barrier
    s_add_u32 m0, s28, 61440
    s_add_u32 s31, s24, 0
    buffer_load_dwordx4 v4, s[4:7], s31 offen lds
    s_add_u32 m0, s28, 65536
    s_add_u32 s31, s26, 0
    buffer_load_dwordx4 v4, s[4:7], s31 offen lds
    s_add_u32 m0, s28, 71680
    s_add_u32 s31, s24, 131072
    buffer_load_dwordx4 v4, s[4:7], s31 offen lds
    s_add_u32 m0, s28, 75776
    s_add_u32 s31, s26, 6144
    buffer_load_dwordx4 v4, s[4:7], s31 offen lds
    s_add_u32 m0, s28, 81920
    s_add_u32 s31, s24, 262144
    buffer_load_dwordx4 v4, s[4:7], s31 offen lds
    s_add_u32 m0, s28, 86016
    s_add_u32 s31, s26, 12288
    buffer_load_dwordx4 v4, s[4:7], s31 offen lds
    s_add_u32 m0, s29, 61440
    s_add_u32 s31, s27, s22
    buffer_load_dwordx4 v4, s[4:7], s27 offen lds
    s_add_u32 m0, m0, s23
    s_add_u32 s30, s30, 1
    buffer_load_dwordx4 v4, s[4:7], s31 offen lds
    s_cmp_eq_u32 s30, 6
    s_cselect_b32 s30, 0, s30
    s_cselect_b32 s31, 2359296, 0
    s_cselect_b32 s32, 110592, 0
    s_add_u32 s24, s24, 393216
    s_add_u32 s26, s26, 18432
    s_add_u32 s27, s27, 18432
    s_sub_u32 s24, s24, s31
    s_sub_u32 s26, s26, s32
    s_sub_u32 s27, s27, s32
    s_waitcnt vmcnt(8)
    s_barrier
    s_add_u32 m0, s28, 92160
    s_add_u32 s31, s24, 0
    buffer_load_dwordx4 v4, s[4:7], s31 offen lds
    s_add_u32 m0, s28, 96256
    s_add_u32 s31, s26, 0
    buffer_load_dwordx4 v4, s[4:7], s31 offen lds
    s_add_u32 m0, s28, 102400
    s_add_u32 s31, s24, 131072
    buffer_load_dwordx4 v4, s[4:7], s31 offen lds
    s_add_u32 m0, s28, 106496
    s_add_u32 s31, s26, 6144
    buffer_load_dwordx4 v4, s[4:7], s31 offen lds
    s_add_u32 m0, s28, 112640
    s_add_u32 s31, s24, 262144
    buffer_load_dwordx4 v4, s[4:7], s31 offen lds
    s_add_u32 m0, s28, 116736
    s_add_u32 s31, s26, 12288
    buffer_load_dwordx4 v4, s[4:7], s31 offen lds
    s_add_u32 m0, s29, 92160
    s_add_u32 s31, s27, s22
    buffer_load_dwordx4 v4, s[4:7], s27 offen lds
    s_add_u32 m0, m0, s23
    s_add_u32 s30, s30, 1
    buffer_load_dwordx4 v4, s[4:7], s31 offen lds
    s_cmp_eq_u32 s30, 6
    s_cselect_b32 s30, 0, s30
    s_cselect_b32 s31, 2359296, 0
    s_cselect_b32 s32, 110592, 0
    s_add_u32 s24, s24, 393216
    s_add_u32 s26, s26, 18432
    s_add_u32 s27, s27, 18432
    s_sub_u32 s24, s24, s31
    s_sub_u32 s26, s26, s32
    s_sub_u32 s27, s27, s32
    s_waitcnt vmcnt(8)
    s_barrier
    s_add_u32 m0, s28, 0
    s_add_u32 s31, s24, 0
    buffer_load_dwordx4 v4, s[4:7], s31 offen lds
    s_add_u32 m0, s28, 4096
    s_add_u32 s31, s26, 0
    buffer_load_dwordx4 v4, s[4:7], s31 offen lds
    s_add_u32 m0, s28, 10240
    s_add_u32 s31, s24, 131072
    buffer_load_dwordx4 v4, s[4:7], s31 offen lds
    s_add_u32 m0, s28, 14336
    s_add_u32 s31, s26, 6144
    buffer_load_dwordx4 v4, s[4:7], s31 offen lds
    s_add_u32 m0, s28, 20480
    s_add_u32 s31, s24, 262144
    buffer_load_dwordx4 v4, s[4:7], s31 offen lds
    s_add_u32 m0, s28, 24576
    s_add_u32 s31, s26, 12288
    buffer_load_dwordx4 v4, s[4:7], s31 offen lds
    s_add_u32 m0, s29, 0
    s_add_u32 s31, s27, s22
    buffer_load_dwordx4 v4, s[4:7], s27 offen lds
    s_add_u32 m0, m0, s23
    s_add_u32 s30, s30, 1
    buffer_load_dwordx4 v4, s[4:7], s31 offen lds
    s_cmp_eq_u32 s30, 6
    s_cselect_b32 s30, 0, s30
    s_cselect_b32 s31, 2359296, 0
    s_cselect_b32 s32, 110592, 0
    s_add_u32 s24, s24, 393216
    s_add_u32 s26, s26, 18432
    s_add_u32 s27, s27, 18432
    s_sub_u32 s24, s24, s31
    s_sub_u32 s26, s26, s32
    s_sub_u32 s27, s27, s32
    s_waitcnt vmcnt(8)
    s_barrier
    s_add_u32 m0, s28, 30720
    s_add_u32 s31, s24, 0
    buffer_load_dwordx4 v4, s[4:7], s31 offen lds
    s_add_u32 m0, s28, 34816
    s_add_u32 s31, s26, 0
    buffer_load_dwordx4 v4, s[4:7], s31 offen lds
    s_add_u32 m0, s28, 40960
    s_add_u32 s31, s24, 131072
    buffer_load_dwordx4 v4, s[4:7], s31 offen lds
    s_add_u32 m0, s28, 45056
    s_add_u32 s31, s26, 6144
    buffer_load_dwordx4 v4, s[4:7], s31 offen lds
    s_add_u32 m0, s28, 51200
    s_add_u32 s31, s24, 262144
    buffer_load_dwordx4 v4, s[4:7], s31 offen lds
    s_add_u32 m0, s28, 55296
    s_add_u32 s31, s26, 12288
    buffer_load_dwordx4 v4, s[4:7], s31 offen lds
    s_add_u32 m0, s29, 30720
    s_add_u32 s31, s27, s22
    buffer_load_dwordx4 v4, s[4:7], s27 offen lds
    s_add_u32 m0, m0, s23
    s_add_u32 s30, s30, 1
    buffer_load_dwordx4 v4, s[4:7], s31 offen lds
    s_cmp_eq_u32 s30, 6
    s_cselect_b32 s30, 0, s30
    s_cselect_b32 s31, 2359296, 0
    s_cselect_b32 s32, 110592, 0
    s_add_u32 s24, s24, 393216
    s_add_u32 s26, s26, 18432
    s_add_u32 s27, s27, 18432
    s_sub_u32 s24, s24, s31
    s_sub_u32 s26, s26, s32
    s_sub_u32 s27, s27, s32
    s_waitcnt vmcnt(8)
    s_barrier
    s_waitcnt vmcnt(0)
    s_barrier
    s_branch op_epi_20002
op_cmp_20001:
    v_lshrrev_b32 v2, 4, v1
    v_and_b32 v3, 15, v1
    s_and_b32 s17, s16, 1
    s_lshr_b32 s18, s16, 1
    v_lshrrev_b32 v10, 1, v2
    v_lshlrev_b32 v10, 11, v10
    s_lshl_b32 s21, s17, 5
    v_add_u32 v11, s21, v3
    v_lshl_add_u32 v10, v11, 5, v10
    v_and_b32 v12, 1, v2
    v_lshl_add_u32 v5, v12, 4, v10
    v_add_u32 v6, 61440, v5
    s_mul_i32 s21, s18, 3072
    s_add_u32 s21, s21, 4096
    v_add_u32 v7, s21, v4
    v_add_u32 v8, 61440, v7
    v_mul_u32_u24 v10, 208, v11
    v_lshl_add_u32 v10, v2, 3, v10
    s_mul_i32 s21, s18, 96
    v_add_u32 v9, s21, v10
    s_barrier
    ds_read_b128 v[40:43], v5 offset:0
    ds_read_b128 v[44:47], v5 offset:512
    ds_read_b128 v[48:51], v7 offset:0
    ds_read_b128 v[52:55], v7 offset:1024
    ds_read_b128 v[56:59], v7 offset:2048
    ds_read_b128 v[60:63], v5 offset:10240
    ds_read_b128 v[64:67], v5 offset:10752
    ds_read_b128 v[68:71], v7 offset:10240
    ds_read_b128 v[72:75], v7 offset:11264
    ds_read_b128 v[76:79], v7 offset:12288
    ds_read_b128 v[80:83], v5 offset:20480
    ds_read_b128 v[84:87], v5 offset:20992
    ds_read_b128 v[88:91], v7 offset:20480
    ds_read_b128 v[92:95], v7 offset:21504
    ds_read_b128 v[96:99], v7 offset:22528
    s_waitcnt lgkmcnt(10)
    v_mfma_f32_16x16x32_bf16 v[16:19], v[48:51], v[40:43], 0
    v_mfma_f32_16x16x32_bf16 v[20:23], v[48:51], v[44:47], 0
    v_mfma_f32_16x16x32_bf16 v[24:27], v[52:55], v[40:43], 0
    v_mfma_f32_16x16x32_bf16 v[28:31], v[52:55], v[44:47], 0
    v_mfma_f32_16x16x32_bf16 v[32:35], v[56:59], v[40:43], 0
    v_mfma_f32_16x16x32_bf16 v[36:39], v[56:59], v[44:47], 0
    s_waitcnt lgkmcnt(5)
    v_mfma_f32_16x16x32_bf16 v[16:19], v[68:71], v[60:63], v[16:19]
    v_mfma_f32_16x16x32_bf16 v[20:23], v[68:71], v[64:67], v[20:23]
    v_mfma_f32_16x16x32_bf16 v[24:27], v[72:75], v[60:63], v[24:27]
    v_mfma_f32_16x16x32_bf16 v[28:31], v[72:75], v[64:67], v[28:31]
    v_mfma_f32_16x16x32_bf16 v[32:35], v[76:79], v[60:63], v[32:35]
    v_mfma_f32_16x16x32_bf16 v[36:39], v[76:79], v[64:67], v[36:39]
    s_waitcnt lgkmcnt(0)
    v_mfma_f32_16x16x32_bf16 v[16:19], v[88:91], v[80:83], v[16:19]
    v_mfma_f32_16x16x32_bf16 v[20:23], v[88:91], v[84:87], v[20:23]
    v_mfma_f32_16x16x32_bf16 v[24:27], v[92:95], v[80:83], v[24:27]
    v_mfma_f32_16x16x32_bf16 v[28:31], v[92:95], v[84:87], v[28:31]
    v_mfma_f32_16x16x32_bf16 v[32:35], v[96:99], v[80:83], v[32:35]
    v_mfma_f32_16x16x32_bf16 v[36:39], v[96:99], v[84:87], v[36:39]
    s_barrier
    ds_read_b128 v[40:43], v5 offset:30720
    ds_read_b128 v[44:47], v5 offset:31232
    ds_read_b128 v[48:51], v7 offset:30720
    ds_read_b128 v[52:55], v7 offset:31744
    ds_read_b128 v[56:59], v7 offset:32768
    ds_read_b128 v[60:63], v5 offset:40960
    ds_read_b128 v[64:67], v5 offset:41472
    ds_read_b128 v[68:71], v7 offset:40960
    ds_read_b128 v[72:75], v7 offset:41984
    ds_read_b128 v[76:79], v7 offset:43008
    ds_read_b128 v[80:83], v5 offset:51200
    ds_read_b128 v[84:87], v5 offset:51712
    ds_read_b128 v[88:91], v7 offset:51200
    ds_read_b128 v[92:95], v7 offset:52224
    ds_read_b128 v[96:99], v7 offset:53248
    s_waitcnt lgkmcnt(10)
    v_mfma_f32_16x16x32_bf16 v[16:19], v[48:51], v[40:43], v[16:19]
    v_mfma_f32_16x16x32_bf16 v[20:23], v[48:51], v[44:47], v[20:23]
    v_mfma_f32_16x16x32_bf16 v[24:27], v[52:55], v[40:43], v[24:27]
    v_mfma_f32_16x16x32_bf16 v[28:31], v[52:55], v[44:47], v[28:31]
    v_mfma_f32_16x16x32_bf16 v[32:35], v[56:59], v[40:43], v[32:35]
    v_mfma_f32_16x16x32_bf16 v[36:39], v[56:59], v[44:47], v[36:39]
    s_waitcnt lgkmcnt(5)
    v_mfma_f32_16x16x32_bf16 v[16:19], v[68:71], v[60:63], v[16:19]
    v_mfma_f32_16x16x32_bf16 v[20:23], v[68:71], v[64:67], v[20:23]
    v_mfma_f32_16x16x32_bf16 v[24:27], v[72:75], v[60:63], v[24:27]
    v_mfma_f32_16x16x32_bf16 v[28:31], v[72:75], v[64:67], v[28:31]
    v_mfma_f32_16x16x32_bf16 v[32:35], v[76:79], v[60:63], v[32:35]
    v_mfma_f32_16x16x32_bf16 v[36:39], v[76:79], v[64:67], v[36:39]
    s_waitcnt lgkmcnt(0)
    v_mfma_f32_16x16x32_bf16 v[16:19], v[88:91], v[80:83], v[16:19]
    v_mfma_f32_16x16x32_bf16 v[20:23], v[88:91], v[84:87], v[20:23]
    v_mfma_f32_16x16x32_bf16 v[24:27], v[92:95], v[80:83], v[24:27]
    v_mfma_f32_16x16x32_bf16 v[28:31], v[92:95], v[84:87], v[28:31]
    v_mfma_f32_16x16x32_bf16 v[32:35], v[96:99], v[80:83], v[32:35]
    v_mfma_f32_16x16x32_bf16 v[36:39], v[96:99], v[84:87], v[36:39]
    s_barrier
    ds_read_b128 v[40:43], v6 offset:0
    ds_read_b128 v[44:47], v6 offset:512
    ds_read_b128 v[48:51], v8 offset:0
    ds_read_b128 v[52:55], v8 offset:1024
    ds_read_b128 v[56:59], v8 offset:2048
    ds_read_b128 v[60:63], v6 offset:10240
    ds_read_b128 v[64:67], v6 offset:10752
    ds_read_b128 v[68:71], v8 offset:10240
    ds_read_b128 v[72:75], v8 offset:11264
    ds_read_b128 v[76:79], v8 offset:12288
    ds_read_b128 v[80:83], v6 offset:20480
    ds_read_b128 v[84:87], v6 offset:20992
    ds_read_b128 v[88:91], v8 offset:20480
    ds_read_b128 v[92:95], v8 offset:21504
    ds_read_b128 v[96:99], v8 offset:22528
    s_waitcnt lgkmcnt(10)
    v_mfma_f32_16x16x32_bf16 v[16:19], v[48:51], v[40:43], v[16:19]
    v_mfma_f32_16x16x32_bf16 v[20:23], v[48:51], v[44:47], v[20:23]
    v_mfma_f32_16x16x32_bf16 v[24:27], v[52:55], v[40:43], v[24:27]
    v_mfma_f32_16x16x32_bf16 v[28:31], v[52:55], v[44:47], v[28:31]
    v_mfma_f32_16x16x32_bf16 v[32:35], v[56:59], v[40:43], v[32:35]
    v_mfma_f32_16x16x32_bf16 v[36:39], v[56:59], v[44:47], v[36:39]
    s_waitcnt lgkmcnt(5)
    v_mfma_f32_16x16x32_bf16 v[16:19], v[68:71], v[60:63], v[16:19]
    v_mfma_f32_16x16x32_bf16 v[20:23], v[68:71], v[64:67], v[20:23]
    v_mfma_f32_16x16x32_bf16 v[24:27], v[72:75], v[60:63], v[24:27]
    v_mfma_f32_16x16x32_bf16 v[28:31], v[72:75], v[64:67], v[28:31]
    v_mfma_f32_16x16x32_bf16 v[32:35], v[76:79], v[60:63], v[32:35]
    v_mfma_f32_16x16x32_bf16 v[36:39], v[76:79], v[64:67], v[36:39]
    s_waitcnt lgkmcnt(0)
    v_mfma_f32_16x16x32_bf16 v[16:19], v[88:91], v[80:83], v[16:19]
    v_mfma_f32_16x16x32_bf16 v[20:23], v[88:91], v[84:87], v[20:23]
    v_mfma_f32_16x16x32_bf16 v[24:27], v[92:95], v[80:83], v[24:27]
    v_mfma_f32_16x16x32_bf16 v[28:31], v[92:95], v[84:87], v[28:31]
    v_mfma_f32_16x16x32_bf16 v[32:35], v[96:99], v[80:83], v[32:35]
    v_mfma_f32_16x16x32_bf16 v[36:39], v[96:99], v[84:87], v[36:39]
    s_barrier
    ds_read_b128 v[40:43], v6 offset:30720
    ds_read_b128 v[44:47], v6 offset:31232
    ds_read_b128 v[48:51], v8 offset:30720
    ds_read_b128 v[52:55], v8 offset:31744
    ds_read_b128 v[56:59], v8 offset:32768
    ds_read_b128 v[60:63], v6 offset:40960
    ds_read_b128 v[64:67], v6 offset:41472
    ds_read_b128 v[68:71], v8 offset:40960
    ds_read_b128 v[72:75], v8 offset:41984
    ds_read_b128 v[76:79], v8 offset:43008
    ds_read_b128 v[80:83], v6 offset:51200
    ds_read_b128 v[84:87], v6 offset:51712
    ds_read_b128 v[88:91], v8 offset:51200
    ds_read_b128 v[92:95], v8 offset:52224
    ds_read_b128 v[96:99], v8 offset:53248
    s_waitcnt lgkmcnt(10)
    v_mfma_f32_16x16x32_bf16 v[16:19], v[48:51], v[40:43], v[16:19]
    v_mfma_f32_16x16x32_bf16 v[20:23], v[48:51], v[44:47], v[20:23]
    v_mfma_f32_16x16x32_bf16 v[24:27], v[52:55], v[40:43], v[24:27]
    v_mfma_f32_16x16x32_bf16 v[28:31], v[52:55], v[44:47], v[28:31]
    v_mfma_f32_16x16x32_bf16 v[32:35], v[56:59], v[40:43], v[32:35]
    v_mfma_f32_16x16x32_bf16 v[36:39], v[56:59], v[44:47], v[36:39]
    s_waitcnt lgkmcnt(5)
    v_mfma_f32_16x16x32_bf16 v[16:19], v[68:71], v[60:63], v[16:19]
    v_mfma_f32_16x16x32_bf16 v[20:23], v[68:71], v[64:67], v[20:23]
    v_mfma_f32_16x16x32_bf16 v[24:27], v[72:75], v[60:63], v[24:27]
    v_mfma_f32_16x16x32_bf16 v[28:31], v[72:75], v[64:67], v[28:31]
    v_mfma_f32_16x16x32_bf16 v[32:35], v[76:79], v[60:63], v[32:35]
    v_mfma_f32_16x16x32_bf16 v[36:39], v[76:79], v[64:67], v[36:39]
    s_waitcnt lgkmcnt(0)
    v_mfma_f32_16x16x32_bf16 v[16:19], v[88:91], v[80:83], v[16:19]
    v_mfma_f32_16x16x32_bf16 v[20:23], v[88:91], v[84:87], v[20:23]
    v_mfma_f32_16x16x32_bf16 v[24:27], v[92:95], v[80:83], v[24:27]
    v_mfma_f32_16x16x32_bf16 v[28:31], v[92:95], v[84:87], v[28:31]
    v_mfma_f32_16x16x32_bf16 v[32:35], v[96:99], v[80:83], v[32:35]
    v_mfma_f32_16x16x32_bf16 v[36:39], v[96:99], v[84:87], v[36:39]
    s_barrier
    ds_read_b128 v[40:43], v5 offset:0
    ds_read_b128 v[44:47], v5 offset:512
    ds_read_b128 v[48:51], v7 offset:0
    ds_read_b128 v[52:55], v7 offset:1024
    ds_read_b128 v[56:59], v7 offset:2048
    ds_read_b128 v[60:63], v5 offset:10240
    ds_read_b128 v[64:67], v5 offset:10752
    ds_read_b128 v[68:71], v7 offset:10240
    ds_read_b128 v[72:75], v7 offset:11264
    ds_read_b128 v[76:79], v7 offset:12288
    ds_read_b128 v[80:83], v5 offset:20480
    ds_read_b128 v[84:87], v5 offset:20992
    ds_read_b128 v[88:91], v7 offset:20480
    ds_read_b128 v[92:95], v7 offset:21504
    ds_read_b128 v[96:99], v7 offset:22528
    s_waitcnt lgkmcnt(10)
    v_mfma_f32_16x16x32_bf16 v[16:19], v[48:51], v[40:43], v[16:19]
    v_mfma_f32_16x16x32_bf16 v[20:23], v[48:51], v[44:47], v[20:23]
    v_mfma_f32_16x16x32_bf16 v[24:27], v[52:55], v[40:43], v[24:27]
    v_mfma_f32_16x16x32_bf16 v[28:31], v[52:55], v[44:47], v[28:31]
    v_mfma_f32_16x16x32_bf16 v[32:35], v[56:59], v[40:43], v[32:35]
    v_mfma_f32_16x16x32_bf16 v[36:39], v[56:59], v[44:47], v[36:39]
    s_waitcnt lgkmcnt(5)
    v_mfma_f32_16x16x32_bf16 v[16:19], v[68:71], v[60:63], v[16:19]
    v_mfma_f32_16x16x32_bf16 v[20:23], v[68:71], v[64:67], v[20:23]
    v_mfma_f32_16x16x32_bf16 v[24:27], v[72:75], v[60:63], v[24:27]
    v_mfma_f32_16x16x32_bf16 v[28:31], v[72:75], v[64:67], v[28:31]
    v_mfma_f32_16x16x32_bf16 v[32:35], v[76:79], v[60:63], v[32:35]
    v_mfma_f32_16x16x32_bf16 v[36:39], v[76:79], v[64:67], v[36:39]
    s_waitcnt lgkmcnt(0)
    v_mfma_f32_16x16x32_bf16 v[16:19], v[88:91], v[80:83], v[16:19]
    v_mfma_f32_16x16x32_bf16 v[20:23], v[88:91], v[84:87], v[20:23]
    v_mfma_f32_16x16x32_bf16 v[24:27], v[92:95], v[80:83], v[24:27]
    v_mfma_f32_16x16x32_bf16 v[28:31], v[92:95], v[84:87], v[28:31]
    v_mfma_f32_16x16x32_bf16 v[32:35], v[96:99], v[80:83], v[32:35]
    v_mfma_f32_16x16x32_bf16 v[36:39], v[96:99], v[84:87], v[36:39]
    s_barrier
    ds_read_b128 v[40:43], v5 offset:30720
    ds_read_b128 v[44:47], v5 offset:31232
    ds_read_b128 v[48:51], v7 offset:30720
    ds_read_b128 v[52:55], v7 offset:31744
    ds_read_b128 v[56:59], v7 offset:32768
    ds_read_b128 v[60:63], v5 offset:40960
    ds_read_b128 v[64:67], v5 offset:41472
    ds_read_b128 v[68:71], v7 offset:40960
    ds_read_b128 v[72:75], v7 offset:41984
    ds_read_b128 v[76:79], v7 offset:43008
    ds_read_b128 v[80:83], v5 offset:51200
    ds_read_b128 v[84:87], v5 offset:51712
    ds_read_b128 v[88:91], v7 offset:51200
    ds_read_b128 v[92:95], v7 offset:52224
    ds_read_b128 v[96:99], v7 offset:53248
    s_waitcnt lgkmcnt(10)
    v_mfma_f32_16x16x32_bf16 v[16:19], v[48:51], v[40:43], v[16:19]
    v_mfma_f32_16x16x32_bf16 v[20:23], v[48:51], v[44:47], v[20:23]
    v_mfma_f32_16x16x32_bf16 v[24:27], v[52:55], v[40:43], v[24:27]
    v_mfma_f32_16x16x32_bf16 v[28:31], v[52:55], v[44:47], v[28:31]
    v_mfma_f32_16x16x32_bf16 v[32:35], v[56:59], v[40:43], v[32:35]
    v_mfma_f32_16x16x32_bf16 v[36:39], v[56:59], v[44:47], v[36:39]
    s_waitcnt lgkmcnt(5)
    v_mfma_f32_16x16x32_bf16 v[16:19], v[68:71], v[60:63], v[16:19]
    v_mfma_f32_16x16x32_bf16 v[20:23], v[68:71], v[64:67], v[20:23]
    v_mfma_f32_16x16x32_bf16 v[24:27], v[72:75], v[60:63], v[24:27]
    v_mfma_f32_16x16x32_bf16 v[28:31], v[72:75], v[64:67], v[28:31]
    v_mfma_f32_16x16x32_bf16 v[32:35], v[76:79], v[60:63], v[32:35]
    v_mfma_f32_16x16x32_bf16 v[36:39], v[76:79], v[64:67], v[36:39]
    s_waitcnt lgkmcnt(0)
    v_mfma_f32_16x16x32_bf16 v[16:19], v[88:91], v[80:83], v[16:19]
    v_mfma_f32_16x16x32_bf16 v[20:23], v[88:91], v[84:87], v[20:23]
    v_mfma_f32_16x16x32_bf16 v[24:27], v[92:95], v[80:83], v[24:27]
    v_mfma_f32_16x16x32_bf16 v[28:31], v[92:95], v[84:87], v[28:31]
    v_mfma_f32_16x16x32_bf16 v[32:35], v[96:99], v[80:83], v[32:35]
    v_mfma_f32_16x16x32_bf16 v[36:39], v[96:99], v[84:87], v[36:39]
    s_nop 2
    v_cvt_pk_bf16_f32 v16, v16, v17
    v_cvt_pk_bf16_f32 v17, v18, v19
    ds_write_b64 v9, v[16:17] offset:61440
    v_cvt_pk_bf16_f32 v20, v20, v21
    v_cvt_pk_bf16_f32 v21, v22, v23
    ds_write_b64 v9, v[20:21] offset:64768
    v_cvt_pk_bf16_f32 v24, v24, v25
    v_cvt_pk_bf16_f32 v25, v26, v27
    ds_write_b64 v9, v[24:25] offset:61472
    v_cvt_pk_bf16_f32 v28, v28, v29
    v_cvt_pk_bf16_f32 v29, v30, v31
    ds_write_b64 v9, v[28:29] offset:64800
    v_cvt_pk_bf16_f32 v32, v32, v33
    v_cvt_pk_bf16_f32 v33, v34, v35
    ds_write_b64 v9, v[32:33] offset:61504
    v_cvt_pk_bf16_f32 v36, v36, v37
    v_cvt_pk_bf16_f32 v37, v38, v39
    ds_write_b64 v9, v[36:37] offset:64832
op_epi_20002:
    v_add_u32 v10, 0, v1
    v_mul_u32_u24 v11, 5462, v10
    v_lshrrev_b32 v11, 16, v11
    v_mul_u32_u24 v12, 12, v11
    v_sub_u32 v12, v10, v12
    s_lshl_b32 s21, s16, 3
    v_add_u32 v11, s21, v11
    v_mul_u32_u24 v13, 208, v11
    v_lshl_add_u32 v14, v12, 4, v13
    v_mul_u32_u24 v13, 2304, v11
    v_lshl_add_u32 v100, v12, 4, v13
    v_add_u32 v10, 64, v1
    v_mul_u32_u24 v11, 5462, v10
    v_lshrrev_b32 v11, 16, v11
    v_mul_u32_u24 v12, 12, v11
    v_sub_u32 v12, v10, v12
    s_lshl_b32 s21, s16, 3
    v_add_u32 v11, s21, v11
    v_mul_u32_u24 v13, 208, v11
    v_lshl_add_u32 v15, v12, 4, v13
    v_mul_u32_u24 v13, 2304, v11
    v_lshl_add_u32 v101, v12, 4, v13
    s_mul_i32 s21, s19, 147456
    s_mul_i32 s22, s20, 192
    s_add_u32 s21, s21, s22
    s_add_u32 s21, s21, 1152
    s_waitcnt lgkmcnt(0)
    s_mov_b32 s10, 4718592
    s_mov_b32 s11, 0x20000
    s_barrier
    ds_read_b128 v[40:43], v14 offset:61440
    ds_read_b128 v[44:47], v15 offset:61440
    s_waitcnt lgkmcnt(1)
    buffer_store_dwordx4 v[40:43], v100, s[8:11], s21 offen
    s_waitcnt lgkmcnt(0)
    s_mov_b32 exec_lo, -1
    s_mov_b32 exec_hi, 0x0
    buffer_store_dwordx4 v[44:47], v101, s[8:11], s21 offen
    s_mov_b64 exec, -1
    s_endpgm
k3_role1:
    s_sub_u32 s2, s2, 192
    s_load_dwordx2 s[4:5], s[0:1], 96
    s_load_dwordx2 s[8:9], s[0:1], 80
    v_lshrrev_b32 v2, 6, v0
    v_and_b32 v1, 63, v0
    v_readfirstlane_b32 s16, v2
    s_nop 0
    s_lshl_b32 s17, s16, 6
    s_add_u32 s17, s17, s2
    s_cmp_ge_u32 s17, 288
    s_cbranch_scc1 k3_done
    s_and_b32 s18, s17, 15
    s_lshr_b32 s19, s17, 4
    s_mul_i32 s20, s19, 131072
    s_lshl_b32 s21, s18, 8
    s_add_u32 s20, s20, s21
    s_add_u32 s20, s20, 19922944
    s_mul_i32 s21, s18, 294912
    s_lshl_b32 s19, s19, 6
    s_add_u32 s21, s21, s19
    v_lshrrev_b32 v4, 2, v1
    v_and_b32 v5, 3, v1
    v_lshlrev_b32 v2, 15, v5
    v_lshl_add_u32 v2, v4, 4, v2
    v_mul_u32_u24 v3, 18432, v4
    v_lshl_add_u32 v3, v5, 4, v3
    s_waitcnt lgkmcnt(0)
    s_mov_b32 s6, 24117248
    s_mov_b32 s7, 0x20000
    s_mov_b32 s10, 4718592
    s_mov_b32 s11, 0x20000
    buffer_load_dwordx4 v[8:11], v2, s[4:7], s20 offen
    s_add_u32 s20, s20, 4096
    buffer_load_dwordx4 v[12:15], v2, s[4:7], s20 offen
    s_add_u32 s20, s20, 4096
    buffer_load_dwordx4 v[16:19], v2, s[4:7], s20 offen
    s_add_u32 s20, s20, 4096
    buffer_load_dwordx4 v[20:23], v2, s[4:7], s20 offen
    s_add_u32 s20, s20, 4096
    buffer_load_dwordx4 v[24:27], v2, s[4:7], s20 offen
    s_add_u32 s20, s20, 4096
    buffer_load_dwordx4 v[28:31], v2, s[4:7], s20 offen
    s_add_u32 s20, s20, 4096
    buffer_load_dwordx4 v[32:35], v2, s[4:7], s20 offen
    s_add_u32 s20, s20, 4096
    buffer_load_dwordx4 v[36:39], v2, s[4:7], s20 offen
    s_waitcnt vmcnt(0)
    s_mov_b32 s22, 0x05040100
    s_mov_b32 s23, 0x07060302
    v_perm_b32 v40, v12, v8, s22
    v_perm_b32 v41, v20, v16, s22
    v_perm_b32 v42, v28, v24, s22
    v_perm_b32 v43, v36, v32, s22
    v_perm_b32 v44, v12, v8, s23
    v_perm_b32 v45, v20, v16, s23
    v_perm_b32 v46, v28, v24, s23
    v_perm_b32 v47, v36, v32, s23
    v_perm_b32 v48, v13, v9, s22
    v_perm_b32 v49, v21, v17, s22
    v_perm_b32 v50, v29, v25, s22
    v_perm_b32 v51, v37, v33, s22
    v_perm_b32 v52, v13, v9, s23
    v_perm_b32 v53, v21, v17, s23
    v_perm_b32 v54, v29, v25, s23
    v_perm_b32 v55, v37, v33, s23
    v_perm_b32 v56, v14, v10, s22
    v_perm_b32 v57, v22, v18, s22
    v_perm_b32 v58, v30, v26, s22
    v_perm_b32 v59, v38, v34, s22
    v_perm_b32 v60, v14, v10, s23
    v_perm_b32 v61, v22, v18, s23
    v_perm_b32 v62, v30, v26, s23
    v_perm_b32 v63, v38, v34, s23
    v_perm_b32 v64, v15, v11, s22
    v_perm_b32 v65, v23, v19, s22
    v_perm_b32 v66, v31, v27, s22
    v_perm_b32 v67, v39, v35, s22
    v_perm_b32 v68, v15, v11, s23
    v_perm_b32 v69, v23, v19, s23
    v_perm_b32 v70, v31, v27, s23
    v_perm_b32 v71, v39, v35, s23
    buffer_store_dwordx4 v[40:43], v3, s[8:11], s21 offen
    s_add_u32 s21, s21, 2304
    buffer_store_dwordx4 v[44:47], v3, s[8:11], s21 offen
    s_add_u32 s21, s21, 2304
    buffer_store_dwordx4 v[48:51], v3, s[8:11], s21 offen
    s_add_u32 s21, s21, 2304
    buffer_store_dwordx4 v[52:55], v3, s[8:11], s21 offen
    s_add_u32 s21, s21, 2304
    buffer_store_dwordx4 v[56:59], v3, s[8:11], s21 offen
    s_add_u32 s21, s21, 2304
    buffer_store_dwordx4 v[60:63], v3, s[8:11], s21 offen
    s_add_u32 s21, s21, 2304
    buffer_store_dwordx4 v[64:67], v3, s[8:11], s21 offen
    s_add_u32 s21, s21, 2304
    buffer_store_dwordx4 v[68:71], v3, s[8:11], s21 offen
    s_endpgm
k3_done:
k3_exit:
    s_endpgm
.section .rodata,"a"
.p2align 6
.amdhsa_kernel k3_kernel
  .amdhsa_next_free_vgpr 128
  .amdhsa_next_free_sgpr 102
  .amdhsa_accum_offset 128
  .amdhsa_group_segment_fixed_size 0
  .amdhsa_kernarg_size 104
  .amdhsa_user_sgpr_count 2
  .amdhsa_user_sgpr_kernarg_segment_ptr 1
  .amdhsa_system_sgpr_workgroup_id_x 1
.end_amdhsa_kernel
.text
```
